```python
import torch

def _softmax(x, axis=-1):
    return torch.softmax(x, dim=axis)

def _gelu(x):
    return torch.nn.functional.gelu(x, approximate='tanh')

def _silu(x):
    return torch.nn.functional.silu(x)

def _sigmoid(x):
    return torch.sigmoid(x)

def _layernorm(x, axis=-1, eps=1e-05):
    m = x.mean(dim=axis, keepdim=True)
    v = x.var(dim=axis, keepdim=True, unbiased=False)
    return (x - m) / torch.sqrt(v + eps)

def _scatter_add(tgt, idx, src, axis=0):
    return tgt.clone().index_add_(axis, idx, src)

def _segment_sum(src, seg, n):
    out = torch.zeros((n,) + src.shape[1:], dtype=src.dtype)
    return out.index_add_(0, seg, src)

def _pad(x, pw):
    flat = tuple((v for pair in reversed(pw) for v in pair))
    return torch.nn.functional.pad(x, flat)
kernel_name = 'gated_mix__memory_aug_recurrent_mem_tr__sliding_block__prompt'

def setup_inputs():

    _w = lambda a: (lambda t: t.to(torch.bfloat16) if t.is_floating_point() else t)(torch.as_tensor(a))

    def _A_setup():
        B, S, Dm = (1, 2048, 576)
        H, Dh = (32, 128)
        M, seg = (8, 32)
        seg = min(seg, S)
        S = S // seg * seg
        return {'x': _w((lambda *s: torch.randn(*s, dtype=torch.bfloat16) * 0.05)(B, S, Dm)), 'mem0': _w((lambda *s: torch.randn(*s, dtype=torch.bfloat16) * 1.6)(B, M, Dm)), 'Wq': _w((lambda *s: torch.randn(*s, dtype=torch.bfloat16) * 0.8)(Dm, H, Dh) * Dm ** (-0.5)), 'Wk': _w((lambda *s: torch.randn(*s, dtype=torch.bfloat16) * 0.8)(Dm, H, Dh) * Dm ** (-0.5)), 'Wv': _w((lambda *s: torch.randn(*s, dtype=torch.bfloat16) * 1.6)(Dm, H, Dh) * Dm ** (-0.5)), 'Wo': _w((lambda *s: torch.randn(*s, dtype=torch.bfloat16) * 1.6)(H, Dh, Dm) * (H * Dh) ** (-0.5)), 'seg_len': seg}
    _A_in = _A_setup()

    def _B_setup():
        B, S, D = (1, 2048, 576)
        return {'x': _w((lambda *s: torch.randn(*s, dtype=torch.bfloat16) * 0.05)(B, S, D)), 'wqkv': _w((lambda *s: torch.randn(*s, dtype=torch.bfloat16) * 1.6)(D, 3 * D)), 'wo': _w((lambda *s: torch.randn(*s, dtype=torch.bfloat16) * 0.05)(D, D))}
    _B_in = _B_setup()
    return {'A_x': _A_in['x'], 'A_mem0': _A_in['mem0'], 'A_Wq': _A_in['Wq'], 'A_Wk': _A_in['Wk'], 'A_Wv': _A_in['Wv'], 'A_Wo': _A_in['Wo'], 'A_seg_len': _A_in['seg_len'], 'B_x': _B_in['x'], 'B_wqkv': _B_in['wqkv'], 'B_wo': _B_in['wo'], 'gate_w': _w((lambda *s: torch.randn(*s, dtype=torch.bfloat16) * 0.05)(576) * 16.0)}

def reference(A_x, A_mem0, A_Wq, A_Wk, A_Wv, A_Wo, A_seg_len, B_x, B_wqkv, B_wo, gate_w):

    def _A_ref(x, mem0, Wq, Wk, Wv, Wo, seg_len):
        B, S, Dm = x.shape
        H, Dh = (Wq.shape[1], Wq.shape[2])
        M = mem0.shape[1]
        scale = Dh ** (-0.5)
        n_seg = S // seg_len
        L = M + seg_len
        idx = torch.arange(L)
        mask = (idx[:, None] < M) | (idx[:, None] >= idx[None, :])
        mem = mem0
        outs = []
        for s in range(n_seg):
            xs = x[:, s * seg_len:(s + 1) * seg_len, :].clone()
            h = torch.concatenate([mem, xs], axis=1)
            q = torch.einsum('btd,dhe->bhte', h, Wq)
            k = torch.einsum('btd,dhe->bhte', h, Wk)
            v = torch.einsum('btd,dhe->bhte', h, Wv)
            scores = torch.einsum('bhqe,bhke->bhqk', q, k) * scale
            scores = torch.where(mask[None, None], scores, -1000000000.0)
            p = _softmax(scores, axis=-1)
            o = torch.einsum('bhqk,bhke->bhqe', p, v)
            o = torch.einsum('bhte,hed->btd', o, Wo)
            mem = o[:, :M, :].clone()
            outs.append(o[:, M:, :])
        return torch.concatenate(outs, axis=1)

    def _B_ref(x, wqkv, wo):
        B, S, D = x.shape
        H = 32
        Dh = D // H
        W = 256
        qkv = (lambda x, *d: x.permute(*d))((x @ wqkv).reshape(B, S, 3, H, Dh), 2, 0, 3, 1, 4)
        q, k, v = (qkv[0], qkv[1], qkv[2])
        scores = torch.einsum('bhqd,bhkd->bhqk', q, k) * Dh ** (-0.5)
        idx = torch.arange(S)
        mask = (idx[:, None] - idx[None, :] >= 0) & (idx[:, None] - idx[None, :] < W)
        scores = torch.where(mask[None, None], scores, -1000000000.0)
        p = _softmax(scores, axis=-1)
        o = torch.einsum('bhqk,bhkd->bhqd', p, v)
        return (lambda x, *d: x.permute(*d))(o, 0, 2, 1, 3).reshape(B, S, D) @ wo
    x = A_x
    g = _sigmoid((x * gate_w).sum(-1, keepdims=True))
    a = _A_ref(x, A_mem0, A_Wq, A_Wk, A_Wv, A_Wo, A_seg_len)
    b = _B_ref(x, B_wqkv, B_wo)
    return g * a + (1 - g) * b
```

```asm
; @launch kernel=km_kernel grid=(256,1,1) block=(256,1,1) lds=163840
.amdgcn_target "amdgcn-amd-amdhsa--gfx950"
.text
.p2align 8
.globl km_kernel
.type km_kernel,@function
km_kernel:
    s_cmp_ge_u32 s2, 256
    s_cbranch_scc1 KM_done
    s_load_dwordx16 s[8:23], s[0:1], 0
    s_load_dwordx8 s[24:31], s[0:1], 64
    s_load_dwordx4 s[32:35], s[0:1], 96
    s_waitcnt lgkmcnt(0)
    s_add_u32 s40, s34, 0x3800000
    s_addc_u32 s41, s35, 0
    s_mov_b32 s42, 0x92400
    s_mov_b32 s43, 0x00020000
    s_add_u32 s44, s34, 0x3900000
    s_addc_u32 s45, s35, 0
    s_mov_b32 s46, 0x90000
    s_mov_b32 s47, 0x00020000
    s_add_u32 s48, s34, 0x5800000
    s_addc_u32 s49, s35, 0
    s_mov_b32 s50, 0x3000
    s_mov_b32 s51, 0x00020000
    v_mov_b32 v4, -1
    v_mov_b32 v5, -1
    v_mov_b32 v6, -1
    v_mov_b32 v7, -1
    v_mov_b32 v8, 0
    v_mov_b32 v9, 0
    v_mov_b32 v10, 0
    v_mov_b32 v11, 0
    v_lshlrev_b32 v1, 4, v0
    s_mul_i32 s36, s2, 2304
    s_add_u32 s37, s36, 9216
    v_cmp_gt_u32 vcc, 144, v0
    s_and_saveexec_b64 s[38:39], vcc
    buffer_store_dwordx4 v[4:7], v1, s[40:43], s37 offen sc1
    buffer_store_dwordx4 v[4:7], v1, s[44:47], s36 offen sc1
    s_mov_b64 exec, s[38:39]
    s_mul_i32 s36, s2, 48
    v_cmp_gt_u32 vcc, 3, v0
    s_and_saveexec_b64 s[38:39], vcc
    buffer_store_dwordx4 v[8:11], v1, s[48:51], s36 offen sc1
    s_mov_b64 exec, s[38:39]
    s_cmp_ge_u32 s2, 3
    s_cbranch_scc1 KI_done
    s_mov_b32 s52, s10
    s_mov_b32 s53, s11
    s_mov_b32 s54, 0x2400
    s_mov_b32 s55, 0x00020000
    s_lshl_b32 s36, s2, 8
    v_add_u32 v2, s36, v0
    v_and_b32 v3, 7, v2
    v_lshrrev_b32 v12, 3, v2
    v_mul_u32_u24 v13, 1152, v3
    v_lshrrev_b32 v14, 2, v12
    v_lshl_add_u32 v13, v14, 6, v13
    v_and_b32 v14, 3, v12
    v_lshl_add_u32 v13, v14, 3, v13
    v_lshlrev_b32 v15, 4, v2
    v_cmp_gt_u32 vcc, 576, v2
    s_and_saveexec_b64 s[38:39], vcc
    s_cbranch_execz KI_r
    buffer_load_dwordx2 v[16:17], v13, s[52:55], 0 offen
    buffer_load_dwordx2 v[18:19], v13, s[52:55], 0 offen offset:32
    s_waitcnt vmcnt(0)
    buffer_store_dwordx4 v[16:19], v15, s[40:43], 0 offen sc1
KI_r:
    s_mov_b64 exec, s[38:39]
KI_done:
    s_waitcnt vmcnt(0)
    s_barrier
    s_getreg_b32 s3, hwreg(HW_REG_XCC_ID)
    s_and_b32 s3, s3, 7
    v_lshrrev_b32 v1, 6, v0
    s_nop 0
    v_readfirstlane_b32 s4, v1
    s_cmp_lg_u32 s4, 0
    s_cbranch_scc1 KM_wait_role
    s_add_u32 s6, s32, 128
    s_addc_u32 s7, s33, 0
    s_mov_b64 s[36:37], s[6:7]
    s_mov_b32 exec_lo, 1
    s_mov_b32 exec_hi, 0
    s_lshl_b32 s5, s3, 4
    v_mov_b32 v2, s5
    v_mov_b32 v3, 1
    global_atomic_add v4, v2, v3, s[36:37] sc0
    s_mov_b32 exec_lo, 0xff
    v_lshlrev_b32 v2, 4, v0
    s_waitcnt vmcnt(0)
    v_readfirstlane_b32 s38, v4
    s_mov_b32 s6, 0
KM_el_spin:
    global_load_dword v6, v2, s[36:37] sc1
    s_add_u32 s6, s6, 1
    s_waitcnt vmcnt(0)
    s_mov_b32 s7, 0
    v_readlane_b32 s40, v6, 0
    v_readlane_b32 s41, v6, 1
    v_readlane_b32 s42, v6, 2
    v_readlane_b32 s43, v6, 3
    v_readlane_b32 s44, v6, 4
    v_readlane_b32 s45, v6, 5
    v_readlane_b32 s46, v6, 6
    v_readlane_b32 s47, v6, 7
    s_nop 0
    s_add_u32 s7, s7, s40
    s_add_u32 s7, s7, s41
    s_add_u32 s7, s7, s42
    s_add_u32 s7, s7, s43
    s_add_u32 s7, s7, s44
    s_add_u32 s7, s7, s45
    s_add_u32 s7, s7, s46
    s_add_u32 s7, s7, s47
    s_cmp_ge_u32 s6, 0x200000
    s_cbranch_scc1 KM_el_go
    s_cmp_lt_u32 s7, 256
    s_cbranch_scc1 KM_el_spin
KM_el_go:
    s_mov_b32 exec_lo, 1
    s_mov_b32 exec_hi, 0
    s_mov_b32 s36, -1
    s_cmp_ge_u32 s47, 32
    s_cselect_b32 s36, 7, s36
    s_cmp_ge_u32 s46, 32
    s_cselect_b32 s36, 6, s36
    s_cmp_ge_u32 s45, 32
    s_cselect_b32 s36, 5, s36
    s_cmp_ge_u32 s44, 32
    s_cselect_b32 s36, 4, s36
    s_cmp_ge_u32 s43, 32
    s_cselect_b32 s36, 3, s36
    s_cmp_ge_u32 s42, 32
    s_cselect_b32 s36, 2, s36
    s_cmp_ge_u32 s41, 32
    s_cselect_b32 s36, 1, s36
    s_cmp_ge_u32 s40, 32
    s_cselect_b32 s36, 0, s36
    s_mov_b32 s37, s38
    s_cmp_gt_u32 s3, 0
    s_cselect_b32 s7, s40, 0
    s_add_u32 s37, s37, s7
    s_cmp_gt_u32 s3, 1
    s_cselect_b32 s7, s41, 0
    s_add_u32 s37, s37, s7
    s_cmp_gt_u32 s3, 2
    s_cselect_b32 s7, s42, 0
    s_add_u32 s37, s37, s7
    s_cmp_gt_u32 s3, 3
    s_cselect_b32 s7, s43, 0
    s_add_u32 s37, s37, s7
    s_cmp_gt_u32 s3, 4
    s_cselect_b32 s7, s44, 0
    s_add_u32 s37, s37, s7
    s_cmp_gt_u32 s3, 5
    s_cselect_b32 s7, s45, 0
    s_add_u32 s37, s37, s7
    s_cmp_gt_u32 s3, 6
    s_cselect_b32 s7, s46, 0
    s_add_u32 s37, s37, s7
    s_cmp_eq_u32 s36, -1
    s_cbranch_scc1 KM_el_slow
    s_cmp_lg_u32 s36, s3
    s_cbranch_scc1 KM_el_w
    s_mov_b32 s39, s38
    s_cmp_lt_u32 s38, 32
    s_cbranch_scc1 KM_el_pub
KM_el_w:
    s_cmp_ge_u32 s3, s36
    s_cselect_b32 s7, 32, 0
    s_sub_u32 s39, s37, s7
    s_or_b32 s39, s39, 0x1000
    s_branch KM_el_pub
KM_el_slow:
    s_or_b32 s39, s37, 0x100
    s_cmp_lt_u32 s37, 32
    s_cbranch_scc1 KM_el_pub
    s_sub_u32 s39, s37, 32
    s_or_b32 s39, s39, 0x1000
KM_el_pub:
    v_mov_b32 v2, 0
    v_mov_b32 v3, s39
    ds_write_b32 v2, v3
    s_mov_b64 exec, -1
    s_waitcnt lgkmcnt(0)
KM_wait_role:
    s_barrier
    v_mov_b32 v2, 0
    ds_read_b32 v3, v2
    s_waitcnt lgkmcnt(0)
    v_readfirstlane_b32 s39, v3
    s_barrier
    s_bitcmp1_b32 s39, 12
    s_cbranch_scc1 KM_worker
    s_and_b32 s36, s39, 31
    s_mov_b32 s5, s39
    v_and_b32 v1, 63, v0
    v_lshrrev_b32 v2, 4, v1
    v_and_b32 v3, 15, v1
    v_and_b32 v4, 7, v1
    v_lshrrev_b32 v22, 6, v0
    s_nop 0
    v_readfirstlane_b32 s37, v22
    v_lshrrev_b32 v5, 4, v0
    v_and_b32 v6, 15, v0
    v_lshlrev_b32 v7, 13, v5
    v_lshl_add_u32 v7, v6, 4, v7
    v_mul_u32_u24 v8, 288, v5
    v_lshl_add_u32 v8, v6, 4, v8
    v_lshlrev_b32 v9, 2, v2
    v_lshrrev_b32 v10, 2, v3
    v_add_u32 v9, v9, v10
    v_mul_u32_u24 v9, 288, v9
    v_and_b32 v10, 3, v3
    v_lshl_add_u32 v9, v10, 3, v9
    v_lshl_add_u32 v9, v22, 6, v9
    s_lshl_b32 s38, s36, 8
    s_add_u32 s40, s12, s38
    s_addc_u32 s41, s13, 0
    s_sub_u32 s42, 4718592, s38
    s_mov_b32 s43, 0x00020000
    s_add_u32 s44, s14, s38
    s_addc_u32 s45, s15, 0
    s_sub_u32 s46, 4718592, s38
    s_mov_b32 s47, 0x00020000
    s_add_u32 s48, s16, s38
    s_addc_u32 s49, s17, 0
    s_sub_u32 s50, 4718592, s38
    s_mov_b32 s51, 0x00020000
    s_mov_b32 s39, 0x0
    buffer_load_dwordx4 v[24:27], v7, s[40:43], s39 offen
    s_mov_b32 s39, 0x20000
    buffer_load_dwordx4 v[28:31], v7, s[40:43], s39 offen
    s_mov_b32 s39, 0x40000
    buffer_load_dwordx4 v[32:35], v7, s[40:43], s39 offen
    s_mov_b32 s39, 0x60000
    buffer_load_dwordx4 v[36:39], v7, s[40:43], s39 offen
    s_mov_b32 s39, 0x80000
    buffer_load_dwordx4 v[40:43], v7, s[40:43], s39 offen
    s_mov_b32 s39, 0xa0000
    buffer_load_dwordx4 v[44:47], v7, s[40:43], s39 offen
    s_mov_b32 s39, 0xc0000
    buffer_load_dwordx4 v[48:51], v7, s[40:43], s39 offen
    s_mov_b32 s39, 0xe0000
    buffer_load_dwordx4 v[52:55], v7, s[40:43], s39 offen
    s_mov_b32 s39, 0x100000
    buffer_load_dwordx4 v[56:59], v7, s[40:43], s39 offen
    s_mov_b32 s39, 0x120000
    buffer_load_dwordx4 v[60:63], v7, s[40:43], s39 offen
    s_mov_b32 s39, 0x140000
    buffer_load_dwordx4 v[64:67], v7, s[40:43], s39 offen
    s_mov_b32 s39, 0x160000
    buffer_load_dwordx4 v[68:71], v7, s[40:43], s39 offen
    s_waitcnt vmcnt(6)
    ds_write_b128 v8, v[24:27] offset:0
    ds_write_b128 v8, v[28:31] offset:4608
    ds_write_b128 v8, v[32:35] offset:9216
    ds_write_b128 v8, v[36:39] offset:13824
    ds_write_b128 v8, v[40:43] offset:18432
    ds_write_b128 v8, v[44:47] offset:23040
    s_waitcnt lgkmcnt(0)
    s_mov_b32 s39, 0x180000
    buffer_load_dwordx4 v[24:27], v7, s[40:43], s39 offen
    s_mov_b32 s39, 0x1a0000
    buffer_load_dwordx4 v[28:31], v7, s[40:43], s39 offen
    s_mov_b32 s39, 0x1c0000
    buffer_load_dwordx4 v[32:35], v7, s[40:43], s39 offen
    s_mov_b32 s39, 0x1e0000
    buffer_load_dwordx4 v[36:39], v7, s[40:43], s39 offen
    s_mov_b32 s39, 0x200000
    buffer_load_dwordx4 v[40:43], v7, s[40:43], s39 offen
    s_mov_b32 s39, 0x220000
    buffer_load_dwordx4 v[44:47], v7, s[40:43], s39 offen
    s_barrier
    ds_read_b64_tr_b16 a[0:1], v9 offset:0
    ds_read_b64_tr_b16 a[2:3], v9 offset:4608
    ds_read_b64_tr_b16 a[4:5], v9 offset:32
    ds_read_b64_tr_b16 a[6:7], v9 offset:4640
    ds_read_b64_tr_b16 a[24:25], v9 offset:9216
    ds_read_b64_tr_b16 a[26:27], v9 offset:13824
    ds_read_b64_tr_b16 a[28:29], v9 offset:9248
    ds_read_b64_tr_b16 a[30:31], v9 offset:13856
    ds_read_b64_tr_b16 a[48:49], v9 offset:18432
    ds_read_b64_tr_b16 a[50:51], v9 offset:23040
    ds_read_b64_tr_b16 a[52:53], v9 offset:18464
    ds_read_b64_tr_b16 a[54:55], v9 offset:23072
    s_waitcnt vmcnt(6)
    ds_write_b128 v8, v[48:51] offset:27648
    ds_write_b128 v8, v[52:55] offset:32256
    ds_write_b128 v8, v[56:59] offset:36864
    ds_write_b128 v8, v[60:63] offset:41472
    ds_write_b128 v8, v[64:67] offset:46080
    ds_write_b128 v8, v[68:71] offset:50688
    s_waitcnt lgkmcnt(0)
    s_mov_b32 s39, 0x240000
    buffer_load_dwordx4 v[48:51], v7, s[40:43], s39 offen
    s_mov_b32 s39, 0x260000
    buffer_load_dwordx4 v[52:55], v7, s[40:43], s39 offen
    s_mov_b32 s39, 0x280000
    buffer_load_dwordx4 v[56:59], v7, s[40:43], s39 offen
    s_mov_b32 s39, 0x2a0000
    buffer_load_dwordx4 v[60:63], v7, s[40:43], s39 offen
    s_mov_b32 s39, 0x2c0000
    buffer_load_dwordx4 v[64:67], v7, s[40:43], s39 offen
    s_mov_b32 s39, 0x2e0000
    buffer_load_dwordx4 v[68:71], v7, s[40:43], s39 offen
    s_barrier
    ds_read_b64_tr_b16 a[72:73], v9 offset:27648
    ds_read_b64_tr_b16 a[74:75], v9 offset:32256
    ds_read_b64_tr_b16 a[76:77], v9 offset:27680
    ds_read_b64_tr_b16 a[78:79], v9 offset:32288
    ds_read_b64_tr_b16 a[96:97], v9 offset:36864
    ds_read_b64_tr_b16 a[98:99], v9 offset:41472
    ds_read_b64_tr_b16 a[100:101], v9 offset:36896
    ds_read_b64_tr_b16 a[102:103], v9 offset:41504
    ds_read_b64_tr_b16 a[120:121], v9 offset:46080
    ds_read_b64_tr_b16 a[122:123], v9 offset:50688
    ds_read_b64_tr_b16 a[124:125], v9 offset:46112
    ds_read_b64_tr_b16 a[126:127], v9 offset:50720
    s_waitcnt vmcnt(6)
    ds_write_b128 v8, v[24:27] offset:0
    ds_write_b128 v8, v[28:31] offset:4608
    ds_write_b128 v8, v[32:35] offset:9216
    ds_write_b128 v8, v[36:39] offset:13824
    ds_write_b128 v8, v[40:43] offset:18432
    ds_write_b128 v8, v[44:47] offset:23040
    s_waitcnt lgkmcnt(0)
    s_mov_b32 s39, 0x300000
    buffer_load_dwordx4 v[24:27], v7, s[40:43], s39 offen
    s_mov_b32 s39, 0x320000
    buffer_load_dwordx4 v[28:31], v7, s[40:43], s39 offen
    s_mov_b32 s39, 0x340000
    buffer_load_dwordx4 v[32:35], v7, s[40:43], s39 offen
    s_mov_b32 s39, 0x360000
    buffer_load_dwordx4 v[36:39], v7, s[40:43], s39 offen
    s_mov_b32 s39, 0x380000
    buffer_load_dwordx4 v[40:43], v7, s[40:43], s39 offen
    s_mov_b32 s39, 0x3a0000
    buffer_load_dwordx4 v[44:47], v7, s[40:43], s39 offen
    s_barrier
    ds_read_b64_tr_b16 a[144:145], v9 offset:0
    ds_read_b64_tr_b16 a[146:147], v9 offset:4608
    ds_read_b64_tr_b16 a[148:149], v9 offset:32
    ds_read_b64_tr_b16 a[150:151], v9 offset:4640
    ds_read_b64_tr_b16 a[168:169], v9 offset:9216
    ds_read_b64_tr_b16 a[170:171], v9 offset:13824
    ds_read_b64_tr_b16 a[172:173], v9 offset:9248
    ds_read_b64_tr_b16 a[174:175], v9 offset:13856
    ds_read_b64_tr_b16 a[192:193], v9 offset:18432
    ds_read_b64_tr_b16 a[194:195], v9 offset:23040
    ds_read_b64_tr_b16 a[196:197], v9 offset:18464
    ds_read_b64_tr_b16 a[198:199], v9 offset:23072
    s_waitcnt vmcnt(6)
    ds_write_b128 v8, v[48:51] offset:27648
    ds_write_b128 v8, v[52:55] offset:32256
    ds_write_b128 v8, v[56:59] offset:36864
    ds_write_b128 v8, v[60:63] offset:41472
    ds_write_b128 v8, v[64:67] offset:46080
    ds_write_b128 v8, v[68:71] offset:50688
    s_waitcnt lgkmcnt(0)
    s_mov_b32 s39, 0x3c0000
    buffer_load_dwordx4 v[48:51], v7, s[40:43], s39 offen
    s_mov_b32 s39, 0x3e0000
    buffer_load_dwordx4 v[52:55], v7, s[40:43], s39 offen
    s_mov_b32 s39, 0x400000
    buffer_load_dwordx4 v[56:59], v7, s[40:43], s39 offen
    s_mov_b32 s39, 0x420000
    buffer_load_dwordx4 v[60:63], v7, s[40:43], s39 offen
    s_mov_b32 s39, 0x440000
    buffer_load_dwordx4 v[64:67], v7, s[40:43], s39 offen
    s_mov_b32 s39, 0x460000
    buffer_load_dwordx4 v[68:71], v7, s[40:43], s39 offen
    s_barrier
    ds_read_b64_tr_b16 a[216:217], v9 offset:27648
    ds_read_b64_tr_b16 a[218:219], v9 offset:32256
    ds_read_b64_tr_b16 a[220:221], v9 offset:27680
    ds_read_b64_tr_b16 a[222:223], v9 offset:32288
    ds_read_b64_tr_b16 a[240:241], v9 offset:36864
    ds_read_b64_tr_b16 a[242:243], v9 offset:41472
    ds_read_b64_tr_b16 a[244:245], v9 offset:36896
    ds_read_b64_tr_b16 a[246:247], v9 offset:41504
    ds_read_b64_tr_b16 v[88:89], v9 offset:46080
    ds_read_b64_tr_b16 v[90:91], v9 offset:50688
    ds_read_b64_tr_b16 v[92:93], v9 offset:46112
    ds_read_b64_tr_b16 v[94:95], v9 offset:50720
    s_waitcnt vmcnt(6)
    ds_write_b128 v8, v[24:27] offset:0
    ds_write_b128 v8, v[28:31] offset:4608
    ds_write_b128 v8, v[32:35] offset:9216
    ds_write_b128 v8, v[36:39] offset:13824
    ds_write_b128 v8, v[40:43] offset:18432
    ds_write_b128 v8, v[44:47] offset:23040
    s_waitcnt lgkmcnt(0)
    s_mov_b32 s39, 0x0
    buffer_load_dwordx4 v[24:27], v7, s[44:47], s39 offen
    s_mov_b32 s39, 0x20000
    buffer_load_dwordx4 v[28:31], v7, s[44:47], s39 offen
    s_mov_b32 s39, 0x40000
    buffer_load_dwordx4 v[32:35], v7, s[44:47], s39 offen
    s_mov_b32 s39, 0x60000
    buffer_load_dwordx4 v[36:39], v7, s[44:47], s39 offen
    s_mov_b32 s39, 0x80000
    buffer_load_dwordx4 v[40:43], v7, s[44:47], s39 offen
    s_mov_b32 s39, 0xa0000
    buffer_load_dwordx4 v[44:47], v7, s[44:47], s39 offen
    s_barrier
    ds_read_b64_tr_b16 v[112:113], v9 offset:0
    ds_read_b64_tr_b16 v[114:115], v9 offset:4608
    ds_read_b64_tr_b16 v[116:117], v9 offset:32
    ds_read_b64_tr_b16 v[118:119], v9 offset:4640
    ds_read_b64_tr_b16 v[136:137], v9 offset:9216
    ds_read_b64_tr_b16 v[138:139], v9 offset:13824
    ds_read_b64_tr_b16 v[140:141], v9 offset:9248
    ds_read_b64_tr_b16 v[142:143], v9 offset:13856
    ds_read_b64_tr_b16 v[160:161], v9 offset:18432
    ds_read_b64_tr_b16 v[162:163], v9 offset:23040
    ds_read_b64_tr_b16 v[164:165], v9 offset:18464
    ds_read_b64_tr_b16 v[166:167], v9 offset:23072
    s_waitcnt vmcnt(6)
    ds_write_b128 v8, v[48:51] offset:27648
    ds_write_b128 v8, v[52:55] offset:32256
    ds_write_b128 v8, v[56:59] offset:36864
    ds_write_b128 v8, v[60:63] offset:41472
    ds_write_b128 v8, v[64:67] offset:46080
    ds_write_b128 v8, v[68:71] offset:50688
    s_waitcnt lgkmcnt(0)
    s_mov_b32 s39, 0xc0000
    buffer_load_dwordx4 v[48:51], v7, s[44:47], s39 offen
    s_mov_b32 s39, 0xe0000
    buffer_load_dwordx4 v[52:55], v7, s[44:47], s39 offen
    s_mov_b32 s39, 0x100000
    buffer_load_dwordx4 v[56:59], v7, s[44:47], s39 offen
    s_mov_b32 s39, 0x120000
    buffer_load_dwordx4 v[60:63], v7, s[44:47], s39 offen
    s_mov_b32 s39, 0x140000
    buffer_load_dwordx4 v[64:67], v7, s[44:47], s39 offen
    s_mov_b32 s39, 0x160000
    buffer_load_dwordx4 v[68:71], v7, s[44:47], s39 offen
    s_barrier
    ds_read_b64_tr_b16 v[184:185], v9 offset:27648
    ds_read_b64_tr_b16 v[186:187], v9 offset:32256
    ds_read_b64_tr_b16 v[188:189], v9 offset:27680
    ds_read_b64_tr_b16 v[190:191], v9 offset:32288
    ds_read_b64_tr_b16 v[208:209], v9 offset:36864
    ds_read_b64_tr_b16 v[210:211], v9 offset:41472
    ds_read_b64_tr_b16 v[212:213], v9 offset:36896
    ds_read_b64_tr_b16 v[214:215], v9 offset:41504
    ds_read_b64_tr_b16 v[232:233], v9 offset:46080
    ds_read_b64_tr_b16 v[234:235], v9 offset:50688
    ds_read_b64_tr_b16 v[236:237], v9 offset:46112
    ds_read_b64_tr_b16 v[238:239], v9 offset:50720
    s_waitcnt vmcnt(6)
    ds_write_b128 v8, v[24:27] offset:0
    ds_write_b128 v8, v[28:31] offset:4608
    ds_write_b128 v8, v[32:35] offset:9216
    ds_write_b128 v8, v[36:39] offset:13824
    ds_write_b128 v8, v[40:43] offset:18432
    ds_write_b128 v8, v[44:47] offset:23040
    s_waitcnt lgkmcnt(0)
    s_mov_b32 s39, 0x180000
    buffer_load_dwordx4 v[24:27], v7, s[44:47], s39 offen
    s_mov_b32 s39, 0x1a0000
    buffer_load_dwordx4 v[28:31], v7, s[44:47], s39 offen
    s_mov_b32 s39, 0x1c0000
    buffer_load_dwordx4 v[32:35], v7, s[44:47], s39 offen
    s_mov_b32 s39, 0x1e0000
    buffer_load_dwordx4 v[36:39], v7, s[44:47], s39 offen
    s_mov_b32 s39, 0x200000
    buffer_load_dwordx4 v[40:43], v7, s[44:47], s39 offen
    s_mov_b32 s39, 0x220000
    buffer_load_dwordx4 v[44:47], v7, s[44:47], s39 offen
    s_barrier
    ds_read_b64_tr_b16 a[8:9], v9 offset:0
    ds_read_b64_tr_b16 a[10:11], v9 offset:4608
    ds_read_b64_tr_b16 a[12:13], v9 offset:32
    ds_read_b64_tr_b16 a[14:15], v9 offset:4640
    ds_read_b64_tr_b16 a[32:33], v9 offset:9216
    ds_read_b64_tr_b16 a[34:35], v9 offset:13824
    ds_read_b64_tr_b16 a[36:37], v9 offset:9248
    ds_read_b64_tr_b16 a[38:39], v9 offset:13856
    ds_read_b64_tr_b16 a[56:57], v9 offset:18432
    ds_read_b64_tr_b16 a[58:59], v9 offset:23040
    ds_read_b64_tr_b16 a[60:61], v9 offset:18464
    ds_read_b64_tr_b16 a[62:63], v9 offset:23072
    s_waitcnt vmcnt(6)
    ds_write_b128 v8, v[48:51] offset:27648
    ds_write_b128 v8, v[52:55] offset:32256
    ds_write_b128 v8, v[56:59] offset:36864
    ds_write_b128 v8, v[60:63] offset:41472
    ds_write_b128 v8, v[64:67] offset:46080
    ds_write_b128 v8, v[68:71] offset:50688
    s_waitcnt lgkmcnt(0)
    s_mov_b32 s39, 0x240000
    buffer_load_dwordx4 v[48:51], v7, s[44:47], s39 offen
    s_mov_b32 s39, 0x260000
    buffer_load_dwordx4 v[52:55], v7, s[44:47], s39 offen
    s_mov_b32 s39, 0x280000
    buffer_load_dwordx4 v[56:59], v7, s[44:47], s39 offen
    s_mov_b32 s39, 0x2a0000
    buffer_load_dwordx4 v[60:63], v7, s[44:47], s39 offen
    s_mov_b32 s39, 0x2c0000
    buffer_load_dwordx4 v[64:67], v7, s[44:47], s39 offen
    s_mov_b32 s39, 0x2e0000
    buffer_load_dwordx4 v[68:71], v7, s[44:47], s39 offen
    s_barrier
    ds_read_b64_tr_b16 a[80:81], v9 offset:27648
    ds_read_b64_tr_b16 a[82:83], v9 offset:32256
    ds_read_b64_tr_b16 a[84:85], v9 offset:27680
    ds_read_b64_tr_b16 a[86:87], v9 offset:32288
    ds_read_b64_tr_b16 a[104:105], v9 offset:36864
    ds_read_b64_tr_b16 a[106:107], v9 offset:41472
    ds_read_b64_tr_b16 a[108:109], v9 offset:36896
    ds_read_b64_tr_b16 a[110:111], v9 offset:41504
    ds_read_b64_tr_b16 a[128:129], v9 offset:46080
    ds_read_b64_tr_b16 a[130:131], v9 offset:50688
    ds_read_b64_tr_b16 a[132:133], v9 offset:46112
    ds_read_b64_tr_b16 a[134:135], v9 offset:50720
    s_waitcnt vmcnt(6)
    ds_write_b128 v8, v[24:27] offset:0
    ds_write_b128 v8, v[28:31] offset:4608
    ds_write_b128 v8, v[32:35] offset:9216
    ds_write_b128 v8, v[36:39] offset:13824
    ds_write_b128 v8, v[40:43] offset:18432
    ds_write_b128 v8, v[44:47] offset:23040
    s_waitcnt lgkmcnt(0)
    s_mov_b32 s39, 0x300000
    buffer_load_dwordx4 v[24:27], v7, s[44:47], s39 offen
    s_mov_b32 s39, 0x320000
    buffer_load_dwordx4 v[28:31], v7, s[44:47], s39 offen
    s_mov_b32 s39, 0x340000
    buffer_load_dwordx4 v[32:35], v7, s[44:47], s39 offen
    s_mov_b32 s39, 0x360000
    buffer_load_dwordx4 v[36:39], v7, s[44:47], s39 offen
    s_mov_b32 s39, 0x380000
    buffer_load_dwordx4 v[40:43], v7, s[44:47], s39 offen
    s_mov_b32 s39, 0x3a0000
    buffer_load_dwordx4 v[44:47], v7, s[44:47], s39 offen
    s_barrier
    ds_read_b64_tr_b16 a[152:153], v9 offset:0
    ds_read_b64_tr_b16 a[154:155], v9 offset:4608
    ds_read_b64_tr_b16 a[156:157], v9 offset:32
    ds_read_b64_tr_b16 a[158:159], v9 offset:4640
    ds_read_b64_tr_b16 a[176:177], v9 offset:9216
    ds_read_b64_tr_b16 a[178:179], v9 offset:13824
    ds_read_b64_tr_b16 a[180:181], v9 offset:9248
    ds_read_b64_tr_b16 a[182:183], v9 offset:13856
    ds_read_b64_tr_b16 a[200:201], v9 offset:18432
    ds_read_b64_tr_b16 a[202:203], v9 offset:23040
    ds_read_b64_tr_b16 a[204:205], v9 offset:18464
    ds_read_b64_tr_b16 a[206:207], v9 offset:23072
    s_waitcnt vmcnt(6)
    ds_write_b128 v8, v[48:51] offset:27648
    ds_write_b128 v8, v[52:55] offset:32256
    ds_write_b128 v8, v[56:59] offset:36864
    ds_write_b128 v8, v[60:63] offset:41472
    ds_write_b128 v8, v[64:67] offset:46080
    ds_write_b128 v8, v[68:71] offset:50688
    s_waitcnt lgkmcnt(0)
    s_mov_b32 s39, 0x3c0000
    buffer_load_dwordx4 v[48:51], v7, s[44:47], s39 offen
    s_mov_b32 s39, 0x3e0000
    buffer_load_dwordx4 v[52:55], v7, s[44:47], s39 offen
    s_mov_b32 s39, 0x400000
    buffer_load_dwordx4 v[56:59], v7, s[44:47], s39 offen
    s_mov_b32 s39, 0x420000
    buffer_load_dwordx4 v[60:63], v7, s[44:47], s39 offen
    s_mov_b32 s39, 0x440000
    buffer_load_dwordx4 v[64:67], v7, s[44:47], s39 offen
    s_mov_b32 s39, 0x460000
    buffer_load_dwordx4 v[68:71], v7, s[44:47], s39 offen
    s_barrier
    ds_read_b64_tr_b16 a[224:225], v9 offset:27648
    ds_read_b64_tr_b16 a[226:227], v9 offset:32256
    ds_read_b64_tr_b16 a[228:229], v9 offset:27680
    ds_read_b64_tr_b16 a[230:231], v9 offset:32288
    ds_read_b64_tr_b16 a[248:249], v9 offset:36864
    ds_read_b64_tr_b16 a[250:251], v9 offset:41472
    ds_read_b64_tr_b16 a[252:253], v9 offset:36896
    ds_read_b64_tr_b16 a[254:255], v9 offset:41504
    ds_read_b64_tr_b16 v[96:97], v9 offset:46080
    ds_read_b64_tr_b16 v[98:99], v9 offset:50688
    ds_read_b64_tr_b16 v[100:101], v9 offset:46112
    ds_read_b64_tr_b16 v[102:103], v9 offset:50720
    s_waitcnt vmcnt(6)
    ds_write_b128 v8, v[24:27] offset:0
    ds_write_b128 v8, v[28:31] offset:4608
    ds_write_b128 v8, v[32:35] offset:9216
    ds_write_b128 v8, v[36:39] offset:13824
    ds_write_b128 v8, v[40:43] offset:18432
    ds_write_b128 v8, v[44:47] offset:23040
    s_waitcnt lgkmcnt(0)
    s_mov_b32 s39, 0x0
    buffer_load_dwordx4 v[24:27], v7, s[48:51], s39 offen
    s_mov_b32 s39, 0x20000
    buffer_load_dwordx4 v[28:31], v7, s[48:51], s39 offen
    s_mov_b32 s39, 0x40000
    buffer_load_dwordx4 v[32:35], v7, s[48:51], s39 offen
    s_mov_b32 s39, 0x60000
    buffer_load_dwordx4 v[36:39], v7, s[48:51], s39 offen
    s_mov_b32 s39, 0x80000
    buffer_load_dwordx4 v[40:43], v7, s[48:51], s39 offen
    s_mov_b32 s39, 0xa0000
    buffer_load_dwordx4 v[44:47], v7, s[48:51], s39 offen
    s_barrier
    ds_read_b64_tr_b16 v[120:121], v9 offset:0
    ds_read_b64_tr_b16 v[122:123], v9 offset:4608
    ds_read_b64_tr_b16 v[124:125], v9 offset:32
    ds_read_b64_tr_b16 v[126:127], v9 offset:4640
    ds_read_b64_tr_b16 v[144:145], v9 offset:9216
    ds_read_b64_tr_b16 v[146:147], v9 offset:13824
    ds_read_b64_tr_b16 v[148:149], v9 offset:9248
    ds_read_b64_tr_b16 v[150:151], v9 offset:13856
    ds_read_b64_tr_b16 v[168:169], v9 offset:18432
    ds_read_b64_tr_b16 v[170:171], v9 offset:23040
    ds_read_b64_tr_b16 v[172:173], v9 offset:18464
    ds_read_b64_tr_b16 v[174:175], v9 offset:23072
    s_waitcnt vmcnt(6)
    ds_write_b128 v8, v[48:51] offset:27648
    ds_write_b128 v8, v[52:55] offset:32256
    ds_write_b128 v8, v[56:59] offset:36864
    ds_write_b128 v8, v[60:63] offset:41472
    ds_write_b128 v8, v[64:67] offset:46080
    ds_write_b128 v8, v[68:71] offset:50688
    s_waitcnt lgkmcnt(0)
    s_mov_b32 s39, 0xc0000
    buffer_load_dwordx4 v[48:51], v7, s[48:51], s39 offen
    s_mov_b32 s39, 0xe0000
    buffer_load_dwordx4 v[52:55], v7, s[48:51], s39 offen
    s_mov_b32 s39, 0x100000
    buffer_load_dwordx4 v[56:59], v7, s[48:51], s39 offen
    s_mov_b32 s39, 0x120000
    buffer_load_dwordx4 v[60:63], v7, s[48:51], s39 offen
    s_mov_b32 s39, 0x140000
    buffer_load_dwordx4 v[64:67], v7, s[48:51], s39 offen
    s_mov_b32 s39, 0x160000
    buffer_load_dwordx4 v[68:71], v7, s[48:51], s39 offen
    s_barrier
    ds_read_b64_tr_b16 v[192:193], v9 offset:27648
    ds_read_b64_tr_b16 v[194:195], v9 offset:32256
    ds_read_b64_tr_b16 v[196:197], v9 offset:27680
    ds_read_b64_tr_b16 v[198:199], v9 offset:32288
    ds_read_b64_tr_b16 v[216:217], v9 offset:36864
    ds_read_b64_tr_b16 v[218:219], v9 offset:41472
    ds_read_b64_tr_b16 v[220:221], v9 offset:36896
    ds_read_b64_tr_b16 v[222:223], v9 offset:41504
    ds_read_b64_tr_b16 v[240:241], v9 offset:46080
    ds_read_b64_tr_b16 v[242:243], v9 offset:50688
    ds_read_b64_tr_b16 v[244:245], v9 offset:46112
    ds_read_b64_tr_b16 v[246:247], v9 offset:50720
    s_waitcnt vmcnt(6)
    ds_write_b128 v8, v[24:27] offset:0
    ds_write_b128 v8, v[28:31] offset:4608
    ds_write_b128 v8, v[32:35] offset:9216
    ds_write_b128 v8, v[36:39] offset:13824
    ds_write_b128 v8, v[40:43] offset:18432
    ds_write_b128 v8, v[44:47] offset:23040
    s_waitcnt lgkmcnt(0)
    s_mov_b32 s39, 0x180000
    buffer_load_dwordx4 v[24:27], v7, s[48:51], s39 offen
    s_mov_b32 s39, 0x1a0000
    buffer_load_dwordx4 v[28:31], v7, s[48:51], s39 offen
    s_mov_b32 s39, 0x1c0000
    buffer_load_dwordx4 v[32:35], v7, s[48:51], s39 offen
    s_mov_b32 s39, 0x1e0000
    buffer_load_dwordx4 v[36:39], v7, s[48:51], s39 offen
    s_mov_b32 s39, 0x200000
    buffer_load_dwordx4 v[40:43], v7, s[48:51], s39 offen
    s_mov_b32 s39, 0x220000
    buffer_load_dwordx4 v[44:47], v7, s[48:51], s39 offen
    s_barrier
    ds_read_b64_tr_b16 a[16:17], v9 offset:0
    ds_read_b64_tr_b16 a[18:19], v9 offset:4608
    ds_read_b64_tr_b16 a[20:21], v9 offset:32
    ds_read_b64_tr_b16 a[22:23], v9 offset:4640
    ds_read_b64_tr_b16 a[40:41], v9 offset:9216
    ds_read_b64_tr_b16 a[42:43], v9 offset:13824
    ds_read_b64_tr_b16 a[44:45], v9 offset:9248
    ds_read_b64_tr_b16 a[46:47], v9 offset:13856
    ds_read_b64_tr_b16 a[64:65], v9 offset:18432
    ds_read_b64_tr_b16 a[66:67], v9 offset:23040
    ds_read_b64_tr_b16 a[68:69], v9 offset:18464
    ds_read_b64_tr_b16 a[70:71], v9 offset:23072
    s_waitcnt vmcnt(6)
    ds_write_b128 v8, v[48:51] offset:27648
    ds_write_b128 v8, v[52:55] offset:32256
    ds_write_b128 v8, v[56:59] offset:36864
    ds_write_b128 v8, v[60:63] offset:41472
    ds_write_b128 v8, v[64:67] offset:46080
    ds_write_b128 v8, v[68:71] offset:50688
    s_waitcnt lgkmcnt(0)
    s_mov_b32 s39, 0x240000
    buffer_load_dwordx4 v[48:51], v7, s[48:51], s39 offen
    s_mov_b32 s39, 0x260000
    buffer_load_dwordx4 v[52:55], v7, s[48:51], s39 offen
    s_mov_b32 s39, 0x280000
    buffer_load_dwordx4 v[56:59], v7, s[48:51], s39 offen
    s_mov_b32 s39, 0x2a0000
    buffer_load_dwordx4 v[60:63], v7, s[48:51], s39 offen
    s_mov_b32 s39, 0x2c0000
    buffer_load_dwordx4 v[64:67], v7, s[48:51], s39 offen
    s_mov_b32 s39, 0x2e0000
    buffer_load_dwordx4 v[68:71], v7, s[48:51], s39 offen
    s_barrier
    ds_read_b64_tr_b16 a[88:89], v9 offset:27648
    ds_read_b64_tr_b16 a[90:91], v9 offset:32256
    ds_read_b64_tr_b16 a[92:93], v9 offset:27680
    ds_read_b64_tr_b16 a[94:95], v9 offset:32288
    ds_read_b64_tr_b16 a[112:113], v9 offset:36864
    ds_read_b64_tr_b16 a[114:115], v9 offset:41472
    ds_read_b64_tr_b16 a[116:117], v9 offset:36896
    ds_read_b64_tr_b16 a[118:119], v9 offset:41504
    ds_read_b64_tr_b16 a[136:137], v9 offset:46080
    ds_read_b64_tr_b16 a[138:139], v9 offset:50688
    ds_read_b64_tr_b16 a[140:141], v9 offset:46112
    ds_read_b64_tr_b16 a[142:143], v9 offset:50720
    s_waitcnt vmcnt(6)
    ds_write_b128 v8, v[24:27] offset:0
    ds_write_b128 v8, v[28:31] offset:4608
    ds_write_b128 v8, v[32:35] offset:9216
    ds_write_b128 v8, v[36:39] offset:13824
    ds_write_b128 v8, v[40:43] offset:18432
    ds_write_b128 v8, v[44:47] offset:23040
    s_waitcnt lgkmcnt(0)
    s_mov_b32 s39, 0x300000
    buffer_load_dwordx4 v[24:27], v7, s[48:51], s39 offen
    s_mov_b32 s39, 0x320000
    buffer_load_dwordx4 v[28:31], v7, s[48:51], s39 offen
    s_mov_b32 s39, 0x340000
    buffer_load_dwordx4 v[32:35], v7, s[48:51], s39 offen
    s_mov_b32 s39, 0x360000
    buffer_load_dwordx4 v[36:39], v7, s[48:51], s39 offen
    s_mov_b32 s39, 0x380000
    buffer_load_dwordx4 v[40:43], v7, s[48:51], s39 offen
    s_mov_b32 s39, 0x3a0000
    buffer_load_dwordx4 v[44:47], v7, s[48:51], s39 offen
    s_barrier
    ds_read_b64_tr_b16 a[160:161], v9 offset:0
    ds_read_b64_tr_b16 a[162:163], v9 offset:4608
    ds_read_b64_tr_b16 a[164:165], v9 offset:32
    ds_read_b64_tr_b16 a[166:167], v9 offset:4640
    ds_read_b64_tr_b16 a[184:185], v9 offset:9216
    ds_read_b64_tr_b16 a[186:187], v9 offset:13824
    ds_read_b64_tr_b16 a[188:189], v9 offset:9248
    ds_read_b64_tr_b16 a[190:191], v9 offset:13856
    ds_read_b64_tr_b16 a[208:209], v9 offset:18432
    ds_read_b64_tr_b16 a[210:211], v9 offset:23040
    ds_read_b64_tr_b16 a[212:213], v9 offset:18464
    ds_read_b64_tr_b16 a[214:215], v9 offset:23072
    s_waitcnt vmcnt(6)
    ds_write_b128 v8, v[48:51] offset:27648
    ds_write_b128 v8, v[52:55] offset:32256
    ds_write_b128 v8, v[56:59] offset:36864
    ds_write_b128 v8, v[60:63] offset:41472
    ds_write_b128 v8, v[64:67] offset:46080
    ds_write_b128 v8, v[68:71] offset:50688
    s_waitcnt lgkmcnt(0)
    s_mov_b32 s39, 0x3c0000
    buffer_load_dwordx4 v[48:51], v7, s[48:51], s39 offen
    s_mov_b32 s39, 0x3e0000
    buffer_load_dwordx4 v[52:55], v7, s[48:51], s39 offen
    s_mov_b32 s39, 0x400000
    buffer_load_dwordx4 v[56:59], v7, s[48:51], s39 offen
    s_mov_b32 s39, 0x420000
    buffer_load_dwordx4 v[60:63], v7, s[48:51], s39 offen
    s_mov_b32 s39, 0x440000
    buffer_load_dwordx4 v[64:67], v7, s[48:51], s39 offen
    s_mov_b32 s39, 0x460000
    buffer_load_dwordx4 v[68:71], v7, s[48:51], s39 offen
    s_barrier
    ds_read_b64_tr_b16 a[232:233], v9 offset:27648
    ds_read_b64_tr_b16 a[234:235], v9 offset:32256
    ds_read_b64_tr_b16 a[236:237], v9 offset:27680
    ds_read_b64_tr_b16 a[238:239], v9 offset:32288
    ds_read_b64_tr_b16 v[80:81], v9 offset:36864
    ds_read_b64_tr_b16 v[82:83], v9 offset:41472
    ds_read_b64_tr_b16 v[84:85], v9 offset:36896
    ds_read_b64_tr_b16 v[86:87], v9 offset:41504
    ds_read_b64_tr_b16 v[104:105], v9 offset:46080
    ds_read_b64_tr_b16 v[106:107], v9 offset:50688
    ds_read_b64_tr_b16 v[108:109], v9 offset:46112
    ds_read_b64_tr_b16 v[110:111], v9 offset:50720
    s_waitcnt vmcnt(6)
    ds_write_b128 v8, v[24:27] offset:0
    ds_write_b128 v8, v[28:31] offset:4608
    ds_write_b128 v8, v[32:35] offset:9216
    ds_write_b128 v8, v[36:39] offset:13824
    ds_write_b128 v8, v[40:43] offset:18432
    ds_write_b128 v8, v[44:47] offset:23040
    s_waitcnt lgkmcnt(0)
    s_barrier
    ds_read_b64_tr_b16 v[128:129], v9 offset:0
    ds_read_b64_tr_b16 v[130:131], v9 offset:4608
    ds_read_b64_tr_b16 v[132:133], v9 offset:32
    ds_read_b64_tr_b16 v[134:135], v9 offset:4640
    ds_read_b64_tr_b16 v[152:153], v9 offset:9216
    ds_read_b64_tr_b16 v[154:155], v9 offset:13824
    ds_read_b64_tr_b16 v[156:157], v9 offset:9248
    ds_read_b64_tr_b16 v[158:159], v9 offset:13856
    ds_read_b64_tr_b16 v[176:177], v9 offset:18432
    ds_read_b64_tr_b16 v[178:179], v9 offset:23040
    ds_read_b64_tr_b16 v[180:181], v9 offset:18464
    ds_read_b64_tr_b16 v[182:183], v9 offset:23072
    s_waitcnt vmcnt(0)
    ds_write_b128 v8, v[48:51] offset:27648
    ds_write_b128 v8, v[52:55] offset:32256
    ds_write_b128 v8, v[56:59] offset:36864
    ds_write_b128 v8, v[60:63] offset:41472
    ds_write_b128 v8, v[64:67] offset:46080
    ds_write_b128 v8, v[68:71] offset:50688
    s_waitcnt lgkmcnt(0)
    s_barrier
    ds_read_b64_tr_b16 v[200:201], v9 offset:27648
    ds_read_b64_tr_b16 v[202:203], v9 offset:32256
    ds_read_b64_tr_b16 v[204:205], v9 offset:27680
    ds_read_b64_tr_b16 v[206:207], v9 offset:32288
    ds_read_b64_tr_b16 v[224:225], v9 offset:36864
    ds_read_b64_tr_b16 v[226:227], v9 offset:41472
    ds_read_b64_tr_b16 v[228:229], v9 offset:36896
    ds_read_b64_tr_b16 v[230:231], v9 offset:41504
    ds_read_b64_tr_b16 v[248:249], v9 offset:46080
    ds_read_b64_tr_b16 v[250:251], v9 offset:50688
    ds_read_b64_tr_b16 v[252:253], v9 offset:46112
    ds_read_b64_tr_b16 v[254:255], v9 offset:50720
    s_mul_i32 s38, s36, 147456
    s_add_u32 s40, s18, s38
    s_addc_u32 s41, s19, 0
    s_mov_b32 s42, 147456
    s_mov_b32 s43, 0x00020000
    v_lshlrev_b32 v9, 3, v2
    v_lshrrev_b32 v10, 2, v3
    v_add_u32 v9, v9, v10
    v_mul_u32_u24 v9, 416, v9
    v_and_b32 v10, 3, v3
    v_lshl_add_u32 v9, v10, 3, v9
    v_add_u32 v9, 98304, v9
    v_mul_u32_u24 v10, 13312, v22
    v_add_u32 v9, v9, v10
    v_lshlrev_b32 v11, 4, v1
    v_lshl_add_u32 v11, v22, 10, v11
    v_add_u32 v5, 0, v0
    v_mul_u32_u24 v6, 43691, v5
    v_lshrrev_b32 v6, 20, v6
    v_mul_u32_u24 v7, 24, v6
    v_sub_u32 v5, v5, v7
    v_mul_u32_u24 v12, 1152, v6
    v_lshl_add_u32 v12, v5, 4, v12
    v_mul_u32_u24 v15, 416, v6
    v_lshl_add_u32 v15, v5, 4, v15
    v_add_u32 v15, 98304, v15
    v_add_u32 v5, 256, v0
    v_mul_u32_u24 v6, 43691, v5
    v_lshrrev_b32 v6, 20, v6
    v_mul_u32_u24 v7, 24, v6
    v_sub_u32 v5, v5, v7
    v_mul_u32_u24 v13, 1152, v6
    v_lshl_add_u32 v13, v5, 4, v13
    v_mul_u32_u24 v16, 416, v6
    v_lshl_add_u32 v16, v5, 4, v16
    v_add_u32 v16, 98304, v16
    v_add_u32 v5, 512, v0
    v_mul_u32_u24 v6, 43691, v5
    v_lshrrev_b32 v6, 20, v6
    v_mul_u32_u24 v7, 24, v6
    v_sub_u32 v5, v5, v7
    v_mul_u32_u24 v14, 1152, v6
    v_lshl_add_u32 v14, v5, 4, v14
    v_mul_u32_u24 v17, 416, v6
    v_lshl_add_u32 v17, v5, 4, v17
    v_add_u32 v17, 98304, v17
    s_mov_b32 s39, 0
    buffer_load_dwordx4 v[24:27], v12, s[40:43], s39 offen
    s_mov_b32 s39, 0
    buffer_load_dwordx4 v[28:31], v13, s[40:43], s39 offen
    s_mov_b32 s39, 0
    buffer_load_dwordx4 v[32:35], v14, s[40:43], s39 offen
    s_mov_b32 s39, 36864
    buffer_load_dwordx4 v[36:39], v12, s[40:43], s39 offen
    s_mov_b32 s39, 36864
    buffer_load_dwordx4 v[40:43], v13, s[40:43], s39 offen
    s_mov_b32 s39, 36864
    buffer_load_dwordx4 v[44:47], v14, s[40:43], s39 offen
    s_mov_b32 s39, 73728
    buffer_load_dwordx4 v[48:51], v12, s[40:43], s39 offen
    s_mov_b32 s39, 73728
    buffer_load_dwordx4 v[52:55], v13, s[40:43], s39 offen
    s_mov_b32 s39, 73728
    buffer_load_dwordx4 v[56:59], v14, s[40:43], s39 offen
    s_mov_b32 s39, 110592
    buffer_load_dwordx4 v[60:63], v12, s[40:43], s39 offen
    s_mov_b32 s39, 110592
    buffer_load_dwordx4 v[64:67], v13, s[40:43], s39 offen
    s_mov_b32 s39, 110592
    buffer_load_dwordx4 v[68:71], v14, s[40:43], s39 offen
    s_waitcnt vmcnt(0) lgkmcnt(0)
    s_barrier
    ds_write_b128 v15, v[24:27] offset:0
    ds_write_b128 v16, v[28:31] offset:0
    ds_write_b128 v17, v[32:35] offset:0
    ds_write_b128 v15, v[36:39] offset:13312
    ds_write_b128 v16, v[40:43] offset:13312
    ds_write_b128 v17, v[44:47] offset:13312
    ds_write_b128 v15, v[48:51] offset:26624
    ds_write_b128 v16, v[52:55] offset:26624
    ds_write_b128 v17, v[56:59] offset:26624
    ds_write_b128 v15, v[60:63] offset:39936
    ds_write_b128 v16, v[64:67] offset:39936
    ds_write_b128 v17, v[68:71] offset:39936
    s_waitcnt lgkmcnt(0)
    s_barrier
    ds_read_b64_tr_b16 v[24:25], v9 offset:0
    ds_read_b64_tr_b16 v[26:27], v9 offset:1664
    ds_read_b64_tr_b16 v[28:29], v9 offset:32
    ds_read_b64_tr_b16 v[30:31], v9 offset:1696
    ds_read_b64_tr_b16 v[32:33], v9 offset:64
    ds_read_b64_tr_b16 v[34:35], v9 offset:1728
    ds_read_b64_tr_b16 v[36:37], v9 offset:96
    ds_read_b64_tr_b16 v[38:39], v9 offset:1760
    ds_read_b64_tr_b16 v[40:41], v9 offset:128
    ds_read_b64_tr_b16 v[42:43], v9 offset:1792
    ds_read_b64_tr_b16 v[44:45], v9 offset:160
    ds_read_b64_tr_b16 v[46:47], v9 offset:1824
    ds_read_b64_tr_b16 v[48:49], v9 offset:192
    ds_read_b64_tr_b16 v[50:51], v9 offset:1856
    ds_read_b64_tr_b16 v[52:53], v9 offset:224
    ds_read_b64_tr_b16 v[54:55], v9 offset:1888
    ds_read_b64_tr_b16 v[56:57], v9 offset:256
    ds_read_b64_tr_b16 v[58:59], v9 offset:1920
    ds_read_b64_tr_b16 v[60:61], v9 offset:288
    ds_read_b64_tr_b16 v[62:63], v9 offset:1952
    ds_read_b64_tr_b16 v[64:65], v9 offset:320
    ds_read_b64_tr_b16 v[66:67], v9 offset:1984
    ds_read_b64_tr_b16 v[68:69], v9 offset:352
    ds_read_b64_tr_b16 v[70:71], v9 offset:2016
    s_waitcnt lgkmcnt(0)
    s_barrier
    v_add_u32 v10, 0, v11
    ds_write_b128 v10, v[24:27]
    v_add_u32 v10, 4096, v11
    ds_write_b128 v10, v[28:31]
    v_add_u32 v10, 8192, v11
    ds_write_b128 v10, v[32:35]
    v_add_u32 v10, 12288, v11
    ds_write_b128 v10, v[36:39]
    v_add_u32 v10, 16384, v11
    ds_write_b128 v10, v[40:43]
    v_add_u32 v10, 20480, v11
    ds_write_b128 v10, v[44:47]
    v_add_u32 v10, 24576, v11
    ds_write_b128 v10, v[48:51]
    v_add_u32 v10, 28672, v11
    ds_write_b128 v10, v[52:55]
    v_add_u32 v10, 32768, v11
    ds_write_b128 v10, v[56:59]
    v_add_u32 v10, 36864, v11
    ds_write_b128 v10, v[60:63]
    v_add_u32 v10, 40960, v11
    ds_write_b128 v10, v[64:67]
    v_add_u32 v10, 45056, v11
    ds_write_b128 v10, v[68:71]
    s_waitcnt lgkmcnt(0)
    s_mov_b32 s39, 384
    buffer_load_dwordx4 v[24:27], v12, s[40:43], s39 offen
    s_mov_b32 s39, 384
    buffer_load_dwordx4 v[28:31], v13, s[40:43], s39 offen
    s_mov_b32 s39, 384
    buffer_load_dwordx4 v[32:35], v14, s[40:43], s39 offen
    s_mov_b32 s39, 37248
    buffer_load_dwordx4 v[36:39], v12, s[40:43], s39 offen
    s_mov_b32 s39, 37248
    buffer_load_dwordx4 v[40:43], v13, s[40:43], s39 offen
    s_mov_b32 s39, 37248
    buffer_load_dwordx4 v[44:47], v14, s[40:43], s39 offen
    s_mov_b32 s39, 74112
    buffer_load_dwordx4 v[48:51], v12, s[40:43], s39 offen
    s_mov_b32 s39, 74112
    buffer_load_dwordx4 v[52:55], v13, s[40:43], s39 offen
    s_mov_b32 s39, 74112
    buffer_load_dwordx4 v[56:59], v14, s[40:43], s39 offen
    s_mov_b32 s39, 110976
    buffer_load_dwordx4 v[60:63], v12, s[40:43], s39 offen
    s_mov_b32 s39, 110976
    buffer_load_dwordx4 v[64:67], v13, s[40:43], s39 offen
    s_mov_b32 s39, 110976
    buffer_load_dwordx4 v[68:71], v14, s[40:43], s39 offen
    s_waitcnt vmcnt(0) lgkmcnt(0)
    s_barrier
    ds_write_b128 v15, v[24:27] offset:0
    ds_write_b128 v16, v[28:31] offset:0
    ds_write_b128 v17, v[32:35] offset:0
    ds_write_b128 v15, v[36:39] offset:13312
    ds_write_b128 v16, v[40:43] offset:13312
    ds_write_b128 v17, v[44:47] offset:13312
    ds_write_b128 v15, v[48:51] offset:26624
    ds_write_b128 v16, v[52:55] offset:26624
    ds_write_b128 v17, v[56:59] offset:26624
    ds_write_b128 v15, v[60:63] offset:39936
    ds_write_b128 v16, v[64:67] offset:39936
    ds_write_b128 v17, v[68:71] offset:39936
    s_waitcnt lgkmcnt(0)
    s_barrier
    ds_read_b64_tr_b16 v[24:25], v9 offset:0
    ds_read_b64_tr_b16 v[26:27], v9 offset:1664
    ds_read_b64_tr_b16 v[28:29], v9 offset:32
    ds_read_b64_tr_b16 v[30:31], v9 offset:1696
    ds_read_b64_tr_b16 v[32:33], v9 offset:64
    ds_read_b64_tr_b16 v[34:35], v9 offset:1728
    ds_read_b64_tr_b16 v[36:37], v9 offset:96
    ds_read_b64_tr_b16 v[38:39], v9 offset:1760
    ds_read_b64_tr_b16 v[40:41], v9 offset:128
    ds_read_b64_tr_b16 v[42:43], v9 offset:1792
    ds_read_b64_tr_b16 v[44:45], v9 offset:160
    ds_read_b64_tr_b16 v[46:47], v9 offset:1824
    ds_read_b64_tr_b16 v[48:49], v9 offset:192
    ds_read_b64_tr_b16 v[50:51], v9 offset:1856
    ds_read_b64_tr_b16 v[52:53], v9 offset:224
    ds_read_b64_tr_b16 v[54:55], v9 offset:1888
    ds_read_b64_tr_b16 v[56:57], v9 offset:256
    ds_read_b64_tr_b16 v[58:59], v9 offset:1920
    ds_read_b64_tr_b16 v[60:61], v9 offset:288
    ds_read_b64_tr_b16 v[62:63], v9 offset:1952
    ds_read_b64_tr_b16 v[64:65], v9 offset:320
    ds_read_b64_tr_b16 v[66:67], v9 offset:1984
    ds_read_b64_tr_b16 v[68:69], v9 offset:352
    ds_read_b64_tr_b16 v[70:71], v9 offset:2016
    s_waitcnt lgkmcnt(0)
    s_barrier
    v_add_u32 v10, 49152, v11
    ds_write_b128 v10, v[24:27]
    v_add_u32 v10, 53248, v11
    ds_write_b128 v10, v[28:31]
    v_add_u32 v10, 57344, v11
    ds_write_b128 v10, v[32:35]
    v_add_u32 v10, 61440, v11
    ds_write_b128 v10, v[36:39]
    v_add_u32 v10, 65536, v11
    ds_write_b128 v10, v[40:43]
    v_add_u32 v10, 69632, v11
    ds_write_b128 v10, v[44:47]
    v_add_u32 v10, 73728, v11
    ds_write_b128 v10, v[48:51]
    v_add_u32 v10, 77824, v11
    ds_write_b128 v10, v[52:55]
    v_add_u32 v10, 81920, v11
    ds_write_b128 v10, v[56:59]
    v_add_u32 v10, 86016, v11
    ds_write_b128 v10, v[60:63]
    v_add_u32 v10, 90112, v11
    ds_write_b128 v10, v[64:67]
    v_add_u32 v10, 94208, v11
    ds_write_b128 v10, v[68:71]
    s_waitcnt lgkmcnt(0)
    s_mov_b32 s39, 768
    buffer_load_dwordx4 v[24:27], v12, s[40:43], s39 offen
    s_mov_b32 s39, 768
    buffer_load_dwordx4 v[28:31], v13, s[40:43], s39 offen
    s_mov_b32 s39, 768
    buffer_load_dwordx4 v[32:35], v14, s[40:43], s39 offen
    s_mov_b32 s39, 37632
    buffer_load_dwordx4 v[36:39], v12, s[40:43], s39 offen
    s_mov_b32 s39, 37632
    buffer_load_dwordx4 v[40:43], v13, s[40:43], s39 offen
    s_mov_b32 s39, 37632
    buffer_load_dwordx4 v[44:47], v14, s[40:43], s39 offen
    s_mov_b32 s39, 74496
    buffer_load_dwordx4 v[48:51], v12, s[40:43], s39 offen
    s_mov_b32 s39, 74496
    buffer_load_dwordx4 v[52:55], v13, s[40:43], s39 offen
    s_mov_b32 s39, 74496
    buffer_load_dwordx4 v[56:59], v14, s[40:43], s39 offen
    s_mov_b32 s39, 111360
    buffer_load_dwordx4 v[60:63], v12, s[40:43], s39 offen
    s_mov_b32 s39, 111360
    buffer_load_dwordx4 v[64:67], v13, s[40:43], s39 offen
    s_mov_b32 s39, 111360
    buffer_load_dwordx4 v[68:71], v14, s[40:43], s39 offen
    s_waitcnt vmcnt(0) lgkmcnt(0)
    s_barrier
    ds_write_b128 v15, v[24:27] offset:0
    ds_write_b128 v16, v[28:31] offset:0
    ds_write_b128 v17, v[32:35] offset:0
    ds_write_b128 v15, v[36:39] offset:13312
    ds_write_b128 v16, v[40:43] offset:13312
    ds_write_b128 v17, v[44:47] offset:13312
    ds_write_b128 v15, v[48:51] offset:26624
    ds_write_b128 v16, v[52:55] offset:26624
    ds_write_b128 v17, v[56:59] offset:26624
    ds_write_b128 v15, v[60:63] offset:39936
    ds_write_b128 v16, v[64:67] offset:39936
    ds_write_b128 v17, v[68:71] offset:39936
    s_waitcnt lgkmcnt(0)
    s_barrier
    ds_read_b64_tr_b16 v[24:25], v9 offset:0
    ds_read_b64_tr_b16 v[26:27], v9 offset:1664
    ds_read_b64_tr_b16 v[28:29], v9 offset:32
    ds_read_b64_tr_b16 v[30:31], v9 offset:1696
    ds_read_b64_tr_b16 v[32:33], v9 offset:64
    ds_read_b64_tr_b16 v[34:35], v9 offset:1728
    ds_read_b64_tr_b16 v[36:37], v9 offset:96
    ds_read_b64_tr_b16 v[38:39], v9 offset:1760
    ds_read_b64_tr_b16 v[40:41], v9 offset:128
    ds_read_b64_tr_b16 v[42:43], v9 offset:1792
    ds_read_b64_tr_b16 v[44:45], v9 offset:160
    ds_read_b64_tr_b16 v[46:47], v9 offset:1824
    ds_read_b64_tr_b16 v[48:49], v9 offset:192
    ds_read_b64_tr_b16 v[50:51], v9 offset:1856
    ds_read_b64_tr_b16 v[52:53], v9 offset:224
    ds_read_b64_tr_b16 v[54:55], v9 offset:1888
    ds_read_b64_tr_b16 v[56:57], v9 offset:256
    ds_read_b64_tr_b16 v[58:59], v9 offset:1920
    ds_read_b64_tr_b16 v[60:61], v9 offset:288
    ds_read_b64_tr_b16 v[62:63], v9 offset:1952
    ds_read_b64_tr_b16 v[64:65], v9 offset:320
    ds_read_b64_tr_b16 v[66:67], v9 offset:1984
    ds_read_b64_tr_b16 v[68:69], v9 offset:352
    ds_read_b64_tr_b16 v[70:71], v9 offset:2016
    s_waitcnt lgkmcnt(0)
    s_barrier
    v_add_u32 v10, 98304, v11
    ds_write_b128 v10, v[24:27]
    v_add_u32 v10, 102400, v11
    ds_write_b128 v10, v[28:31]
    v_add_u32 v10, 106496, v11
    ds_write_b128 v10, v[32:35]
    v_add_u32 v10, 110592, v11
    ds_write_b128 v10, v[36:39]
    v_add_u32 v10, 114688, v11
    ds_write_b128 v10, v[40:43]
    v_add_u32 v10, 118784, v11
    ds_write_b128 v10, v[44:47]
    v_add_u32 v10, 122880, v11
    ds_write_b128 v10, v[48:51]
    v_add_u32 v10, 126976, v11
    ds_write_b128 v10, v[52:55]
    v_add_u32 v10, 131072, v11
    ds_write_b128 v10, v[56:59]
    v_add_u32 v10, 135168, v11
    ds_write_b128 v10, v[60:63]
    v_add_u32 v10, 139264, v11
    ds_write_b128 v10, v[64:67]
    v_add_u32 v10, 143360, v11
    ds_write_b128 v10, v[68:71]
    s_waitcnt lgkmcnt(0)
    s_barrier
    v_mul_u32_u24 v5, 2304, v22
    v_lshl_add_u32 v6, v3, 4, v5
    v_add_u32 v6, 2048, v6
    v_lshl_add_u32 v5, v1, 4, v5
    v_add_u32 v7, 147456, v5
    v_add_u32 v8, 147456, v6
    v_lshlrev_b32 v9, 7, v2
    v_lshl_add_u32 v9, v4, 4, v9
    v_add_u32 v9, 147456, v9
    v_lshlrev_b32 v10, 13, v3
    v_lshl_add_u32 v10, v22, 6, v10
    v_lshl_add_u32 v10, v2, 3, v10
    s_lshl_b32 s38, s36, 8
    v_add_u32 v10, s38, v10
    v_lshl_add_u32 v11, v22, 5, v3
    v_lshlrev_b32 v11, 12, v11
    v_lshl_add_u32 v11, v2, 3, v11
    s_lshl_b32 s38, s36, 19
    v_add_u32 v11, s38, v11
    v_lshlrev_b32 v13, 7, v2
    v_lshl_add_u32 v13, v4, 4, v13
    v_add_u32 v13, 156672, v13
    v_mul_u32_u24 v12, 1280, v22
    v_add_u32 v12, v12, v13
    v_lshrrev_b32 v24, 3, v3
    v_lshl_add_u32 v13, v24, 9, v13
    v_add_u32 v13, 256, v13
    v_and_b32 v23, 1, v2
    v_lshlrev_b32 v23, 7, v23
    v_lshl_add_u32 v23, v4, 4, v23
    v_add_u32 v23, 156672, v23
    v_lshlrev_b32 v15, 7, v2
    v_lshl_add_u32 v15, v4, 4, v15
    v_add_u32 v15, 161792, v15
    v_lshrrev_b32 v14, 1, v2
    v_lshlrev_b32 v14, 7, v14
    v_lshl_add_u32 v14, v4, 4, v14
    v_and_b32 v24, 1, v2
    v_lshl_add_u32 v14, v24, 3, v14
    v_lshl_add_u32 v14, v22, 9, v14
    v_add_u32 v14, 161792, v14
    s_add_u32 s75, s37, 1
    s_lshr_b32 s75, s75, 1
    s_lshl_b32 s38, s37, 2
    s_add_u32 s75, s75, s38
    s_lshl_b32 s38, s75, 13
    v_lshlrev_b32 v16, 4, v1
    v_add_u32 v16, s38, v16
    v_lshlrev_b32 v17, 12, v2
    v_lshl_add_u32 v17, v4, 4, v17
    s_lshl_b32 s38, s75, 14
    v_add_u32 v17, s38, v17
    s_lshl_b32 s38, s36, 7
    v_add_u32 v17, s38, v17
    s_bitcmp1_b32 s37, 0
    s_mov_b32 s80, 32768
    s_cselect_b32 s80, -4096, s80
    s_mov_b32 s81, 0
    s_cselect_b32 s81, -81912, s81
    v_lshlrev_b32 v18, 4, v1
    v_lshlrev_b32 v19, 4, v4
    v_lshl_add_u32 v19, v2, 3, v19
    v_lshlrev_b32 v20, 8, v4
    v_lshl_add_u32 v20, v22, 6, v20
    v_lshl_add_u32 v20, v2, 3, v20
    s_lshl_b32 s38, s36, 11
    v_add_u32 v20, s38, v20
    v_lshl_add_u32 v21, v22, 5, v3
    v_lshlrev_b32 v21, 4, v21
    v_lshl_add_u32 v21, v2, 3, v21
    v_add_u32 v21, s38, v21
    v_lshrrev_b32 v24, 1, v1
    v_lshlrev_b32 v24, 13, v24
    v_and_b32 v25, 1, v1
    v_lshl_add_u32 v24, v25, 7, v24
    s_lshl_b32 s38, s36, 8
    v_add_u32 v24, s38, v24
    s_min_u32 s38, s37, 2
    s_lshl_b32 s38, s38, 6
    s_sub_u32 s38, s38, 64
    v_add_u32 v25, s38, v1
    v_lshlrev_b32 v25, 12, v25
    s_lshl_b32 s38, s36, 19
    s_add_u32 s38, s38, 0x1000000
    v_add_u32 v25, s38, v25
    s_cmp_eq_u32 s37, 0
    s_cselect_b64 vcc, -1, 0
    v_cndmask_b32 v4, v25, v24, vcc
    s_cselect_b32 s76, 18, 6
    v_mov_b32 v24, 0x3f80
    v_and_b32 v25, 1, v3
    v_lshlrev_b32 v25, 4, v25
    v_lshlrev_b32 v24, v25, v24
    v_lshrrev_b32 v25, 1, v3
    v_cmp_eq_u32 vcc, 0, v25
    s_nop 1
    v_cndmask_b32 v26, 0, v24, vcc
    v_cmp_eq_u32 vcc, 1, v25
    s_nop 1
    v_cndmask_b32 v27, 0, v24, vcc
    v_cmp_eq_u32 vcc, 2, v25
    s_nop 1
    v_cndmask_b32 v28, 0, v24, vcc
    v_cmp_eq_u32 vcc, 3, v25
    s_nop 1
    v_cndmask_b32 v29, 0, v24, vcc
    v_mov_b32 v0, v26
    v_mov_b32 v1, v27
    v_mov_b32 v2, v28
    v_mov_b32 v3, v29
    s_lshl_b32 s39, s37, 5
    s_add_u32 s39, s39, s36
    s_cmp_ge_u32 s39, 72
    s_cselect_b32 s39, -1, s39
    s_lshr_b32 s38, s39, 2
    s_mov_b32 s77, 0
    s_cmp_eq_u32 s38, 0
    s_cselect_b32 s77, 0, s77
    s_cmp_eq_u32 s38, 1
    s_cselect_b32 s77, 512, s77
    s_cmp_eq_u32 s38, 2
    s_cselect_b32 s77, 1024, s77
    s_cmp_eq_u32 s38, 3
    s_cselect_b32 s77, 1536, s77
    s_cmp_eq_u32 s38, 4
    s_cselect_b32 s77, 2048, s77
    s_cmp_eq_u32 s38, 5
    s_cselect_b32 s77, 2560, s77
    s_cmp_eq_u32 s38, 6
    s_cselect_b32 s77, 3072, s77
    s_cmp_eq_u32 s38, 7
    s_cselect_b32 s77, 3584, s77
    s_cmp_eq_u32 s38, 8
    s_cselect_b32 s77, 4096, s77
    s_cmp_eq_u32 s38, 9
    s_cselect_b32 s77, 4608, s77
    s_cmp_eq_u32 s38, 10
    s_cselect_b32 s77, 5120, s77
    s_cmp_eq_u32 s38, 11
    s_cselect_b32 s77, 5632, s77
    s_cmp_eq_u32 s38, 12
    s_cselect_b32 s77, 6144, s77
    s_cmp_eq_u32 s38, 13
    s_cselect_b32 s77, 6656, s77
    s_cmp_eq_u32 s38, 14
    s_cselect_b32 s77, 7168, s77
    s_cmp_eq_u32 s38, 15
    s_cselect_b32 s77, 7680, s77
    s_cmp_eq_u32 s38, 16
    s_cselect_b32 s77, 8192, s77
    s_cmp_eq_u32 s38, 17
    s_cselect_b32 s77, 8704, s77
    s_and_b32 s38, s39, 3
    s_lshl_b32 s38, s38, 7
    s_add_u32 s77, s77, s38
    s_add_u32 s40, s34, 0x3800000
    s_addc_u32 s41, s35, 0
    s_mov_b32 s42, 0x92400
    s_mov_b32 s43, 0x00020000
    s_add_u32 s44, s34, 0x3900000
    s_addc_u32 s45, s35, 0
    s_mov_b32 s46, 0x90000
    s_mov_b32 s47, 0x00020000
    s_add_u32 s48, s34, 0x1000000
    s_addc_u32 s49, s35, 0
    s_mov_b32 s50, 0x2000000
    s_mov_b32 s51, 0x00020000
    s_add_u32 s52, s34, 0x2000000
    s_addc_u32 s53, s35, 0
    s_mov_b32 s54, 0x1000000
    s_mov_b32 s55, 0x00020000
    s_add_u32 s56, s34, 0x3c00000
    s_addc_u32 s57, s35, 0
    s_mov_b32 s58, 0x400000
    s_mov_b32 s59, 0x00020000
    s_add_u32 s60, s34, 0x4000000
    s_addc_u32 s61, s35, 0
    s_mov_b32 s62, 0x400000
    s_mov_b32 s63, 0x00020000
    s_mov_b32 s64, 0
    s_mov_b32 s72, 0xff00ff00
    s_mov_b32 s73, -1
    s_mov_b32 s74, 0xff800000
    s_lshl_b32 s38, s36, 2
    s_add_u32 s38, s38, s37
    s_lshl_b32 s38, s38, 2
    s_add_u32 s38, s38, 0x5800000
    s_add_u32 s78, s34, s38
    s_addc_u32 s79, s35, 0
    s_bitcmp1_b32 s5, 8
    s_cbranch_scc1 KM_slow
    s_mov_b32 s68, 0x3e0293ee
    s_mov_b32 s69, 0x3e0293ee
    s_mov_b32 s82, 0
CF_top:
    s_and_b32 s65, s64, 3
    s_cmp_eq_u32 s65, 3
    s_cselect_b32 s65, 1, 0
    s_cmp_eq_u32 s64, 0
    s_cselect_b32 s65, 1, s65
    s_andn2_b32 s65, s65, s82
    s_cmp_eq_u32 s65, 0
    s_cbranch_scc1 CF_kvok
    s_add_u32 s65, s64, 1
    s_min_u32 s65, s65, 63
    s_lshr_b32 s65, s65, 2
    s_lshl_b32 s65, s65, 2
    s_add_u32 s65, s65, 64
    v_mov_b32 v77, s65
    s_mov_b32 s67, 0
CF_kvw:
    global_load_dword v76, v77, s[32:33] sc1
    v_mov_b32 v78, 40
    global_load_dword v78, v78, s[32:33] sc1
    s_add_u32 s67, s67, 1
    s_waitcnt vmcnt(0)
    v_readfirstlane_b32 s66, v78
    s_cmp_ge_u32 s66, 224
    s_cselect_b32 s82, 1, 0
    v_cmp_gt_u32 vcc, 64, v76
    s_cmp_ge_u32 s67, 0x100000
    s_cbranch_scc1 CF_kvok
    s_cbranch_vccz CF_kvok
    s_sleep 4
    s_branch CF_kvw
CF_kvok:
    s_mul_i32 s65, s64, 9216
    s_mov_b32 s67, 0
CF_pollm:
    buffer_load_dwordx4 v[48:51], v5, s[40:43], s65 offen sc1
    buffer_load_dwordx4 v[52:55], v5, s[40:43], s65 offen offset:1024 sc1
    buffer_load_dwordx4 v[56:59], v6, s[40:43], s65 offen sc1
    s_add_u32 s67, s67, 1
    s_waitcnt vmcnt(0)
    v_max3_u32 v76, v48, v49, v50
    v_max3_u32 v77, v51, v52, v53
    v_max3_u32 v78, v54, v55, v56
    v_max3_u32 v79, v57, v58, v59
    v_max3_u32 v76, v76, v77, v78
    v_max_u32 v76, v76, v79
    v_cmp_eq_u32 vcc, -1, v76
    s_cmp_ge_u32 s67, 0x100000
    s_cbranch_scc1 CF_pm_done
    s_cbranch_vccnz CF_pollm
CF_pm_done:
    ds_write_b128 v7, v[48:51]
    ds_write_b128 v7, v[52:55] offset:1024
    ds_write_b128 v8, v[56:59]
    s_lshl_b32 s70, s64, 18
    s_add_u32 s71, s70, 0x20000
    s_lshl_b32 s65, s64, 16
    s_waitcnt lgkmcnt(0)
    s_barrier
    ds_read_b128 v[48:51], v9 offset:0
    ds_read_b128 v[52:55], v9 offset:512
    ds_read_b128 v[56:59], v9 offset:1024
    s_waitcnt lgkmcnt(2)
    v_mfma_f32_16x16x32_bf16 v[24:27], a[0:3], v[48:51], 0
    v_mfma_f32_16x16x32_bf16 v[28:31], a[4:7], v[48:51], 0
    buffer_load_dwordx2 v[60:61], v10, s[48:51], s70 offen
    v_mfma_f32_16x16x32_bf16 v[32:35], a[8:11], v[48:51], 0
    buffer_load_dwordx2 v[62:63], v10, s[48:51], s70 offen offset:32
    v_mfma_f32_16x16x32_bf16 v[36:39], a[12:15], v[48:51], 0
    ds_read_b128 v[48:51], v9 offset:1536
    s_waitcnt lgkmcnt(2)
    v_mfma_f32_16x16x32_bf16 v[24:27], a[24:27], v[52:55], v[24:27]
    v_mfma_f32_16x16x32_bf16 v[28:31], a[28:31], v[52:55], v[28:31]
    buffer_load_dwordx2 v[64:65], v10, s[48:51], s71 offen
    v_mfma_f32_16x16x32_bf16 v[32:35], a[32:35], v[52:55], v[32:35]
    buffer_load_dwordx2 v[66:67], v10, s[48:51], s71 offen offset:32
    v_mfma_f32_16x16x32_bf16 v[36:39], a[36:39], v[52:55], v[36:39]
    ds_read_b128 v[52:55], v9 offset:2048
    s_waitcnt lgkmcnt(2)
    v_mfma_f32_16x16x32_bf16 v[24:27], a[48:51], v[56:59], v[24:27]
    v_mfma_f32_16x16x32_bf16 v[28:31], a[52:55], v[56:59], v[28:31]
    s_lshl_b32 s70, s64, 6
    v_mfma_f32_16x16x32_bf16 v[32:35], a[56:59], v[56:59], v[32:35]
    s_add_u32 s71, s70, 0x10000
    v_mfma_f32_16x16x32_bf16 v[36:39], a[60:63], v[56:59], v[36:39]
    ds_read_b128 v[56:59], v9 offset:2560
    s_waitcnt lgkmcnt(2)
    v_mfma_f32_16x16x32_bf16 v[24:27], a[72:75], v[48:51], v[24:27]
    v_mfma_f32_16x16x32_bf16 v[28:31], a[76:79], v[48:51], v[28:31]
    buffer_load_dwordx2 v[68:69], v11, s[52:55], s70 offen
    v_mfma_f32_16x16x32_bf16 v[32:35], a[80:83], v[48:51], v[32:35]
    buffer_load_dwordx2 v[70:71], v11, s[52:55], s70 offen offset:32
    v_mfma_f32_16x16x32_bf16 v[36:39], a[84:87], v[48:51], v[36:39]
    ds_read_b128 v[48:51], v9 offset:3072
    s_waitcnt lgkmcnt(2)
    v_mfma_f32_16x16x32_bf16 v[24:27], a[96:99], v[52:55], v[24:27]
    v_mfma_f32_16x16x32_bf16 v[28:31], a[100:103], v[52:55], v[28:31]
    buffer_load_dwordx2 v[72:73], v11, s[52:55], s71 offen
    v_mfma_f32_16x16x32_bf16 v[32:35], a[104:107], v[52:55], v[32:35]
    buffer_load_dwordx2 v[74:75], v11, s[52:55], s71 offen offset:32
    v_mfma_f32_16x16x32_bf16 v[36:39], a[108:111], v[52:55], v[36:39]
    ds_read_b128 v[52:55], v9 offset:3584
    s_waitcnt lgkmcnt(2)
    v_mfma_f32_16x16x32_bf16 v[24:27], a[120:123], v[56:59], v[24:27]
    v_mfma_f32_16x16x32_bf16 v[28:31], a[124:127], v[56:59], v[28:31]
    s_add_u32 s70, s64, 1
    v_mfma_f32_16x16x32_bf16 v[32:35], a[128:131], v[56:59], v[32:35]
    s_min_u32 s70, s70, 63
    v_mfma_f32_16x16x32_bf16 v[36:39], a[132:135], v[56:59], v[36:39]
    ds_read_b128 v[56:59], v9 offset:4096
    s_waitcnt lgkmcnt(2)
    v_mfma_f32_16x16x32_bf16 v[24:27], a[144:147], v[48:51], v[24:27]
    v_mfma_f32_16x16x32_bf16 v[28:31], a[148:151], v[48:51], v[28:31]
    s_lshl_b32 s70, s70, s76
    v_mfma_f32_16x16x32_bf16 v[32:35], a[152:155], v[48:51], v[32:35]
    buffer_load_dword v22, v4, s[48:51], s70 offen
    v_mfma_f32_16x16x32_bf16 v[36:39], a[156:159], v[48:51], v[36:39]
    ds_read_b128 v[48:51], v9 offset:4608
    s_waitcnt lgkmcnt(2)
    v_mfma_f32_16x16x32_bf16 v[24:27], a[168:171], v[52:55], v[24:27]
    v_mfma_f32_16x16x32_bf16 v[28:31], a[172:175], v[52:55], v[28:31]
    v_mfma_f32_16x16x32_bf16 v[32:35], a[176:179], v[52:55], v[32:35]
    v_mfma_f32_16x16x32_bf16 v[36:39], a[180:183], v[52:55], v[36:39]
    ds_read_b128 v[52:55], v9 offset:5120
    s_waitcnt lgkmcnt(2)
    v_mfma_f32_16x16x32_bf16 v[24:27], a[192:195], v[56:59], v[24:27]
    v_mfma_f32_16x16x32_bf16 v[28:31], a[196:199], v[56:59], v[28:31]
    v_mfma_f32_16x16x32_bf16 v[32:35], a[200:203], v[56:59], v[32:35]
    v_mfma_f32_16x16x32_bf16 v[36:39], a[204:207], v[56:59], v[36:39]
    ds_read_b128 v[56:59], v9 offset:5632
    s_waitcnt lgkmcnt(2)
    v_mfma_f32_16x16x32_bf16 v[24:27], a[216:219], v[48:51], v[24:27]
    v_mfma_f32_16x16x32_bf16 v[28:31], a[220:223], v[48:51], v[28:31]
    v_mfma_f32_16x16x32_bf16 v[32:35], a[224:227], v[48:51], v[32:35]
    v_mfma_f32_16x16x32_bf16 v[36:39], a[228:231], v[48:51], v[36:39]
    ds_read_b128 v[48:51], v9 offset:6144
    s_waitcnt lgkmcnt(2)
    v_mfma_f32_16x16x32_bf16 v[24:27], a[240:243], v[52:55], v[24:27]
    v_mfma_f32_16x16x32_bf16 v[28:31], a[244:247], v[52:55], v[28:31]
    v_mfma_f32_16x16x32_bf16 v[32:35], a[248:251], v[52:55], v[32:35]
    v_mfma_f32_16x16x32_bf16 v[36:39], a[252:255], v[52:55], v[36:39]
    ds_read_b128 v[52:55], v9 offset:6656
    s_waitcnt lgkmcnt(2)
    v_mfma_f32_16x16x32_bf16 v[24:27], v[88:91], v[56:59], v[24:27]
    v_mfma_f32_16x16x32_bf16 v[28:31], v[92:95], v[56:59], v[28:31]
    v_mfma_f32_16x16x32_bf16 v[32:35], v[96:99], v[56:59], v[32:35]
    v_mfma_f32_16x16x32_bf16 v[36:39], v[100:103], v[56:59], v[36:39]
    ds_read_b128 v[56:59], v9 offset:7168
    s_waitcnt lgkmcnt(2)
    v_mfma_f32_16x16x32_bf16 v[24:27], v[112:115], v[48:51], v[24:27]
    v_mfma_f32_16x16x32_bf16 v[28:31], v[116:119], v[48:51], v[28:31]
    v_mfma_f32_16x16x32_bf16 v[32:35], v[120:123], v[48:51], v[32:35]
    v_mfma_f32_16x16x32_bf16 v[36:39], v[124:127], v[48:51], v[36:39]
    ds_read_b128 v[48:51], v9 offset:7680
    s_waitcnt lgkmcnt(2)
    v_mfma_f32_16x16x32_bf16 v[24:27], v[136:139], v[52:55], v[24:27]
    v_mfma_f32_16x16x32_bf16 v[28:31], v[140:143], v[52:55], v[28:31]
    v_mfma_f32_16x16x32_bf16 v[32:35], v[144:147], v[52:55], v[32:35]
    v_mfma_f32_16x16x32_bf16 v[36:39], v[148:151], v[52:55], v[36:39]
    ds_read_b128 v[52:55], v9 offset:8192
    s_waitcnt lgkmcnt(2)
    v_mfma_f32_16x16x32_bf16 v[24:27], v[160:163], v[56:59], v[24:27]
    v_mfma_f32_16x16x32_bf16 v[28:31], v[164:167], v[56:59], v[28:31]
    v_mfma_f32_16x16x32_bf16 v[32:35], v[168:171], v[56:59], v[32:35]
    v_mfma_f32_16x16x32_bf16 v[36:39], v[172:175], v[56:59], v[36:39]
    ds_read_b128 v[56:59], v9 offset:8704
    s_waitcnt lgkmcnt(2)
    v_mfma_f32_16x16x32_bf16 v[24:27], v[184:187], v[48:51], v[24:27]
    v_mfma_f32_16x16x32_bf16 v[28:31], v[188:191], v[48:51], v[28:31]
    v_mfma_f32_16x16x32_bf16 v[32:35], v[192:195], v[48:51], v[32:35]
    v_mfma_f32_16x16x32_bf16 v[36:39], v[196:199], v[48:51], v[36:39]
    ds_read_b128 v[48:51], v9 offset:0
    s_waitcnt lgkmcnt(2)
    v_mfma_f32_16x16x32_bf16 v[24:27], v[208:211], v[52:55], v[24:27]
    v_mfma_f32_16x16x32_bf16 v[28:31], v[212:215], v[52:55], v[28:31]
    v_mfma_f32_16x16x32_bf16 v[32:35], v[216:219], v[52:55], v[32:35]
    v_mfma_f32_16x16x32_bf16 v[36:39], v[220:223], v[52:55], v[36:39]
    ds_read_b128 v[52:55], v9 offset:512
    s_waitcnt lgkmcnt(2)
    v_mfma_f32_16x16x32_bf16 v[24:27], v[232:235], v[56:59], v[24:27]
    v_mfma_f32_16x16x32_bf16 v[28:31], v[236:239], v[56:59], v[28:31]
    v_mfma_f32_16x16x32_bf16 v[32:35], v[240:243], v[56:59], v[32:35]
    v_mfma_f32_16x16x32_bf16 v[36:39], v[244:247], v[56:59], v[36:39]
    ds_read_b128 v[56:59], v9 offset:1024
    s_waitcnt lgkmcnt(2)
    v_mfma_f32_16x16x32_bf16 v[40:43], v[48:51], a[16:19], 0
    v_mfma_f32_16x16x32_bf16 v[44:47], v[48:51], a[20:23], 0
    ds_read_b128 v[48:51], v9 offset:1536
    s_waitcnt lgkmcnt(2)
    v_mfma_f32_16x16x32_bf16 v[40:43], v[52:55], a[40:43], v[40:43]
    v_mfma_f32_16x16x32_bf16 v[44:47], v[52:55], a[44:47], v[44:47]
    s_waitcnt vmcnt(5)
    v_cvt_pk_bf16_f32 v24, v24, v25
    v_cvt_pk_bf16_f32 v25, v26, v27
    v_cvt_pk_bf16_f32 v26, v28, v29
    v_cvt_pk_bf16_f32 v27, v30, v31
    v_cvt_pk_bf16_f32 v32, v32, v33
    v_cvt_pk_bf16_f32 v33, v34, v35
    v_cvt_pk_bf16_f32 v34, v36, v37
    v_cvt_pk_bf16_f32 v35, v38, v39
    v_mfma_f32_16x16x32_bf16 v[36:39], v[60:63], v[24:27], 0
    v_mfma_f32_16x16x32_bf16 v[76:79], v[64:67], v[24:27], 0
    v_mfma_f32_16x16x32_bf16 v[28:31], v[32:35], v[24:27], 0
    ds_read_b128 v[52:55], v9 offset:2048
    s_waitcnt lgkmcnt(2)
    v_mfma_f32_16x16x32_bf16 v[40:43], v[56:59], a[64:67], v[40:43]
    buffer_store_dwordx2 v[32:33], v20, s[56:59], s65 offen sc1
    v_mfma_f32_16x16x32_bf16 v[44:47], v[56:59], a[68:71], v[44:47]
    buffer_store_dwordx2 v[34:35], v20, s[56:59], s65 offen offset:32 sc1
    ds_read_b128 v[56:59], v9 offset:2560
    s_waitcnt lgkmcnt(2)
    v_mfma_f32_16x16x32_bf16 v[40:43], v[48:51], a[88:91], v[40:43]
    v_mfma_f32_16x16x32_bf16 v[44:47], v[48:51], a[92:95], v[44:47]
    v_mov_b32 v60, s64
    v_mov_b32 v61, 0
    s_mov_b32 exec_lo, 1
    s_mov_b32 exec_hi, 0
    global_store_dword v61, v60, s[78:79] sc1
    s_mov_b64 exec, -1
    ds_write_b128 v12, v[36:39] offset:256
    ds_write_b128 v12, v[76:79] offset:768
    s_mov_b32 exec_hi, 0
    ds_write_b128 v12, v[28:31]
    s_mov_b64 exec, -1
    ds_read_b128 v[48:51], v9 offset:3072
    s_waitcnt lgkmcnt(5)
    v_mfma_f32_16x16x32_bf16 v[40:43], v[52:55], a[112:115], v[40:43]
    v_mfma_f32_16x16x32_bf16 v[44:47], v[52:55], a[116:119], v[44:47]
    s_waitcnt lgkmcnt(1)
    s_barrier
    ds_read_b128 v[28:31], v23 offset:0
    ds_read_b128 v[36:39], v13 offset:0
    ds_read_b128 v[24:27], v23 offset:1280
    ds_read_b128 v[32:35], v13 offset:1280
    ds_read_b128 v[60:63], v23 offset:2560
    ds_read_b128 v[64:67], v13 offset:2560
    ds_read_b128 v[52:55], v9 offset:3584
    v_mfma_f32_16x16x32_bf16 v[40:43], v[56:59], a[136:139], v[40:43]
    s_waitcnt lgkmcnt(3)
    v_add_f32 v28, v28, v24
    v_add_f32 v29, v29, v25
    v_mfma_f32_16x16x32_bf16 v[44:47], v[56:59], a[140:143], v[44:47]
    v_add_f32 v30, v30, v26
    v_add_f32 v31, v31, v27
    v_add_f32 v36, v36, v32
    ds_read_b128 v[56:59], v9 offset:4096
    v_mfma_f32_16x16x32_bf16 v[40:43], v[48:51], a[160:163], v[40:43]
    v_add_f32 v37, v37, v33
    v_add_f32 v38, v38, v34
    v_mfma_f32_16x16x32_bf16 v[44:47], v[48:51], a[164:167], v[44:47]
    v_add_f32 v39, v39, v35
    ds_read_b128 v[24:27], v23 offset:3840
    ds_read_b128 v[32:35], v13 offset:3840
    s_waitcnt lgkmcnt(4)
    ds_read_b128 v[48:51], v9 offset:4608
    s_waitcnt lgkmcnt(4)
    v_mfma_f32_16x16x32_bf16 v[40:43], v[52:55], a[184:187], v[40:43]
    v_add_f32 v28, v28, v60
    v_add_f32 v29, v29, v61
    v_add_f32 v30, v30, v62
    v_mfma_f32_16x16x32_bf16 v[44:47], v[52:55], a[188:191], v[44:47]
    v_add_f32 v31, v31, v63
    v_add_f32 v36, v36, v64
    v_add_f32 v37, v37, v65
    ds_read_b128 v[52:55], v9 offset:5120
    s_waitcnt lgkmcnt(4)
    v_mfma_f32_16x16x32_bf16 v[40:43], v[56:59], a[208:211], v[40:43]
    v_add_f32 v38, v38, v66
    v_add_f32 v39, v39, v67
    v_mfma_f32_16x16x32_bf16 v[44:47], v[56:59], a[212:215], v[44:47]
    s_waitcnt lgkmcnt(2)
    v_add_f32 v28, v28, v24
    v_add_f32 v29, v29, v25
    ds_read_b128 v[56:59], v9 offset:5632
    s_waitcnt lgkmcnt(2)
    v_mfma_f32_16x16x32_bf16 v[40:43], v[48:51], a[232:235], v[40:43]
    v_add_f32 v30, v30, v26
    v_add_f32 v31, v31, v27
    v_add_f32 v36, v36, v32
    v_mfma_f32_16x16x32_bf16 v[44:47], v[48:51], a[236:239], v[44:47]
    v_add_f32 v37, v37, v33
    v_add_f32 v38, v38, v34
    v_add_f32 v39, v39, v35
    ds_read_b128 v[48:51], v9 offset:6144
    s_waitcnt lgkmcnt(2)
    v_mfma_f32_16x16x32_bf16 v[40:43], v[52:55], v[80:83], v[40:43]
    v_mov_b32 v24, s74
    v_cndmask_b32 v28, v28, v24, s[72:73]
    v_mfma_f32_16x16x32_bf16 v[44:47], v[52:55], v[84:87], v[44:47]
    v_cndmask_b32 v29, v29, v24, s[72:73]
    v_cndmask_b32 v30, v30, v24, s[72:73]
    v_cndmask_b32 v31, v31, v24, s[72:73]
    ds_read_b128 v[52:55], v9 offset:6656
    s_waitcnt lgkmcnt(2)
    v_mfma_f32_16x16x32_bf16 v[40:43], v[56:59], v[104:107], v[40:43]
    v_max3_f32 v25, v36, v37, v38
    v_max3_f32 v26, v39, v28, v29
    v_max3_f32 v25, v25, v30, v31
    v_mfma_f32_16x16x32_bf16 v[44:47], v[56:59], v[108:111], v[44:47]
    v_max_f32 v25, v25, v26
    s_nop 1
    v_max_f32_dpp v25, v25, v25 row_ror:8 row_mask:0xf bank_mask:0xf
    ds_read_b128 v[56:59], v9 offset:7168
    s_waitcnt lgkmcnt(2)
    v_mfma_f32_16x16x32_bf16 v[40:43], v[48:51], v[128:131], v[40:43]
    v_mov_b32 v26, v25
    s_nop 1
    v_permlane16_swap_b32 v25, v26
    v_mfma_f32_16x16x32_bf16 v[44:47], v[48:51], v[132:135], v[44:47]
    s_nop 0
    v_max_f32 v25, v25, v26
    ds_read_b128 v[48:51], v9 offset:7680
    s_waitcnt lgkmcnt(2)
    v_mfma_f32_16x16x32_bf16 v[40:43], v[52:55], v[152:155], v[40:43]
    v_mov_b32 v26, v25
    s_nop 1
    v_permlane32_swap_b32 v25, v26
    v_mfma_f32_16x16x32_bf16 v[44:47], v[52:55], v[156:159], v[44:47]
    s_nop 0
    v_max_f32 v25, v25, v26
    v_mul_f32 v26, s68, v25
    ds_read_b128 v[52:55], v9 offset:8192
    s_waitcnt lgkmcnt(2)
    v_mfma_f32_16x16x32_bf16 v[40:43], v[56:59], v[176:179], v[40:43]
    v_fma_f32 v36, v36, s68, -v26
    v_fma_f32 v37, v37, s68, -v26
    v_fma_f32 v38, v38, s68, -v26
    v_mfma_f32_16x16x32_bf16 v[44:47], v[56:59], v[180:183], v[44:47]
    v_fma_f32 v39, v39, s68, -v26
    v_fma_f32 v28, v28, s68, -v26
    ds_read_b128 v[56:59], v9 offset:8704
    s_waitcnt lgkmcnt(2)
    v_mfma_f32_16x16x32_bf16 v[40:43], v[48:51], v[200:203], v[40:43]
    v_fma_f32 v29, v29, s68, -v26
    v_fma_f32 v30, v30, s68, -v26
    v_fma_f32 v31, v31, s68, -v26
    v_mfma_f32_16x16x32_bf16 v[44:47], v[48:51], v[204:207], v[44:47]
    v_exp_f32 v36, v36
    v_exp_f32 v37, v37
    v_exp_f32 v38, v38
    s_waitcnt lgkmcnt(1)
    v_mfma_f32_16x16x32_bf16 v[40:43], v[52:55], v[224:227], v[40:43]
    v_exp_f32 v39, v39
    v_exp_f32 v28, v28
    v_exp_f32 v29, v29
    v_mfma_f32_16x16x32_bf16 v[44:47], v[52:55], v[228:231], v[44:47]
    v_exp_f32 v30, v30
    v_exp_f32 v31, v31
    s_waitcnt lgkmcnt(0)
    v_mfma_f32_16x16x32_bf16 v[40:43], v[56:59], v[248:251], v[40:43]
    v_cvt_pk_bf16_f32 v60, v36, v37
    v_cvt_pk_bf16_f32 v61, v38, v39
    v_cvt_pk_bf16_f32 v32, v28, v29
    v_mfma_f32_16x16x32_bf16 v[44:47], v[56:59], v[252:255], v[44:47]
    v_cvt_pk_bf16_f32 v33, v30, v31
    v_mov_b32_dpp v62, v60 row_ror:8 row_mask:0xf bank_mask:0xf
    v_mov_b32_dpp v63, v61 row_ror:8 row_mask:0xf bank_mask:0xf
    s_waitcnt vmcnt(4)
    v_add_f32 v24, v28, v29
    v_add_f32 v25, v30, v31
    v_mfma_f32_16x16x32_bf16 v[48:51], v[68:71], v[60:63], 0
    v_add_f32 v26, v36, v37
    v_add_f32 v27, v38, v39
    v_mfma_f32_16x16x32_bf16 v[52:55], v[72:75], v[60:63], 0
    v_add_f32 v24, v24, v26
    v_add_f32 v25, v25, v27
    v_cvt_pk_bf16_f32 v40, v40, v41
    v_cvt_pk_bf16_f32 v41, v42, v43
    v_cvt_pk_bf16_f32 v44, v44, v45
    v_cvt_pk_bf16_f32 v45, v46, v47
    v_add_f32 v24, v24, v25
    s_nop 1
    v_add_f32_dpp v24, v24, v24 row_ror:8 row_mask:0xf bank_mask:0xf
    v_mov_b32 v25, v24
    s_mov_b32 exec_hi, 0
    buffer_store_dwordx2 v[40:41], v21, s[60:63], s65 offen sc1
    buffer_store_dwordx2 v[44:45], v21, s[60:63], s65 offen offset:256 sc1
    s_mov_b64 exec, -1
    s_cmp_eq_u32 s64, 63
    s_cbranch_scc1 CF_exit
    v_permlane16_swap_b32 v24, v25
    v_mfma_f32_16x16x16_bf16 v[48:51], v[40:41], v[32:33], v[48:51]
    v_mfma_f32_16x16x16_bf16 v[52:55], v[44:45], v[32:33], v[52:55]
    v_add_f32 v24, v24, v25
    v_mov_b32 v25, v24
    ds_read_b128 v[64:67], v16 offset:0
    ds_read_b128 v[68:71], v16 offset:1024
    v_permlane32_swap_b32 v24, v25
    ds_read_b128 v[72:75], v16 offset:2048
    ds_read_b128 v[76:79], v16 offset:3072
    v_add_f32 v24, v24, v25
    v_rcp_f32 v24, v24
    s_and_b32 s65, s64, 1
    s_mul_i32 s65, s65, 294912
    v_mov_b32 v25, v24
    s_nop 0
    v_pk_mul_f32 v[48:49], v[48:49], v[24:25]
    v_pk_mul_f32 v[50:51], v[50:51], v[24:25]
    v_pk_mul_f32 v[52:53], v[52:53], v[24:25]
    v_pk_mul_f32 v[54:55], v[54:55], v[24:25]
    v_cvt_pk_bf16_f32 v48, v48, v49
    v_cvt_pk_bf16_f32 v49, v50, v51
    v_cvt_pk_bf16_f32 v52, v52, v53
    v_cvt_pk_bf16_f32 v53, v54, v55
    s_mov_b32 exec_lo, 0x00ff00ff
    s_mov_b32 exec_hi, 0x00ff00ff
    ds_write_b64 v14, v[48:49]
    ds_write_b64 v14, v[52:53] offset:256
    s_mov_b64 exec, -1
    ds_read_b128 v[28:31], v16 offset:4096
    ds_read_b128 v[56:59], v16 offset:5120
    s_waitcnt lgkmcnt(2)
    s_barrier
    ds_read_b128 v[40:43], v15 offset:0
    ds_read_b128 v[44:47], v15 offset:512
    ds_read_b128 v[48:51], v15 offset:1024
    ds_read_b128 v[52:55], v15 offset:1536
    s_waitcnt vmcnt(5)
    v_add_u32 v22, s80, v16
    s_waitcnt lgkmcnt(0)
    v_mfma_f32_16x16x32_bf16 v[32:35], v[64:67], v[40:43], 0
    ds_read_b128 v[64:67], v16 offset:6144
    v_mfma_f32_16x16x32_bf16 v[32:35], v[68:71], v[44:47], v[32:35]
    ds_read_b128 v[68:71], v16 offset:7168
    v_mfma_f32_16x16x32_bf16 v[32:35], v[72:75], v[48:51], v[32:35]
    ds_read_b128 v[72:75], v16 offset:8192
    v_mfma_f32_16x16x32_bf16 v[32:35], v[76:79], v[52:55], v[32:35]
    ds_read_b128 v[76:79], v16 offset:9216
    v_mfma_f32_16x16x32_bf16 v[60:63], v[28:31], v[40:43], 0
    ds_read_b128 v[28:31], v16 offset:10240
    v_mfma_f32_16x16x32_bf16 v[60:63], v[56:59], v[44:47], v[60:63]
    ds_read_b128 v[56:59], v16 offset:11264
    s_waitcnt lgkmcnt(5)
    v_mfma_f32_16x16x32_bf16 v[60:63], v[64:67], v[48:51], v[60:63]
    ds_read_b128 v[64:67], v16 offset:12288
    s_waitcnt lgkmcnt(5)
    v_mfma_f32_16x16x32_bf16 v[60:63], v[68:71], v[52:55], v[60:63]
    ds_read_b128 v[68:71], v16 offset:13312
    s_waitcnt lgkmcnt(5)
    v_mfma_f32_16x16x32_bf16 v[36:39], v[72:75], v[40:43], 0
    ds_read_b128 v[72:75], v16 offset:14336
    s_waitcnt lgkmcnt(5)
    v_mfma_f32_16x16x32_bf16 v[36:39], v[76:79], v[44:47], v[36:39]
    ds_read_b128 v[76:79], v16 offset:15360
    s_waitcnt lgkmcnt(5)
    v_mfma_f32_16x16x32_bf16 v[36:39], v[28:31], v[48:51], v[36:39]
    ds_read_b128 v[28:31], v16 offset:16384
    s_waitcnt lgkmcnt(5)
    v_mfma_f32_16x16x32_bf16 v[36:39], v[56:59], v[52:55], v[36:39]
    ds_read_b128 v[56:59], v16 offset:17408
    v_cvt_pk_bf16_f32 v32, v32, v33
    s_waitcnt lgkmcnt(5)
    v_mfma_f32_16x16x32_bf16 v[24:27], v[64:67], v[40:43], 0
    ds_read_b128 v[64:67], v16 offset:18432
    v_cvt_pk_bf16_f32 v33, v34, v35
    v_cvt_pk_bf16_f32 v34, v60, v61
    s_waitcnt lgkmcnt(5)
    v_mfma_f32_16x16x32_bf16 v[24:27], v[68:71], v[44:47], v[24:27]
    ds_read_b128 v[68:71], v16 offset:19456
    v_cvt_pk_bf16_f32 v35, v62, v63
    s_waitcnt lgkmcnt(5)
    v_mfma_f32_16x16x32_bf16 v[24:27], v[72:75], v[48:51], v[24:27]
    ds_read_b128 v[72:75], v16 offset:20480
    buffer_store_dwordx4 v[32:35], v17, s[44:47], s65 offen
    s_waitcnt lgkmcnt(5)
    v_mfma_f32_16x16x32_bf16 v[24:27], v[76:79], v[52:55], v[24:27]
    ds_read_b128 v[76:79], v16 offset:21504
    s_add_u32 s65, s65, 16384
    s_waitcnt lgkmcnt(5)
    v_mfma_f32_16x16x32_bf16 v[32:35], v[28:31], v[40:43], 0
    ds_read_b128 v[28:31], v16 offset:22528
    s_waitcnt lgkmcnt(5)
    v_mfma_f32_16x16x32_bf16 v[32:35], v[56:59], v[44:47], v[32:35]
    ds_read_b128 v[56:59], v16 offset:23552
    s_waitcnt lgkmcnt(5)
    v_mfma_f32_16x16x32_bf16 v[32:35], v[64:67], v[48:51], v[32:35]
    ds_read_b128 v[64:67], v16 offset:24576
    s_waitcnt lgkmcnt(5)
    v_mfma_f32_16x16x32_bf16 v[32:35], v[68:71], v[52:55], v[32:35]
    ds_read_b128 v[68:71], v16 offset:25600
    v_cvt_pk_bf16_f32 v36, v36, v37
    s_waitcnt lgkmcnt(5)
    v_mfma_f32_16x16x32_bf16 v[60:63], v[72:75], v[40:43], 0
    ds_read_b128 v[72:75], v16 offset:26624
    v_cvt_pk_bf16_f32 v37, v38, v39
    v_cvt_pk_bf16_f32 v38, v24, v25
    s_waitcnt lgkmcnt(5)
    v_mfma_f32_16x16x32_bf16 v[60:63], v[76:79], v[44:47], v[60:63]
    ds_read_b128 v[76:79], v16 offset:27648
    v_cvt_pk_bf16_f32 v39, v26, v27
    s_waitcnt lgkmcnt(5)
    v_mfma_f32_16x16x32_bf16 v[60:63], v[28:31], v[48:51], v[60:63]
    ds_read_b128 v[28:31], v16 offset:28672
    buffer_store_dwordx4 v[36:39], v17, s[44:47], s65 offen
    s_waitcnt lgkmcnt(5)
    v_mfma_f32_16x16x32_bf16 v[60:63], v[56:59], v[52:55], v[60:63]
    ds_read_b128 v[56:59], v16 offset:29696
    s_add_u32 s65, s65, 16384
    s_waitcnt lgkmcnt(5)
    v_mfma_f32_16x16x32_bf16 v[36:39], v[64:67], v[40:43], 0
    ds_read_b128 v[64:67], v16 offset:30720
    s_waitcnt lgkmcnt(5)
    v_mfma_f32_16x16x32_bf16 v[36:39], v[68:71], v[44:47], v[36:39]
    ds_read_b128 v[68:71], v16 offset:31744
    s_waitcnt lgkmcnt(5)
    v_mfma_f32_16x16x32_bf16 v[36:39], v[72:75], v[48:51], v[36:39]
    ds_read_b128 v[72:75], v22 offset:0
    s_waitcnt lgkmcnt(5)
    v_mfma_f32_16x16x32_bf16 v[36:39], v[76:79], v[52:55], v[36:39]
    ds_read_b128 v[76:79], v22 offset:1024
    v_cvt_pk_bf16_f32 v32, v32, v33
    s_waitcnt lgkmcnt(5)
    v_mfma_f32_16x16x32_bf16 v[24:27], v[28:31], v[40:43], 0
    ds_read_b128 v[28:31], v22 offset:2048
    v_cvt_pk_bf16_f32 v33, v34, v35
    v_cvt_pk_bf16_f32 v34, v60, v61
    s_waitcnt lgkmcnt(5)
    v_mfma_f32_16x16x32_bf16 v[24:27], v[56:59], v[44:47], v[24:27]
    ds_read_b128 v[56:59], v22 offset:3072
    v_cvt_pk_bf16_f32 v35, v62, v63
    s_waitcnt lgkmcnt(5)
    v_mfma_f32_16x16x32_bf16 v[24:27], v[64:67], v[48:51], v[24:27]
    buffer_store_dwordx4 v[32:35], v17, s[44:47], s65 offen
    s_waitcnt lgkmcnt(4)
    v_mfma_f32_16x16x32_bf16 v[24:27], v[68:71], v[52:55], v[24:27]
    s_add_u32 s65, s65, 16384
    s_waitcnt lgkmcnt(3)
    v_mfma_f32_16x16x32_bf16 v[32:35], v[72:75], v[40:43], 0
    s_waitcnt lgkmcnt(2)
    v_mfma_f32_16x16x32_bf16 v[32:35], v[76:79], v[44:47], v[32:35]
    s_waitcnt lgkmcnt(1)
    v_mfma_f32_16x16x32_bf16 v[32:35], v[28:31], v[48:51], v[32:35]
    s_nop 2
    s_waitcnt lgkmcnt(0)
    v_mfma_f32_16x16x32_bf16 v[32:35], v[56:59], v[52:55], v[32:35]
    v_cvt_pk_bf16_f32 v36, v36, v37
    v_cvt_pk_bf16_f32 v37, v38, v39
    v_cvt_pk_bf16_f32 v38, v24, v25
    v_cvt_pk_bf16_f32 v39, v26, v27
    buffer_store_dwordx4 v[36:39], v17, s[44:47], s65 offen
    s_add_u32 s65, s65, 16384
    v_add_u32 v22, s81, v17
    s_nop 3
    v_cvt_pk_bf16_f32 v32, v32, v33
    v_cvt_pk_bf16_f32 v33, v34, v35
    buffer_store_dwordx2 v[32:33], v22, s[44:47], s65 offen
    s_cmp_eq_u32 s39, -1
    s_cbranch_scc1 CF_nored
    s_and_b32 s65, s64, 1
    s_mul_i32 s65, s65, 72
    s_add_u32 s65, s65, s39
    s_lshl_b32 s65, s65, 12
    s_add_u32 s70, s64, 1
    s_mul_i32 s70, s70, 9216
    s_add_u32 s70, s70, s77
    s_mov_b32 s67, 0
CF_pollr:
    buffer_load_dwordx4 v[24:27], v18, s[44:47], s65 offen offset:0 sc1
    buffer_load_dwordx4 v[28:31], v18, s[44:47], s65 offen offset:1024 sc1
    buffer_load_dwordx4 v[32:35], v18, s[44:47], s65 offen offset:2048 sc1
    buffer_load_dwordx4 v[36:39], v18, s[44:47], s65 offen offset:3072 sc1
    s_add_u32 s67, s67, 1
    s_waitcnt vmcnt(0)
    v_mfma_f32_16x16x32_bf16 v[40:43], v[0:3], v[24:27], 0
    v_mfma_f32_16x16x32_bf16 v[40:43], v[0:3], v[28:31], v[40:43]
    v_mfma_f32_16x16x32_bf16 v[40:43], v[0:3], v[32:35], v[40:43]
    v_mfma_f32_16x16x32_bf16 v[40:43], v[0:3], v[36:39], v[40:43]
    v_max3_u32 v76, v24, v25, v26
    v_max3_u32 v77, v27, v28, v29
    v_max3_u32 v78, v30, v31, v32
    v_max3_u32 v79, v33, v34, v35
    v_max3_u32 v76, v76, v36, v37
    v_max3_u32 v77, v77, v38, v39
    v_max3_u32 v76, v76, v77, v78
    v_max_u32 v76, v76, v79
    v_cmp_eq_u32 vcc, -1, v76
    s_cmp_ge_u32 s67, 0x100000
    s_cbranch_scc1 CF_pr_done
    s_cbranch_vccnz CF_pollr
CF_pr_done:
    v_add_f32_dpp v40, v40, v40 row_ror:8 row_mask:0xf bank_mask:0xf
    v_add_f32_dpp v41, v41, v41 row_ror:8 row_mask:0xf bank_mask:0xf
    v_add_f32_dpp v42, v42, v42 row_ror:8 row_mask:0xf bank_mask:0xf
    v_add_f32_dpp v43, v43, v43 row_ror:8 row_mask:0xf bank_mask:0xf
    v_cvt_pk_bf16_f32 v40, v40, v41
    v_cvt_pk_bf16_f32 v41, v42, v43
    s_mov_b32 exec_lo, 0x00ff00ff
    s_mov_b32 exec_hi, 0
    buffer_store_dwordx2 v[40:41], v19, s[40:43], s70 offen
    s_mov_b64 exec, -1
    v_mov_b32 v76, -1
    v_mov_b32 v77, -1
    v_mov_b32 v78, -1
    v_mov_b32 v79, -1
    buffer_store_dwordx4 v[76:79], v18, s[44:47], s65 offen offset:0
    buffer_store_dwordx4 v[76:79], v18, s[44:47], s65 offen offset:1024
    buffer_store_dwordx4 v[76:79], v18, s[44:47], s65 offen offset:2048
    buffer_store_dwordx4 v[76:79], v18, s[44:47], s65 offen offset:3072
CF_nored:
    s_add_u32 s64, s64, 1
    s_cmp_lt_u32 s64, 64
    s_cbranch_scc1 CF_top
CF_exit:
    s_branch KM_chain_end
KM_slow:
    s_mov_b32 s68, 0x3e0293ee
    s_mov_b32 s69, 0x3e0293ee
    s_mov_b32 s82, 0
CS_top:
    s_and_b32 s65, s64, 3
    s_cmp_eq_u32 s65, 3
    s_cselect_b32 s65, 1, 0
    s_cmp_eq_u32 s64, 0
    s_cselect_b32 s65, 1, s65
    s_andn2_b32 s65, s65, s82
    s_cmp_eq_u32 s65, 0
    s_cbranch_scc1 CS_kvok
    s_add_u32 s65, s64, 1
    s_min_u32 s65, s65, 63
    s_lshr_b32 s65, s65, 2
    s_lshl_b32 s65, s65, 2
    s_add_u32 s65, s65, 64
    v_mov_b32 v77, s65
    s_mov_b32 s67, 0
CS_kvw:
    global_load_dword v76, v77, s[32:33] sc1
    v_mov_b32 v78, 40
    global_load_dword v78, v78, s[32:33] sc1
    s_add_u32 s67, s67, 1
    s_waitcnt vmcnt(0)
    v_readfirstlane_b32 s66, v78
    s_cmp_ge_u32 s66, 224
    s_cselect_b32 s82, 1, 0
    v_cmp_gt_u32 vcc, 64, v76
    s_cmp_ge_u32 s67, 0x100000
    s_cbranch_scc1 CS_kvok
    s_cbranch_vccz CS_kvok
    s_sleep 4
    s_branch CS_kvw
CS_kvok:
    s_mul_i32 s65, s64, 9216
    s_mov_b32 s67, 0
CS_pollm:
    buffer_load_dwordx4 v[48:51], v5, s[40:43], s65 offen sc1
    buffer_load_dwordx4 v[52:55], v5, s[40:43], s65 offen offset:1024 sc1
    buffer_load_dwordx4 v[56:59], v6, s[40:43], s65 offen sc1
    s_add_u32 s67, s67, 1
    s_waitcnt vmcnt(0)
    v_max3_u32 v76, v48, v49, v50
    v_max3_u32 v77, v51, v52, v53
    v_max3_u32 v78, v54, v55, v56
    v_max3_u32 v79, v57, v58, v59
    v_max3_u32 v76, v76, v77, v78
    v_max_u32 v76, v76, v79
    v_cmp_eq_u32 vcc, -1, v76
    s_cmp_ge_u32 s67, 0x100000
    s_cbranch_scc1 CS_pm_done
    s_cbranch_vccnz CS_pollm
CS_pm_done:
    ds_write_b128 v7, v[48:51]
    ds_write_b128 v7, v[52:55] offset:1024
    ds_write_b128 v8, v[56:59]
    s_lshl_b32 s70, s64, 18
    s_add_u32 s71, s70, 0x20000
    s_lshl_b32 s65, s64, 16
    s_waitcnt lgkmcnt(0)
    s_barrier
    ds_read_b128 v[48:51], v9 offset:0
    ds_read_b128 v[52:55], v9 offset:512
    ds_read_b128 v[56:59], v9 offset:1024
    s_waitcnt lgkmcnt(2)
    v_mfma_f32_16x16x32_bf16 v[24:27], a[0:3], v[48:51], 0
    v_mfma_f32_16x16x32_bf16 v[28:31], a[4:7], v[48:51], 0
    buffer_load_dwordx2 v[60:61], v10, s[48:51], s70 offen
    v_mfma_f32_16x16x32_bf16 v[32:35], a[8:11], v[48:51], 0
    buffer_load_dwordx2 v[62:63], v10, s[48:51], s70 offen offset:32
    v_mfma_f32_16x16x32_bf16 v[36:39], a[12:15], v[48:51], 0
    ds_read_b128 v[48:51], v9 offset:1536
    s_waitcnt lgkmcnt(2)
    v_mfma_f32_16x16x32_bf16 v[24:27], a[24:27], v[52:55], v[24:27]
    v_mfma_f32_16x16x32_bf16 v[28:31], a[28:31], v[52:55], v[28:31]
    buffer_load_dwordx2 v[64:65], v10, s[48:51], s71 offen
    v_mfma_f32_16x16x32_bf16 v[32:35], a[32:35], v[52:55], v[32:35]
    buffer_load_dwordx2 v[66:67], v10, s[48:51], s71 offen offset:32
    v_mfma_f32_16x16x32_bf16 v[36:39], a[36:39], v[52:55], v[36:39]
    ds_read_b128 v[52:55], v9 offset:2048
    s_waitcnt lgkmcnt(2)
    v_mfma_f32_16x16x32_bf16 v[24:27], a[48:51], v[56:59], v[24:27]
    v_mfma_f32_16x16x32_bf16 v[28:31], a[52:55], v[56:59], v[28:31]
    s_lshl_b32 s70, s64, 6
    v_mfma_f32_16x16x32_bf16 v[32:35], a[56:59], v[56:59], v[32:35]
    s_add_u32 s71, s70, 0x10000
    v_mfma_f32_16x16x32_bf16 v[36:39], a[60:63], v[56:59], v[36:39]
    ds_read_b128 v[56:59], v9 offset:2560
    s_waitcnt lgkmcnt(2)
    v_mfma_f32_16x16x32_bf16 v[24:27], a[72:75], v[48:51], v[24:27]
    v_mfma_f32_16x16x32_bf16 v[28:31], a[76:79], v[48:51], v[28:31]
    buffer_load_dwordx2 v[68:69], v11, s[52:55], s70 offen
    v_mfma_f32_16x16x32_bf16 v[32:35], a[80:83], v[48:51], v[32:35]
    buffer_load_dwordx2 v[70:71], v11, s[52:55], s70 offen offset:32
    v_mfma_f32_16x16x32_bf16 v[36:39], a[84:87], v[48:51], v[36:39]
    ds_read_b128 v[48:51], v9 offset:3072
    s_waitcnt lgkmcnt(2)
    v_mfma_f32_16x16x32_bf16 v[24:27], a[96:99], v[52:55], v[24:27]
    v_mfma_f32_16x16x32_bf16 v[28:31], a[100:103], v[52:55], v[28:31]
    buffer_load_dwordx2 v[72:73], v11, s[52:55], s71 offen
    v_mfma_f32_16x16x32_bf16 v[32:35], a[104:107], v[52:55], v[32:35]
    buffer_load_dwordx2 v[74:75], v11, s[52:55], s71 offen offset:32
    v_mfma_f32_16x16x32_bf16 v[36:39], a[108:111], v[52:55], v[36:39]
    ds_read_b128 v[52:55], v9 offset:3584
    s_waitcnt lgkmcnt(2)
    v_mfma_f32_16x16x32_bf16 v[24:27], a[120:123], v[56:59], v[24:27]
    v_mfma_f32_16x16x32_bf16 v[28:31], a[124:127], v[56:59], v[28:31]
    s_add_u32 s70, s64, 1
    v_mfma_f32_16x16x32_bf16 v[32:35], a[128:131], v[56:59], v[32:35]
    s_min_u32 s70, s70, 63
    v_mfma_f32_16x16x32_bf16 v[36:39], a[132:135], v[56:59], v[36:39]
    ds_read_b128 v[56:59], v9 offset:4096
    s_waitcnt lgkmcnt(2)
    v_mfma_f32_16x16x32_bf16 v[24:27], a[144:147], v[48:51], v[24:27]
    v_mfma_f32_16x16x32_bf16 v[28:31], a[148:151], v[48:51], v[28:31]
    s_lshl_b32 s70, s70, s76
    v_mfma_f32_16x16x32_bf16 v[32:35], a[152:155], v[48:51], v[32:35]
    buffer_load_dword v22, v4, s[48:51], s70 offen
    v_mfma_f32_16x16x32_bf16 v[36:39], a[156:159], v[48:51], v[36:39]
    ds_read_b128 v[48:51], v9 offset:4608
    s_waitcnt lgkmcnt(2)
    v_mfma_f32_16x16x32_bf16 v[24:27], a[168:171], v[52:55], v[24:27]
    v_mfma_f32_16x16x32_bf16 v[28:31], a[172:175], v[52:55], v[28:31]
    v_mfma_f32_16x16x32_bf16 v[32:35], a[176:179], v[52:55], v[32:35]
    v_mfma_f32_16x16x32_bf16 v[36:39], a[180:183], v[52:55], v[36:39]
    ds_read_b128 v[52:55], v9 offset:5120
    s_waitcnt lgkmcnt(2)
    v_mfma_f32_16x16x32_bf16 v[24:27], a[192:195], v[56:59], v[24:27]
    v_mfma_f32_16x16x32_bf16 v[28:31], a[196:199], v[56:59], v[28:31]
    v_mfma_f32_16x16x32_bf16 v[32:35], a[200:203], v[56:59], v[32:35]
    v_mfma_f32_16x16x32_bf16 v[36:39], a[204:207], v[56:59], v[36:39]
    ds_read_b128 v[56:59], v9 offset:5632
    s_waitcnt lgkmcnt(2)
    v_mfma_f32_16x16x32_bf16 v[24:27], a[216:219], v[48:51], v[24:27]
    v_mfma_f32_16x16x32_bf16 v[28:31], a[220:223], v[48:51], v[28:31]
    v_mfma_f32_16x16x32_bf16 v[32:35], a[224:227], v[48:51], v[32:35]
    v_mfma_f32_16x16x32_bf16 v[36:39], a[228:231], v[48:51], v[36:39]
    ds_read_b128 v[48:51], v9 offset:6144
    s_waitcnt lgkmcnt(2)
    v_mfma_f32_16x16x32_bf16 v[24:27], a[240:243], v[52:55], v[24:27]
    v_mfma_f32_16x16x32_bf16 v[28:31], a[244:247], v[52:55], v[28:31]
    v_mfma_f32_16x16x32_bf16 v[32:35], a[248:251], v[52:55], v[32:35]
    v_mfma_f32_16x16x32_bf16 v[36:39], a[252:255], v[52:55], v[36:39]
    ds_read_b128 v[52:55], v9 offset:6656
    s_waitcnt lgkmcnt(2)
    v_mfma_f32_16x16x32_bf16 v[24:27], v[88:91], v[56:59], v[24:27]
    v_mfma_f32_16x16x32_bf16 v[28:31], v[92:95], v[56:59], v[28:31]
    v_mfma_f32_16x16x32_bf16 v[32:35], v[96:99], v[56:59], v[32:35]
    v_mfma_f32_16x16x32_bf16 v[36:39], v[100:103], v[56:59], v[36:39]
    ds_read_b128 v[56:59], v9 offset:7168
    s_waitcnt lgkmcnt(2)
    v_mfma_f32_16x16x32_bf16 v[24:27], v[112:115], v[48:51], v[24:27]
    v_mfma_f32_16x16x32_bf16 v[28:31], v[116:119], v[48:51], v[28:31]
    v_mfma_f32_16x16x32_bf16 v[32:35], v[120:123], v[48:51], v[32:35]
    v_mfma_f32_16x16x32_bf16 v[36:39], v[124:127], v[48:51], v[36:39]
    ds_read_b128 v[48:51], v9 offset:7680
    s_waitcnt lgkmcnt(2)
    v_mfma_f32_16x16x32_bf16 v[24:27], v[136:139], v[52:55], v[24:27]
    v_mfma_f32_16x16x32_bf16 v[28:31], v[140:143], v[52:55], v[28:31]
    v_mfma_f32_16x16x32_bf16 v[32:35], v[144:147], v[52:55], v[32:35]
    v_mfma_f32_16x16x32_bf16 v[36:39], v[148:151], v[52:55], v[36:39]
    ds_read_b128 v[52:55], v9 offset:8192
    s_waitcnt lgkmcnt(2)
    v_mfma_f32_16x16x32_bf16 v[24:27], v[160:163], v[56:59], v[24:27]
    v_mfma_f32_16x16x32_bf16 v[28:31], v[164:167], v[56:59], v[28:31]
    v_mfma_f32_16x16x32_bf16 v[32:35], v[168:171], v[56:59], v[32:35]
    v_mfma_f32_16x16x32_bf16 v[36:39], v[172:175], v[56:59], v[36:39]
    ds_read_b128 v[56:59], v9 offset:8704
    s_waitcnt lgkmcnt(2)
    v_mfma_f32_16x16x32_bf16 v[24:27], v[184:187], v[48:51], v[24:27]
    v_mfma_f32_16x16x32_bf16 v[28:31], v[188:191], v[48:51], v[28:31]
    v_mfma_f32_16x16x32_bf16 v[32:35], v[192:195], v[48:51], v[32:35]
    v_mfma_f32_16x16x32_bf16 v[36:39], v[196:199], v[48:51], v[36:39]
    ds_read_b128 v[48:51], v9 offset:0
    s_waitcnt lgkmcnt(2)
    v_mfma_f32_16x16x32_bf16 v[24:27], v[208:211], v[52:55], v[24:27]
    v_mfma_f32_16x16x32_bf16 v[28:31], v[212:215], v[52:55], v[28:31]
    v_mfma_f32_16x16x32_bf16 v[32:35], v[216:219], v[52:55], v[32:35]
    v_mfma_f32_16x16x32_bf16 v[36:39], v[220:223], v[52:55], v[36:39]
    ds_read_b128 v[52:55], v9 offset:512
    s_waitcnt lgkmcnt(2)
    v_mfma_f32_16x16x32_bf16 v[24:27], v[232:235], v[56:59], v[24:27]
    v_mfma_f32_16x16x32_bf16 v[28:31], v[236:239], v[56:59], v[28:31]
    v_mfma_f32_16x16x32_bf16 v[32:35], v[240:243], v[56:59], v[32:35]
    v_mfma_f32_16x16x32_bf16 v[36:39], v[244:247], v[56:59], v[36:39]
    ds_read_b128 v[56:59], v9 offset:1024
    s_waitcnt lgkmcnt(2)
    v_mfma_f32_16x16x32_bf16 v[40:43], v[48:51], a[16:19], 0
    v_mfma_f32_16x16x32_bf16 v[44:47], v[48:51], a[20:23], 0
    ds_read_b128 v[48:51], v9 offset:1536
    s_waitcnt lgkmcnt(2)
    v_mfma_f32_16x16x32_bf16 v[40:43], v[52:55], a[40:43], v[40:43]
    v_mfma_f32_16x16x32_bf16 v[44:47], v[52:55], a[44:47], v[44:47]
    s_waitcnt vmcnt(5)
    v_cvt_pk_bf16_f32 v24, v24, v25
    v_cvt_pk_bf16_f32 v25, v26, v27
    v_cvt_pk_bf16_f32 v26, v28, v29
    v_cvt_pk_bf16_f32 v27, v30, v31
    v_cvt_pk_bf16_f32 v32, v32, v33
    v_cvt_pk_bf16_f32 v33, v34, v35
    v_cvt_pk_bf16_f32 v34, v36, v37
    v_cvt_pk_bf16_f32 v35, v38, v39
    v_mfma_f32_16x16x32_bf16 v[36:39], v[60:63], v[24:27], 0
    v_mfma_f32_16x16x32_bf16 v[76:79], v[64:67], v[24:27], 0
    v_mfma_f32_16x16x32_bf16 v[28:31], v[32:35], v[24:27], 0
    ds_read_b128 v[52:55], v9 offset:2048
    s_waitcnt lgkmcnt(2)
    v_mfma_f32_16x16x32_bf16 v[40:43], v[56:59], a[64:67], v[40:43]
    buffer_store_dwordx2 v[32:33], v20, s[56:59], s65 offen sc1
    v_mfma_f32_16x16x32_bf16 v[44:47], v[56:59], a[68:71], v[44:47]
    buffer_store_dwordx2 v[34:35], v20, s[56:59], s65 offen offset:32 sc1
    ds_read_b128 v[56:59], v9 offset:2560
    s_waitcnt lgkmcnt(2)
    v_mfma_f32_16x16x32_bf16 v[40:43], v[48:51], a[88:91], v[40:43]
    v_mfma_f32_16x16x32_bf16 v[44:47], v[48:51], a[92:95], v[44:47]
    v_mov_b32 v60, s64
    v_mov_b32 v61, 0
    s_mov_b32 exec_lo, 1
    s_mov_b32 exec_hi, 0
    global_store_dword v61, v60, s[78:79] sc1
    s_mov_b64 exec, -1
    ds_write_b128 v12, v[36:39] offset:256
    ds_write_b128 v12, v[76:79] offset:768
    s_mov_b32 exec_hi, 0
    ds_write_b128 v12, v[28:31]
    s_mov_b64 exec, -1
    ds_read_b128 v[48:51], v9 offset:3072
    s_waitcnt lgkmcnt(5)
    v_mfma_f32_16x16x32_bf16 v[40:43], v[52:55], a[112:115], v[40:43]
    v_mfma_f32_16x16x32_bf16 v[44:47], v[52:55], a[116:119], v[44:47]
    s_waitcnt lgkmcnt(1)
    s_barrier
    ds_read_b128 v[28:31], v23 offset:0
    ds_read_b128 v[36:39], v13 offset:0
    ds_read_b128 v[24:27], v23 offset:1280
    ds_read_b128 v[32:35], v13 offset:1280
    ds_read_b128 v[60:63], v23 offset:2560
    ds_read_b128 v[64:67], v13 offset:2560
    ds_read_b128 v[52:55], v9 offset:3584
    v_mfma_f32_16x16x32_bf16 v[40:43], v[56:59], a[136:139], v[40:43]
    s_waitcnt lgkmcnt(3)
    v_add_f32 v28, v28, v24
    v_add_f32 v29, v29, v25
    v_mfma_f32_16x16x32_bf16 v[44:47], v[56:59], a[140:143], v[44:47]
    v_add_f32 v30, v30, v26
    v_add_f32 v31, v31, v27
    v_add_f32 v36, v36, v32
    ds_read_b128 v[56:59], v9 offset:4096
    v_mfma_f32_16x16x32_bf16 v[40:43], v[48:51], a[160:163], v[40:43]
    v_add_f32 v37, v37, v33
    v_add_f32 v38, v38, v34
    v_mfma_f32_16x16x32_bf16 v[44:47], v[48:51], a[164:167], v[44:47]
    v_add_f32 v39, v39, v35
    ds_read_b128 v[24:27], v23 offset:3840
    ds_read_b128 v[32:35], v13 offset:3840
    s_waitcnt lgkmcnt(4)
    ds_read_b128 v[48:51], v9 offset:4608
    s_waitcnt lgkmcnt(4)
    v_mfma_f32_16x16x32_bf16 v[40:43], v[52:55], a[184:187], v[40:43]
    v_add_f32 v28, v28, v60
    v_add_f32 v29, v29, v61
    v_add_f32 v30, v30, v62
    v_mfma_f32_16x16x32_bf16 v[44:47], v[52:55], a[188:191], v[44:47]
    v_add_f32 v31, v31, v63
    v_add_f32 v36, v36, v64
    v_add_f32 v37, v37, v65
    ds_read_b128 v[52:55], v9 offset:5120
    s_waitcnt lgkmcnt(4)
    v_mfma_f32_16x16x32_bf16 v[40:43], v[56:59], a[208:211], v[40:43]
    v_add_f32 v38, v38, v66
    v_add_f32 v39, v39, v67
    v_mfma_f32_16x16x32_bf16 v[44:47], v[56:59], a[212:215], v[44:47]
    s_waitcnt lgkmcnt(2)
    v_add_f32 v28, v28, v24
    v_add_f32 v29, v29, v25
    ds_read_b128 v[56:59], v9 offset:5632
    s_waitcnt lgkmcnt(2)
    v_mfma_f32_16x16x32_bf16 v[40:43], v[48:51], a[232:235], v[40:43]
    v_add_f32 v30, v30, v26
    v_add_f32 v31, v31, v27
    v_add_f32 v36, v36, v32
    v_mfma_f32_16x16x32_bf16 v[44:47], v[48:51], a[236:239], v[44:47]
    v_add_f32 v37, v37, v33
    v_add_f32 v38, v38, v34
    v_add_f32 v39, v39, v35
    ds_read_b128 v[48:51], v9 offset:6144
    s_waitcnt lgkmcnt(2)
    v_mfma_f32_16x16x32_bf16 v[40:43], v[52:55], v[80:83], v[40:43]
    v_mov_b32 v24, s74
    v_cndmask_b32 v28, v28, v24, s[72:73]
    v_mfma_f32_16x16x32_bf16 v[44:47], v[52:55], v[84:87], v[44:47]
    v_cndmask_b32 v29, v29, v24, s[72:73]
    v_cndmask_b32 v30, v30, v24, s[72:73]
    v_cndmask_b32 v31, v31, v24, s[72:73]
    ds_read_b128 v[52:55], v9 offset:6656
    s_waitcnt lgkmcnt(2)
    v_mfma_f32_16x16x32_bf16 v[40:43], v[56:59], v[104:107], v[40:43]
    v_max3_f32 v25, v36, v37, v38
    v_max3_f32 v26, v39, v28, v29
    v_max3_f32 v25, v25, v30, v31
    v_mfma_f32_16x16x32_bf16 v[44:47], v[56:59], v[108:111], v[44:47]
    v_max_f32 v25, v25, v26
    s_nop 1
    v_max_f32_dpp v25, v25, v25 row_ror:8 row_mask:0xf bank_mask:0xf
    ds_read_b128 v[56:59], v9 offset:7168
    s_waitcnt lgkmcnt(2)
    v_mfma_f32_16x16x32_bf16 v[40:43], v[48:51], v[128:131], v[40:43]
    v_mov_b32 v26, v25
    s_nop 1
    v_permlane16_swap_b32 v25, v26
    v_mfma_f32_16x16x32_bf16 v[44:47], v[48:51], v[132:135], v[44:47]
    s_nop 0
    v_max_f32 v25, v25, v26
    ds_read_b128 v[48:51], v9 offset:7680
    s_waitcnt lgkmcnt(2)
    v_mfma_f32_16x16x32_bf16 v[40:43], v[52:55], v[152:155], v[40:43]
    v_mov_b32 v26, v25
    s_nop 1
    v_permlane32_swap_b32 v25, v26
    v_mfma_f32_16x16x32_bf16 v[44:47], v[52:55], v[156:159], v[44:47]
    s_nop 0
    v_max_f32 v25, v25, v26
    v_mul_f32 v26, s68, v25
    ds_read_b128 v[52:55], v9 offset:8192
    s_waitcnt lgkmcnt(2)
    v_mfma_f32_16x16x32_bf16 v[40:43], v[56:59], v[176:179], v[40:43]
    v_fma_f32 v36, v36, s68, -v26
    v_fma_f32 v37, v37, s68, -v26
    v_fma_f32 v38, v38, s68, -v26
    v_mfma_f32_16x16x32_bf16 v[44:47], v[56:59], v[180:183], v[44:47]
    v_fma_f32 v39, v39, s68, -v26
    v_fma_f32 v28, v28, s68, -v26
    ds_read_b128 v[56:59], v9 offset:8704
    s_waitcnt lgkmcnt(2)
    v_mfma_f32_16x16x32_bf16 v[40:43], v[48:51], v[200:203], v[40:43]
    v_fma_f32 v29, v29, s68, -v26
    v_fma_f32 v30, v30, s68, -v26
    v_fma_f32 v31, v31, s68, -v26
    v_mfma_f32_16x16x32_bf16 v[44:47], v[48:51], v[204:207], v[44:47]
    v_exp_f32 v36, v36
    v_exp_f32 v37, v37
    v_exp_f32 v38, v38
    s_waitcnt lgkmcnt(1)
    v_mfma_f32_16x16x32_bf16 v[40:43], v[52:55], v[224:227], v[40:43]
    v_exp_f32 v39, v39
    v_exp_f32 v28, v28
    v_exp_f32 v29, v29
    v_mfma_f32_16x16x32_bf16 v[44:47], v[52:55], v[228:231], v[44:47]
    v_exp_f32 v30, v30
    v_exp_f32 v31, v31
    s_waitcnt lgkmcnt(0)
    v_mfma_f32_16x16x32_bf16 v[40:43], v[56:59], v[248:251], v[40:43]
    v_cvt_pk_bf16_f32 v60, v36, v37
    v_cvt_pk_bf16_f32 v61, v38, v39
    v_cvt_pk_bf16_f32 v32, v28, v29
    v_mfma_f32_16x16x32_bf16 v[44:47], v[56:59], v[252:255], v[44:47]
    v_cvt_pk_bf16_f32 v33, v30, v31
    v_mov_b32_dpp v62, v60 row_ror:8 row_mask:0xf bank_mask:0xf
    v_mov_b32_dpp v63, v61 row_ror:8 row_mask:0xf bank_mask:0xf
    s_waitcnt vmcnt(4)
    v_add_f32 v24, v28, v29
    v_add_f32 v25, v30, v31
    v_mfma_f32_16x16x32_bf16 v[48:51], v[68:71], v[60:63], 0
    v_add_f32 v26, v36, v37
    v_add_f32 v27, v38, v39
    v_mfma_f32_16x16x32_bf16 v[52:55], v[72:75], v[60:63], 0
    v_add_f32 v24, v24, v26
    v_add_f32 v25, v25, v27
    v_cvt_pk_bf16_f32 v40, v40, v41
    v_cvt_pk_bf16_f32 v41, v42, v43
    v_cvt_pk_bf16_f32 v44, v44, v45
    v_cvt_pk_bf16_f32 v45, v46, v47
    v_add_f32 v24, v24, v25
    s_nop 1
    v_add_f32_dpp v24, v24, v24 row_ror:8 row_mask:0xf bank_mask:0xf
    v_mov_b32 v25, v24
    s_mov_b32 exec_hi, 0
    buffer_store_dwordx2 v[40:41], v21, s[60:63], s65 offen sc1
    buffer_store_dwordx2 v[44:45], v21, s[60:63], s65 offen offset:256 sc1
    s_mov_b64 exec, -1
    s_cmp_eq_u32 s64, 63
    s_cbranch_scc1 CS_exit
    v_permlane16_swap_b32 v24, v25
    v_mfma_f32_16x16x16_bf16 v[48:51], v[40:41], v[32:33], v[48:51]
    v_mfma_f32_16x16x16_bf16 v[52:55], v[44:45], v[32:33], v[52:55]
    v_add_f32 v24, v24, v25
    v_mov_b32 v25, v24
    ds_read_b128 v[64:67], v16 offset:0
    ds_read_b128 v[68:71], v16 offset:1024
    v_permlane32_swap_b32 v24, v25
    ds_read_b128 v[72:75], v16 offset:2048
    ds_read_b128 v[76:79], v16 offset:3072
    v_add_f32 v24, v24, v25
    v_rcp_f32 v24, v24
    s_and_b32 s65, s64, 1
    s_mul_i32 s65, s65, 294912
    v_mov_b32 v25, v24
    s_nop 0
    v_pk_mul_f32 v[48:49], v[48:49], v[24:25]
    v_pk_mul_f32 v[50:51], v[50:51], v[24:25]
    v_pk_mul_f32 v[52:53], v[52:53], v[24:25]
    v_pk_mul_f32 v[54:55], v[54:55], v[24:25]
    v_cvt_pk_bf16_f32 v48, v48, v49
    v_cvt_pk_bf16_f32 v49, v50, v51
    v_cvt_pk_bf16_f32 v52, v52, v53
    v_cvt_pk_bf16_f32 v53, v54, v55
    s_mov_b32 exec_lo, 0x00ff00ff
    s_mov_b32 exec_hi, 0x00ff00ff
    ds_write_b64 v14, v[48:49]
    ds_write_b64 v14, v[52:53] offset:256
    s_mov_b64 exec, -1
    ds_read_b128 v[28:31], v16 offset:4096
    ds_read_b128 v[56:59], v16 offset:5120
    s_waitcnt lgkmcnt(2)
    s_barrier
    ds_read_b128 v[40:43], v15 offset:0
    ds_read_b128 v[44:47], v15 offset:512
    ds_read_b128 v[48:51], v15 offset:1024
    ds_read_b128 v[52:55], v15 offset:1536
    s_waitcnt vmcnt(5)
    v_add_u32 v22, s80, v16
    s_waitcnt lgkmcnt(0)
    v_mfma_f32_16x16x32_bf16 v[32:35], v[64:67], v[40:43], 0
    ds_read_b128 v[64:67], v16 offset:6144
    v_mfma_f32_16x16x32_bf16 v[32:35], v[68:71], v[44:47], v[32:35]
    ds_read_b128 v[68:71], v16 offset:7168
    v_mfma_f32_16x16x32_bf16 v[32:35], v[72:75], v[48:51], v[32:35]
    ds_read_b128 v[72:75], v16 offset:8192
    v_mfma_f32_16x16x32_bf16 v[32:35], v[76:79], v[52:55], v[32:35]
    ds_read_b128 v[76:79], v16 offset:9216
    v_mfma_f32_16x16x32_bf16 v[60:63], v[28:31], v[40:43], 0
    ds_read_b128 v[28:31], v16 offset:10240
    v_mfma_f32_16x16x32_bf16 v[60:63], v[56:59], v[44:47], v[60:63]
    ds_read_b128 v[56:59], v16 offset:11264
    s_waitcnt lgkmcnt(5)
    v_mfma_f32_16x16x32_bf16 v[60:63], v[64:67], v[48:51], v[60:63]
    ds_read_b128 v[64:67], v16 offset:12288
    s_waitcnt lgkmcnt(5)
    v_mfma_f32_16x16x32_bf16 v[60:63], v[68:71], v[52:55], v[60:63]
    ds_read_b128 v[68:71], v16 offset:13312
    s_waitcnt lgkmcnt(5)
    v_mfma_f32_16x16x32_bf16 v[36:39], v[72:75], v[40:43], 0
    ds_read_b128 v[72:75], v16 offset:14336
    s_waitcnt lgkmcnt(5)
    v_mfma_f32_16x16x32_bf16 v[36:39], v[76:79], v[44:47], v[36:39]
    ds_read_b128 v[76:79], v16 offset:15360
    s_waitcnt lgkmcnt(5)
    v_mfma_f32_16x16x32_bf16 v[36:39], v[28:31], v[48:51], v[36:39]
    ds_read_b128 v[28:31], v16 offset:16384
    s_waitcnt lgkmcnt(5)
    v_mfma_f32_16x16x32_bf16 v[36:39], v[56:59], v[52:55], v[36:39]
    ds_read_b128 v[56:59], v16 offset:17408
    v_cvt_pk_bf16_f32 v32, v32, v33
    s_waitcnt lgkmcnt(5)
    v_mfma_f32_16x16x32_bf16 v[24:27], v[64:67], v[40:43], 0
    ds_read_b128 v[64:67], v16 offset:18432
    v_cvt_pk_bf16_f32 v33, v34, v35
    v_cvt_pk_bf16_f32 v34, v60, v61
    s_waitcnt lgkmcnt(5)
    v_mfma_f32_16x16x32_bf16 v[24:27], v[68:71], v[44:47], v[24:27]
    ds_read_b128 v[68:71], v16 offset:19456
    v_cvt_pk_bf16_f32 v35, v62, v63
    s_waitcnt lgkmcnt(5)
    v_mfma_f32_16x16x32_bf16 v[24:27], v[72:75], v[48:51], v[24:27]
    ds_read_b128 v[72:75], v16 offset:20480
    buffer_store_dwordx4 v[32:35], v17, s[44:47], s65 offen sc1
    s_waitcnt lgkmcnt(5)
    v_mfma_f32_16x16x32_bf16 v[24:27], v[76:79], v[52:55], v[24:27]
    ds_read_b128 v[76:79], v16 offset:21504
    s_add_u32 s65, s65, 16384
    s_waitcnt lgkmcnt(5)
    v_mfma_f32_16x16x32_bf16 v[32:35], v[28:31], v[40:43], 0
    ds_read_b128 v[28:31], v16 offset:22528
    s_waitcnt lgkmcnt(5)
    v_mfma_f32_16x16x32_bf16 v[32:35], v[56:59], v[44:47], v[32:35]
    ds_read_b128 v[56:59], v16 offset:23552
    s_waitcnt lgkmcnt(5)
    v_mfma_f32_16x16x32_bf16 v[32:35], v[64:67], v[48:51], v[32:35]
    ds_read_b128 v[64:67], v16 offset:24576
    s_waitcnt lgkmcnt(5)
    v_mfma_f32_16x16x32_bf16 v[32:35], v[68:71], v[52:55], v[32:35]
    ds_read_b128 v[68:71], v16 offset:25600
    v_cvt_pk_bf16_f32 v36, v36, v37
    s_waitcnt lgkmcnt(5)
    v_mfma_f32_16x16x32_bf16 v[60:63], v[72:75], v[40:43], 0
    ds_read_b128 v[72:75], v16 offset:26624
    v_cvt_pk_bf16_f32 v37, v38, v39
    v_cvt_pk_bf16_f32 v38, v24, v25
    s_waitcnt lgkmcnt(5)
    v_mfma_f32_16x16x32_bf16 v[60:63], v[76:79], v[44:47], v[60:63]
    ds_read_b128 v[76:79], v16 offset:27648
    v_cvt_pk_bf16_f32 v39, v26, v27
    s_waitcnt lgkmcnt(5)
    v_mfma_f32_16x16x32_bf16 v[60:63], v[28:31], v[48:51], v[60:63]
    ds_read_b128 v[28:31], v16 offset:28672
    buffer_store_dwordx4 v[36:39], v17, s[44:47], s65 offen sc1
    s_waitcnt lgkmcnt(5)
    v_mfma_f32_16x16x32_bf16 v[60:63], v[56:59], v[52:55], v[60:63]
    ds_read_b128 v[56:59], v16 offset:29696
    s_add_u32 s65, s65, 16384
    s_waitcnt lgkmcnt(5)
    v_mfma_f32_16x16x32_bf16 v[36:39], v[64:67], v[40:43], 0
    ds_read_b128 v[64:67], v16 offset:30720
    s_waitcnt lgkmcnt(5)
    v_mfma_f32_16x16x32_bf16 v[36:39], v[68:71], v[44:47], v[36:39]
    ds_read_b128 v[68:71], v16 offset:31744
    s_waitcnt lgkmcnt(5)
    v_mfma_f32_16x16x32_bf16 v[36:39], v[72:75], v[48:51], v[36:39]
    ds_read_b128 v[72:75], v22 offset:0
    s_waitcnt lgkmcnt(5)
    v_mfma_f32_16x16x32_bf16 v[36:39], v[76:79], v[52:55], v[36:39]
    ds_read_b128 v[76:79], v22 offset:1024
    v_cvt_pk_bf16_f32 v32, v32, v33
    s_waitcnt lgkmcnt(5)
    v_mfma_f32_16x16x32_bf16 v[24:27], v[28:31], v[40:43], 0
    ds_read_b128 v[28:31], v22 offset:2048
    v_cvt_pk_bf16_f32 v33, v34, v35
    v_cvt_pk_bf16_f32 v34, v60, v61
    s_waitcnt lgkmcnt(5)
    v_mfma_f32_16x16x32_bf16 v[24:27], v[56:59], v[44:47], v[24:27]
    ds_read_b128 v[56:59], v22 offset:3072
    v_cvt_pk_bf16_f32 v35, v62, v63
    s_waitcnt lgkmcnt(5)
    v_mfma_f32_16x16x32_bf16 v[24:27], v[64:67], v[48:51], v[24:27]
    buffer_store_dwordx4 v[32:35], v17, s[44:47], s65 offen sc1
    s_waitcnt lgkmcnt(4)
    v_mfma_f32_16x16x32_bf16 v[24:27], v[68:71], v[52:55], v[24:27]
    s_add_u32 s65, s65, 16384
    s_waitcnt lgkmcnt(3)
    v_mfma_f32_16x16x32_bf16 v[32:35], v[72:75], v[40:43], 0
    s_waitcnt lgkmcnt(2)
    v_mfma_f32_16x16x32_bf16 v[32:35], v[76:79], v[44:47], v[32:35]
    s_waitcnt lgkmcnt(1)
    v_mfma_f32_16x16x32_bf16 v[32:35], v[28:31], v[48:51], v[32:35]
    s_nop 2
    s_waitcnt lgkmcnt(0)
    v_mfma_f32_16x16x32_bf16 v[32:35], v[56:59], v[52:55], v[32:35]
    v_cvt_pk_bf16_f32 v36, v36, v37
    v_cvt_pk_bf16_f32 v37, v38, v39
    v_cvt_pk_bf16_f32 v38, v24, v25
    v_cvt_pk_bf16_f32 v39, v26, v27
    buffer_store_dwordx4 v[36:39], v17, s[44:47], s65 offen sc1
    s_add_u32 s65, s65, 16384
    v_add_u32 v22, s81, v17
    s_nop 3
    v_cvt_pk_bf16_f32 v32, v32, v33
    v_cvt_pk_bf16_f32 v33, v34, v35
    buffer_store_dwordx2 v[32:33], v22, s[44:47], s65 offen sc1
    s_cmp_eq_u32 s39, -1
    s_cbranch_scc1 CS_nored
    s_and_b32 s65, s64, 1
    s_mul_i32 s65, s65, 72
    s_add_u32 s65, s65, s39
    s_lshl_b32 s65, s65, 12
    s_add_u32 s70, s64, 1
    s_mul_i32 s70, s70, 9216
    s_add_u32 s70, s70, s77
    s_mov_b32 s67, 0
CS_pollr:
    buffer_load_dwordx4 v[24:27], v18, s[44:47], s65 offen offset:0 sc1
    buffer_load_dwordx4 v[28:31], v18, s[44:47], s65 offen offset:1024 sc1
    buffer_load_dwordx4 v[32:35], v18, s[44:47], s65 offen offset:2048 sc1
    buffer_load_dwordx4 v[36:39], v18, s[44:47], s65 offen offset:3072 sc1
    s_add_u32 s67, s67, 1
    s_waitcnt vmcnt(0)
    v_mfma_f32_16x16x32_bf16 v[40:43], v[0:3], v[24:27], 0
    v_mfma_f32_16x16x32_bf16 v[40:43], v[0:3], v[28:31], v[40:43]
    v_mfma_f32_16x16x32_bf16 v[40:43], v[0:3], v[32:35], v[40:43]
    v_mfma_f32_16x16x32_bf16 v[40:43], v[0:3], v[36:39], v[40:43]
    v_max3_u32 v76, v24, v25, v26
    v_max3_u32 v77, v27, v28, v29
    v_max3_u32 v78, v30, v31, v32
    v_max3_u32 v79, v33, v34, v35
    v_max3_u32 v76, v76, v36, v37
    v_max3_u32 v77, v77, v38, v39
    v_max3_u32 v76, v76, v77, v78
    v_max_u32 v76, v76, v79
    v_cmp_eq_u32 vcc, -1, v76
    s_cmp_ge_u32 s67, 0x100000
    s_cbranch_scc1 CS_pr_done
    s_cbranch_vccnz CS_pollr
CS_pr_done:
    v_add_f32_dpp v40, v40, v40 row_ror:8 row_mask:0xf bank_mask:0xf
    v_add_f32_dpp v41, v41, v41 row_ror:8 row_mask:0xf bank_mask:0xf
    v_add_f32_dpp v42, v42, v42 row_ror:8 row_mask:0xf bank_mask:0xf
    v_add_f32_dpp v43, v43, v43 row_ror:8 row_mask:0xf bank_mask:0xf
    v_cvt_pk_bf16_f32 v40, v40, v41
    v_cvt_pk_bf16_f32 v41, v42, v43
    s_mov_b32 exec_lo, 0x00ff00ff
    s_mov_b32 exec_hi, 0
    buffer_store_dwordx2 v[40:41], v19, s[40:43], s70 offen sc1
    s_mov_b64 exec, -1
    v_mov_b32 v76, -1
    v_mov_b32 v77, -1
    v_mov_b32 v78, -1
    v_mov_b32 v79, -1
    buffer_store_dwordx4 v[76:79], v18, s[44:47], s65 offen offset:0 sc1
    buffer_store_dwordx4 v[76:79], v18, s[44:47], s65 offen offset:1024 sc1
    buffer_store_dwordx4 v[76:79], v18, s[44:47], s65 offen offset:2048 sc1
    buffer_store_dwordx4 v[76:79], v18, s[44:47], s65 offen offset:3072 sc1
CS_nored:
    s_add_u32 s64, s64, 1
    s_cmp_lt_u32 s64, 64
    s_cbranch_scc1 CS_top
CS_exit:
KM_chain_end:
    s_waitcnt vmcnt(0)
    v_mov_b32 v76, 64
    v_mov_b32 v77, 0
    s_mov_b32 exec_lo, 1
    s_mov_b32 exec_hi, 0
    global_store_dword v77, v76, s[78:79] sc1
    s_waitcnt vmcnt(0)
    s_branch KM_done
KM_worker:
    s_and_b32 s88, s39, 0xfff
    s_mov_b32 s89, s88
KW_loop:
    s_cmp_ge_u32 s89, 1744
    s_cbranch_scc1 KW_gemm_done
    s_cmp_ge_u32 s89, 1680
    s_cbranch_scc1 KW_gate
    s_cmp_ge_u32 s89, 1168
    s_cbranch_scc1 KW_q
    s_cmp_ge_u32 s89, 1024
    s_cbranch_scc1 KW_b
    s_lshr_b32 s37, s89, 6
    s_bfe_u32 s36, s89, 0x10005
    s_add_u32 s36, s36, 1
    s_and_b32 s38, s89, 31
    s_branch KW_a
KW_q:
    s_sub_u32 s39, s89, 1168
    s_mov_b32 s36, 0
    s_and_b32 s37, s39, 15
    s_lshr_b32 s38, s39, 4
KW_a:
    s_mul_i32 s39, s37, 147456
    s_add_u32 s40, s8, s39
    s_addc_u32 s41, s9, 0
    s_mov_b32 s42, 147456
    s_mov_b32 s43, 0x00020000
    s_cmp_eq_u32 s36, 0
    s_cselect_b32 s44, s12, s14
    s_cselect_b32 s45, s13, s15
    s_cmp_eq_u32 s36, 2
    s_cselect_b32 s44, s16, s44
    s_cselect_b32 s45, s17, s45
    s_lshl_b32 s39, s38, 8
    s_add_u32 s44, s44, s39
    s_addc_u32 s45, s45, 0
    s_sub_u32 s46, 4718592, s39
    s_mov_b32 s47, 0x00020000
    s_cmp_eq_u32 s36, 2
    s_cbranch_scc1 TV_1
    v_lshrrev_b32 v1, 3, v0
    v_add_u32 v1, 0, v1
    v_and_b32 v2, 7, v0
    v_mul_u32_u24 v3, 1152, v1
    v_lshl_add_u32 v8, v2, 4, v3
    v_mul_u32_u24 v3, 144, v1
    v_lshl_add_u32 v16, v2, 4, v3
    v_lshrrev_b32 v1, 3, v0
    v_add_u32 v1, 32, v1
    v_and_b32 v2, 7, v0
    v_mul_u32_u24 v3, 1152, v1
    v_lshl_add_u32 v9, v2, 4, v3
    v_mul_u32_u24 v3, 144, v1
    v_lshl_add_u32 v17, v2, 4, v3
    v_lshrrev_b32 v1, 3, v0
    v_add_u32 v1, 64, v1
    v_and_b32 v2, 7, v0
    v_mul_u32_u24 v3, 1152, v1
    v_lshl_add_u32 v10, v2, 4, v3
    v_mul_u32_u24 v3, 144, v1
    v_lshl_add_u32 v18, v2, 4, v3
    v_lshrrev_b32 v1, 3, v0
    v_add_u32 v1, 96, v1
    v_and_b32 v2, 7, v0
    v_mul_u32_u24 v3, 1152, v1
    v_lshl_add_u32 v11, v2, 4, v3
    v_mul_u32_u24 v3, 144, v1
    v_lshl_add_u32 v19, v2, 4, v3
    v_add_u32 v1, 0, v0
    v_lshrrev_b32 v2, 4, v1
    v_and_b32 v1, 15, v1
    v_mul_u32_u24 v3, 8192, v2
    v_lshl_add_u32 v12, v1, 4, v3
    v_mul_u32_u24 v3, 288, v2
    v_lshl_add_u32 v20, v1, 4, v3
    v_add_u32 v20, 18432, v20
    v_add_u32 v1, 256, v0
    v_lshrrev_b32 v2, 4, v1
    v_and_b32 v1, 15, v1
    v_mul_u32_u24 v3, 8192, v2
    v_lshl_add_u32 v13, v1, 4, v3
    v_mul_u32_u24 v3, 288, v2
    v_lshl_add_u32 v21, v1, 4, v3
    v_add_u32 v21, 18432, v21
    v_add_u32 v1, 512, v0
    v_lshrrev_b32 v2, 4, v1
    v_and_b32 v1, 15, v1
    v_mul_u32_u24 v3, 8192, v2
    v_lshl_add_u32 v14, v1, 4, v3
    v_mul_u32_u24 v3, 288, v2
    v_lshl_add_u32 v22, v1, 4, v3
    v_add_u32 v22, 18432, v22
    v_add_u32 v1, 768, v0
    v_lshrrev_b32 v2, 4, v1
    v_and_b32 v1, 15, v1
    v_mul_u32_u24 v3, 8192, v2
    v_lshl_add_u32 v15, v1, 4, v3
    v_mul_u32_u24 v3, 288, v2
    v_lshl_add_u32 v23, v1, 4, v3
    v_add_u32 v23, 18432, v23
    v_lshrrev_b32 v1, 6, v0
    v_and_b32 v2, 63, v0
    v_lshrrev_b32 v3, 1, v1
    v_mul_u32_u24 v3, 64, v3
    v_and_b32 v24, 15, v2
    v_add_u32 v3, v3, v24
    v_mul_u32_u24 v3, 144, v3
    v_lshrrev_b32 v24, 4, v2
    v_lshl_add_u32 v24, v24, 3, v3
    v_lshrrev_b32 v3, 4, v2
    v_lshlrev_b32 v3, 2, v3
    v_bfe_u32 v25, v2, 2, 2
    v_add_u32 v3, v3, v25
    v_mul_u32_u24 v3, 288, v3
    v_and_b32 v1, 1, v1
    v_mul_u32_u24 v1, 128, v1
    v_add_u32 v3, v3, v1
    v_and_b32 v1, 3, v2
    v_lshl_add_u32 v25, v1, 3, v3
    v_add_u32 v25, 18432, v25
    v_add_u32 v26, 36864, v24
    v_add_u32 v27, 36864, v25
    v_mov_b32 v156, 0
    v_mov_b32 v157, 0
    v_mov_b32 v158, 0
    v_mov_b32 v159, 0
    v_mov_b32 v160, 0
    v_mov_b32 v161, 0
    v_mov_b32 v162, 0
    v_mov_b32 v163, 0
    v_mov_b32 v164, 0
    v_mov_b32 v165, 0
    v_mov_b32 v166, 0
    v_mov_b32 v167, 0
    v_mov_b32 v168, 0
    v_mov_b32 v169, 0
    v_mov_b32 v170, 0
    v_mov_b32 v171, 0
    v_mov_b32 v172, 0
    v_mov_b32 v173, 0
    v_mov_b32 v174, 0
    v_mov_b32 v175, 0
    v_mov_b32 v176, 0
    v_mov_b32 v177, 0
    v_mov_b32 v178, 0
    v_mov_b32 v179, 0
    v_mov_b32 v180, 0
    v_mov_b32 v181, 0
    v_mov_b32 v182, 0
    v_mov_b32 v183, 0
    v_mov_b32 v184, 0
    v_mov_b32 v185, 0
    v_mov_b32 v186, 0
    v_mov_b32 v187, 0
    v_mov_b32 v188, 0
    v_mov_b32 v189, 0
    v_mov_b32 v190, 0
    v_mov_b32 v191, 0
    v_mov_b32 v192, 0
    v_mov_b32 v193, 0
    v_mov_b32 v194, 0
    v_mov_b32 v195, 0
    v_mov_b32 v196, 0
    v_mov_b32 v197, 0
    v_mov_b32 v198, 0
    v_mov_b32 v199, 0
    v_mov_b32 v200, 0
    v_mov_b32 v201, 0
    v_mov_b32 v202, 0
    v_mov_b32 v203, 0
    v_mov_b32 v204, 0
    v_mov_b32 v205, 0
    v_mov_b32 v206, 0
    v_mov_b32 v207, 0
    v_mov_b32 v208, 0
    v_mov_b32 v209, 0
    v_mov_b32 v210, 0
    v_mov_b32 v211, 0
    v_mov_b32 v212, 0
    v_mov_b32 v213, 0
    v_mov_b32 v214, 0
    v_mov_b32 v215, 0
    v_mov_b32 v216, 0
    v_mov_b32 v217, 0
    v_mov_b32 v218, 0
    v_mov_b32 v219, 0
    s_mov_b32 s48, 0
    s_mov_b32 s49, 0
    buffer_load_dwordx4 v[28:31], v8, s[40:43], s48 offen
    buffer_load_dwordx4 v[32:35], v9, s[40:43], s48 offen
    buffer_load_dwordx4 v[36:39], v10, s[40:43], s48 offen
    buffer_load_dwordx4 v[40:43], v11, s[40:43], s48 offen
    buffer_load_dwordx4 v[44:47], v12, s[44:47], s49 offen
    buffer_load_dwordx4 v[48:51], v13, s[44:47], s49 offen
    buffer_load_dwordx4 v[52:55], v14, s[44:47], s49 offen
    buffer_load_dwordx4 v[56:59], v15, s[44:47], s49 offen
    s_add_u32 s48, s48, 128
    s_add_u32 s49, s49, 0x80000
    buffer_load_dwordx4 v[60:63], v8, s[40:43], s48 offen
    buffer_load_dwordx4 v[64:67], v9, s[40:43], s48 offen
    buffer_load_dwordx4 v[68:71], v10, s[40:43], s48 offen
    buffer_load_dwordx4 v[72:75], v11, s[40:43], s48 offen
    buffer_load_dwordx4 v[76:79], v12, s[44:47], s49 offen
    buffer_load_dwordx4 v[80:83], v13, s[44:47], s49 offen
    buffer_load_dwordx4 v[84:87], v14, s[44:47], s49 offen
    buffer_load_dwordx4 v[88:91], v15, s[44:47], s49 offen
    s_add_u32 s48, s48, 128
    s_add_u32 s49, s49, 0x80000
    s_waitcnt vmcnt(8)
    s_barrier
    ds_write_b128 v16, v[28:31] offset:0
    ds_write_b128 v17, v[32:35] offset:0
    ds_write_b128 v18, v[36:39] offset:0
    ds_write_b128 v19, v[40:43] offset:0
    ds_write_b128 v20, v[44:47] offset:0
    ds_write_b128 v21, v[48:51] offset:0
    ds_write_b128 v22, v[52:55] offset:0
    ds_write_b128 v23, v[56:59] offset:0
    s_waitcnt lgkmcnt(0)
    s_barrier
    s_mov_b32 s50, 9
GL_3:
    buffer_load_dwordx4 v[28:31], v8, s[40:43], s48 offen
    buffer_load_dwordx4 v[32:35], v9, s[40:43], s48 offen
    buffer_load_dwordx4 v[36:39], v10, s[40:43], s48 offen
    buffer_load_dwordx4 v[40:43], v11, s[40:43], s48 offen
    buffer_load_dwordx4 v[44:47], v12, s[44:47], s49 offen
    buffer_load_dwordx4 v[48:51], v13, s[44:47], s49 offen
    buffer_load_dwordx4 v[52:55], v14, s[44:47], s49 offen
    buffer_load_dwordx4 v[56:59], v15, s[44:47], s49 offen
    s_add_u32 s48, s48, 128
    s_add_u32 s49, s49, 0x80000
    ds_read_b64 v[92:93], v24 offset:0
    ds_read_b64 v[94:95], v24 offset:32
    ds_read_b64 v[96:97], v24 offset:2304
    ds_read_b64 v[98:99], v24 offset:2336
    ds_read_b64 v[100:101], v24 offset:4608
    ds_read_b64 v[102:103], v24 offset:4640
    ds_read_b64 v[104:105], v24 offset:6912
    ds_read_b64 v[106:107], v24 offset:6944
    ds_read_b64_tr_b16 v[124:125], v25 offset:0
    ds_read_b64_tr_b16 v[126:127], v25 offset:4608
    ds_read_b64_tr_b16 v[128:129], v25 offset:32
    ds_read_b64_tr_b16 v[130:131], v25 offset:4640
    ds_read_b64_tr_b16 v[132:133], v25 offset:64
    ds_read_b64_tr_b16 v[134:135], v25 offset:4672
    ds_read_b64_tr_b16 v[136:137], v25 offset:96
    ds_read_b64_tr_b16 v[138:139], v25 offset:4704
    ds_read_b64 v[108:109], v24 offset:64
    ds_read_b64 v[110:111], v24 offset:96
    ds_read_b64 v[112:113], v24 offset:2368
    ds_read_b64 v[114:115], v24 offset:2400
    ds_read_b64 v[116:117], v24 offset:4672
    ds_read_b64 v[118:119], v24 offset:4704
    ds_read_b64 v[120:121], v24 offset:6976
    ds_read_b64 v[122:123], v24 offset:7008
    ds_read_b64_tr_b16 v[140:141], v25 offset:9216
    ds_read_b64_tr_b16 v[142:143], v25 offset:13824
    ds_read_b64_tr_b16 v[144:145], v25 offset:9248
    ds_read_b64_tr_b16 v[146:147], v25 offset:13856
    ds_read_b64_tr_b16 v[148:149], v25 offset:9280
    ds_read_b64_tr_b16 v[150:151], v25 offset:13888
    ds_read_b64_tr_b16 v[152:153], v25 offset:9312
    ds_read_b64_tr_b16 v[154:155], v25 offset:13920
    s_waitcnt lgkmcnt(15)
    v_mfma_f32_16x16x32_bf16 v[156:159], v[124:127], v[92:95], v[156:159]
    v_mfma_f32_16x16x32_bf16 v[160:163], v[128:131], v[92:95], v[160:163]
    v_mfma_f32_16x16x32_bf16 v[164:167], v[132:135], v[92:95], v[164:167]
    v_mfma_f32_16x16x32_bf16 v[168:171], v[136:139], v[92:95], v[168:171]
    v_mfma_f32_16x16x32_bf16 v[172:175], v[124:127], v[96:99], v[172:175]
    v_mfma_f32_16x16x32_bf16 v[176:179], v[128:131], v[96:99], v[176:179]
    v_mfma_f32_16x16x32_bf16 v[180:183], v[132:135], v[96:99], v[180:183]
    v_mfma_f32_16x16x32_bf16 v[184:187], v[136:139], v[96:99], v[184:187]
    v_mfma_f32_16x16x32_bf16 v[188:191], v[124:127], v[100:103], v[188:191]
    v_mfma_f32_16x16x32_bf16 v[192:195], v[128:131], v[100:103], v[192:195]
    v_mfma_f32_16x16x32_bf16 v[196:199], v[132:135], v[100:103], v[196:199]
    v_mfma_f32_16x16x32_bf16 v[200:203], v[136:139], v[100:103], v[200:203]
    v_mfma_f32_16x16x32_bf16 v[204:207], v[124:127], v[104:107], v[204:207]
    v_mfma_f32_16x16x32_bf16 v[208:211], v[128:131], v[104:107], v[208:211]
    v_mfma_f32_16x16x32_bf16 v[212:215], v[132:135], v[104:107], v[212:215]
    v_mfma_f32_16x16x32_bf16 v[216:219], v[136:139], v[104:107], v[216:219]
    s_waitcnt lgkmcnt(0)
    v_mfma_f32_16x16x32_bf16 v[156:159], v[140:143], v[108:111], v[156:159]
    v_mfma_f32_16x16x32_bf16 v[160:163], v[144:147], v[108:111], v[160:163]
    v_mfma_f32_16x16x32_bf16 v[164:167], v[148:151], v[108:111], v[164:167]
    v_mfma_f32_16x16x32_bf16 v[168:171], v[152:155], v[108:111], v[168:171]
    v_mfma_f32_16x16x32_bf16 v[172:175], v[140:143], v[112:115], v[172:175]
    v_mfma_f32_16x16x32_bf16 v[176:179], v[144:147], v[112:115], v[176:179]
    v_mfma_f32_16x16x32_bf16 v[180:183], v[148:151], v[112:115], v[180:183]
    v_mfma_f32_16x16x32_bf16 v[184:187], v[152:155], v[112:115], v[184:187]
    v_mfma_f32_16x16x32_bf16 v[188:191], v[140:143], v[116:119], v[188:191]
    v_mfma_f32_16x16x32_bf16 v[192:195], v[144:147], v[116:119], v[192:195]
    v_mfma_f32_16x16x32_bf16 v[196:199], v[148:151], v[116:119], v[196:199]
    v_mfma_f32_16x16x32_bf16 v[200:203], v[152:155], v[116:119], v[200:203]
    v_mfma_f32_16x16x32_bf16 v[204:207], v[140:143], v[120:123], v[204:207]
    v_mfma_f32_16x16x32_bf16 v[208:211], v[144:147], v[120:123], v[208:211]
    v_mfma_f32_16x16x32_bf16 v[212:215], v[148:151], v[120:123], v[212:215]
    v_mfma_f32_16x16x32_bf16 v[216:219], v[152:155], v[120:123], v[216:219]
    s_waitcnt vmcnt(8)
    ds_write_b128 v16, v[60:63] offset:36864
    ds_write_b128 v17, v[64:67] offset:36864
    ds_write_b128 v18, v[68:71] offset:36864
    ds_write_b128 v19, v[72:75] offset:36864
    ds_write_b128 v20, v[76:79] offset:36864
    ds_write_b128 v21, v[80:83] offset:36864
    ds_write_b128 v22, v[84:87] offset:36864
    ds_write_b128 v23, v[88:91] offset:36864
    s_waitcnt lgkmcnt(0)
    s_barrier
    s_sub_u32 s50, s50, 1
    s_cmp_eq_u32 s50, 0
    s_cbranch_scc1 GE_4
    buffer_load_dwordx4 v[60:63], v8, s[40:43], s48 offen
    buffer_load_dwordx4 v[64:67], v9, s[40:43], s48 offen
    buffer_load_dwordx4 v[68:71], v10, s[40:43], s48 offen
    buffer_load_dwordx4 v[72:75], v11, s[40:43], s48 offen
    buffer_load_dwordx4 v[76:79], v12, s[44:47], s49 offen
    buffer_load_dwordx4 v[80:83], v13, s[44:47], s49 offen
    buffer_load_dwordx4 v[84:87], v14, s[44:47], s49 offen
    buffer_load_dwordx4 v[88:91], v15, s[44:47], s49 offen
    s_add_u32 s48, s48, 128
    s_add_u32 s49, s49, 0x80000
    ds_read_b64 v[92:93], v26 offset:0
    ds_read_b64 v[94:95], v26 offset:32
    ds_read_b64 v[96:97], v26 offset:2304
    ds_read_b64 v[98:99], v26 offset:2336
    ds_read_b64 v[100:101], v26 offset:4608
    ds_read_b64 v[102:103], v26 offset:4640
    ds_read_b64 v[104:105], v26 offset:6912
    ds_read_b64 v[106:107], v26 offset:6944
    ds_read_b64_tr_b16 v[124:125], v27 offset:0
    ds_read_b64_tr_b16 v[126:127], v27 offset:4608
    ds_read_b64_tr_b16 v[128:129], v27 offset:32
    ds_read_b64_tr_b16 v[130:131], v27 offset:4640
    ds_read_b64_tr_b16 v[132:133], v27 offset:64
    ds_read_b64_tr_b16 v[134:135], v27 offset:4672
    ds_read_b64_tr_b16 v[136:137], v27 offset:96
    ds_read_b64_tr_b16 v[138:139], v27 offset:4704
    ds_read_b64 v[108:109], v26 offset:64
    ds_read_b64 v[110:111], v26 offset:96
    ds_read_b64 v[112:113], v26 offset:2368
    ds_read_b64 v[114:115], v26 offset:2400
    ds_read_b64 v[116:117], v26 offset:4672
    ds_read_b64 v[118:119], v26 offset:4704
    ds_read_b64 v[120:121], v26 offset:6976
    ds_read_b64 v[122:123], v26 offset:7008
    ds_read_b64_tr_b16 v[140:141], v27 offset:9216
    ds_read_b64_tr_b16 v[142:143], v27 offset:13824
    ds_read_b64_tr_b16 v[144:145], v27 offset:9248
    ds_read_b64_tr_b16 v[146:147], v27 offset:13856
    ds_read_b64_tr_b16 v[148:149], v27 offset:9280
    ds_read_b64_tr_b16 v[150:151], v27 offset:13888
    ds_read_b64_tr_b16 v[152:153], v27 offset:9312
    ds_read_b64_tr_b16 v[154:155], v27 offset:13920
    s_waitcnt lgkmcnt(15)
    v_mfma_f32_16x16x32_bf16 v[156:159], v[124:127], v[92:95], v[156:159]
    v_mfma_f32_16x16x32_bf16 v[160:163], v[128:131], v[92:95], v[160:163]
    v_mfma_f32_16x16x32_bf16 v[164:167], v[132:135], v[92:95], v[164:167]
    v_mfma_f32_16x16x32_bf16 v[168:171], v[136:139], v[92:95], v[168:171]
    v_mfma_f32_16x16x32_bf16 v[172:175], v[124:127], v[96:99], v[172:175]
    v_mfma_f32_16x16x32_bf16 v[176:179], v[128:131], v[96:99], v[176:179]
    v_mfma_f32_16x16x32_bf16 v[180:183], v[132:135], v[96:99], v[180:183]
    v_mfma_f32_16x16x32_bf16 v[184:187], v[136:139], v[96:99], v[184:187]
    v_mfma_f32_16x16x32_bf16 v[188:191], v[124:127], v[100:103], v[188:191]
    v_mfma_f32_16x16x32_bf16 v[192:195], v[128:131], v[100:103], v[192:195]
    v_mfma_f32_16x16x32_bf16 v[196:199], v[132:135], v[100:103], v[196:199]
    v_mfma_f32_16x16x32_bf16 v[200:203], v[136:139], v[100:103], v[200:203]
    v_mfma_f32_16x16x32_bf16 v[204:207], v[124:127], v[104:107], v[204:207]
    v_mfma_f32_16x16x32_bf16 v[208:211], v[128:131], v[104:107], v[208:211]
    v_mfma_f32_16x16x32_bf16 v[212:215], v[132:135], v[104:107], v[212:215]
    v_mfma_f32_16x16x32_bf16 v[216:219], v[136:139], v[104:107], v[216:219]
    s_waitcnt lgkmcnt(0)
    v_mfma_f32_16x16x32_bf16 v[156:159], v[140:143], v[108:111], v[156:159]
    v_mfma_f32_16x16x32_bf16 v[160:163], v[144:147], v[108:111], v[160:163]
    v_mfma_f32_16x16x32_bf16 v[164:167], v[148:151], v[108:111], v[164:167]
    v_mfma_f32_16x16x32_bf16 v[168:171], v[152:155], v[108:111], v[168:171]
    v_mfma_f32_16x16x32_bf16 v[172:175], v[140:143], v[112:115], v[172:175]
    v_mfma_f32_16x16x32_bf16 v[176:179], v[144:147], v[112:115], v[176:179]
    v_mfma_f32_16x16x32_bf16 v[180:183], v[148:151], v[112:115], v[180:183]
    v_mfma_f32_16x16x32_bf16 v[184:187], v[152:155], v[112:115], v[184:187]
    v_mfma_f32_16x16x32_bf16 v[188:191], v[140:143], v[116:119], v[188:191]
    v_mfma_f32_16x16x32_bf16 v[192:195], v[144:147], v[116:119], v[192:195]
    v_mfma_f32_16x16x32_bf16 v[196:199], v[148:151], v[116:119], v[196:199]
    v_mfma_f32_16x16x32_bf16 v[200:203], v[152:155], v[116:119], v[200:203]
    v_mfma_f32_16x16x32_bf16 v[204:207], v[140:143], v[120:123], v[204:207]
    v_mfma_f32_16x16x32_bf16 v[208:211], v[144:147], v[120:123], v[208:211]
    v_mfma_f32_16x16x32_bf16 v[212:215], v[148:151], v[120:123], v[212:215]
    v_mfma_f32_16x16x32_bf16 v[216:219], v[152:155], v[120:123], v[216:219]
    s_waitcnt vmcnt(8)
    ds_write_b128 v16, v[28:31] offset:0
    ds_write_b128 v17, v[32:35] offset:0
    ds_write_b128 v18, v[36:39] offset:0
    ds_write_b128 v19, v[40:43] offset:0
    ds_write_b128 v20, v[44:47] offset:0
    ds_write_b128 v21, v[48:51] offset:0
    ds_write_b128 v22, v[52:55] offset:0
    ds_write_b128 v23, v[56:59] offset:0
    s_waitcnt lgkmcnt(0)
    s_barrier
    s_sub_u32 s50, s50, 1
    s_cmp_lg_u32 s50, 0
    s_cbranch_scc1 GL_3
GE_4:
    s_waitcnt vmcnt(0)
    s_nop 7
    s_nop 7
    s_lshl_b32 s39, s36, 24
    s_lshl_b32 s52, s37, 20
    s_add_u32 s39, s39, s52
    s_lshl_b32 s52, s38, 8
    s_add_u32 s39, s39, s52
    s_add_u32 s52, s34, s39
    s_addc_u32 s53, s35, 0
    s_mov_b32 s54, 0x100000
    s_mov_b32 s55, 0x00020000
    v_lshrrev_b32 v1, 6, v0
    v_and_b32 v2, 63, v0
    v_lshrrev_b32 v3, 1, v1
    v_and_b32 v1, 1, v1
    v_mul_u32_u24 v3, 64, v3
    v_mul_u32_u24 v1, 64, v1
    v_and_b32 v4, 15, v2
    v_lshrrev_b32 v2, 4, v2
    v_lshlrev_b32 v2, 2, v2
    v_add_u32 v3, v3, v4
    v_add_u32 v1, v1, v2
    v_mul_u32_u24 v3, 8192, v3
    v_lshl_add_u32 v4, v1, 1, v3
    v_cvt_pk_bf16_f32 v156, v156, v157
    v_cvt_pk_bf16_f32 v157, v158, v159
    s_mov_b32 s51, 0x0
    buffer_store_dwordx2 v[156:157], v4, s[52:55], s51 offen offset:0 sc1
    v_cvt_pk_bf16_f32 v160, v160, v161
    v_cvt_pk_bf16_f32 v161, v162, v163
    s_mov_b32 s51, 0x0
    buffer_store_dwordx2 v[160:161], v4, s[52:55], s51 offen offset:32 sc1
    v_cvt_pk_bf16_f32 v164, v164, v165
    v_cvt_pk_bf16_f32 v165, v166, v167
    s_mov_b32 s51, 0x0
    buffer_store_dwordx2 v[164:165], v4, s[52:55], s51 offen offset:64 sc1
    v_cvt_pk_bf16_f32 v168, v168, v169
    v_cvt_pk_bf16_f32 v169, v170, v171
    s_mov_b32 s51, 0x0
    buffer_store_dwordx2 v[168:169], v4, s[52:55], s51 offen offset:96 sc1
    v_cvt_pk_bf16_f32 v172, v172, v173
    v_cvt_pk_bf16_f32 v173, v174, v175
    s_mov_b32 s51, 0x20000
    buffer_store_dwordx2 v[172:173], v4, s[52:55], s51 offen offset:0 sc1
    v_cvt_pk_bf16_f32 v176, v176, v177
    v_cvt_pk_bf16_f32 v177, v178, v179
    s_mov_b32 s51, 0x20000
    buffer_store_dwordx2 v[176:177], v4, s[52:55], s51 offen offset:32 sc1
    v_cvt_pk_bf16_f32 v180, v180, v181
    v_cvt_pk_bf16_f32 v181, v182, v183
    s_mov_b32 s51, 0x20000
    buffer_store_dwordx2 v[180:181], v4, s[52:55], s51 offen offset:64 sc1
    v_cvt_pk_bf16_f32 v184, v184, v185
    v_cvt_pk_bf16_f32 v185, v186, v187
    s_mov_b32 s51, 0x20000
    buffer_store_dwordx2 v[184:185], v4, s[52:55], s51 offen offset:96 sc1
    v_cvt_pk_bf16_f32 v188, v188, v189
    v_cvt_pk_bf16_f32 v189, v190, v191
    s_mov_b32 s51, 0x40000
    buffer_store_dwordx2 v[188:189], v4, s[52:55], s51 offen offset:0 sc1
    v_cvt_pk_bf16_f32 v192, v192, v193
    v_cvt_pk_bf16_f32 v193, v194, v195
    s_mov_b32 s51, 0x40000
    buffer_store_dwordx2 v[192:193], v4, s[52:55], s51 offen offset:32 sc1
    v_cvt_pk_bf16_f32 v196, v196, v197
    v_cvt_pk_bf16_f32 v197, v198, v199
    s_mov_b32 s51, 0x40000
    buffer_store_dwordx2 v[196:197], v4, s[52:55], s51 offen offset:64 sc1
    v_cvt_pk_bf16_f32 v200, v200, v201
    v_cvt_pk_bf16_f32 v201, v202, v203
    s_mov_b32 s51, 0x40000
    buffer_store_dwordx2 v[200:201], v4, s[52:55], s51 offen offset:96 sc1
    v_cvt_pk_bf16_f32 v204, v204, v205
    v_cvt_pk_bf16_f32 v205, v206, v207
    s_mov_b32 s51, 0x60000
    buffer_store_dwordx2 v[204:205], v4, s[52:55], s51 offen offset:0 sc1
    v_cvt_pk_bf16_f32 v208, v208, v209
    v_cvt_pk_bf16_f32 v209, v210, v211
    s_mov_b32 s51, 0x60000
    buffer_store_dwordx2 v[208:209], v4, s[52:55], s51 offen offset:32 sc1
    v_cvt_pk_bf16_f32 v212, v212, v213
    v_cvt_pk_bf16_f32 v213, v214, v215
    s_mov_b32 s51, 0x60000
    buffer_store_dwordx2 v[212:213], v4, s[52:55], s51 offen offset:64 sc1
    v_cvt_pk_bf16_f32 v216, v216, v217
    v_cvt_pk_bf16_f32 v217, v218, v219
    s_mov_b32 s51, 0x60000
    buffer_store_dwordx2 v[216:217], v4, s[52:55], s51 offen offset:96 sc1
    s_branch TE_2
TV_1:
    v_lshrrev_b32 v1, 3, v0
    v_add_u32 v1, 0, v1
    v_and_b32 v2, 7, v0
    v_mul_u32_u24 v3, 1152, v1
    v_lshl_add_u32 v8, v2, 4, v3
    v_mul_u32_u24 v3, 144, v1
    v_lshl_add_u32 v16, v2, 4, v3
    v_lshrrev_b32 v1, 3, v0
    v_add_u32 v1, 32, v1
    v_and_b32 v2, 7, v0
    v_mul_u32_u24 v3, 1152, v1
    v_lshl_add_u32 v9, v2, 4, v3
    v_mul_u32_u24 v3, 144, v1
    v_lshl_add_u32 v17, v2, 4, v3
    v_lshrrev_b32 v1, 3, v0
    v_add_u32 v1, 64, v1
    v_and_b32 v2, 7, v0
    v_mul_u32_u24 v3, 1152, v1
    v_lshl_add_u32 v10, v2, 4, v3
    v_mul_u32_u24 v3, 144, v1
    v_lshl_add_u32 v18, v2, 4, v3
    v_lshrrev_b32 v1, 3, v0
    v_add_u32 v1, 96, v1
    v_and_b32 v2, 7, v0
    v_mul_u32_u24 v3, 1152, v1
    v_lshl_add_u32 v11, v2, 4, v3
    v_mul_u32_u24 v3, 144, v1
    v_lshl_add_u32 v19, v2, 4, v3
    v_add_u32 v1, 0, v0
    v_lshrrev_b32 v2, 4, v1
    v_and_b32 v1, 15, v1
    v_mul_u32_u24 v3, 8192, v2
    v_lshl_add_u32 v12, v1, 4, v3
    v_mul_u32_u24 v3, 288, v2
    v_lshl_add_u32 v20, v1, 4, v3
    v_add_u32 v20, 18432, v20
    v_add_u32 v1, 256, v0
    v_lshrrev_b32 v2, 4, v1
    v_and_b32 v1, 15, v1
    v_mul_u32_u24 v3, 8192, v2
    v_lshl_add_u32 v13, v1, 4, v3
    v_mul_u32_u24 v3, 288, v2
    v_lshl_add_u32 v21, v1, 4, v3
    v_add_u32 v21, 18432, v21
    v_add_u32 v1, 512, v0
    v_lshrrev_b32 v2, 4, v1
    v_and_b32 v1, 15, v1
    v_mul_u32_u24 v3, 8192, v2
    v_lshl_add_u32 v14, v1, 4, v3
    v_mul_u32_u24 v3, 288, v2
    v_lshl_add_u32 v22, v1, 4, v3
    v_add_u32 v22, 18432, v22
    v_add_u32 v1, 768, v0
    v_lshrrev_b32 v2, 4, v1
    v_and_b32 v1, 15, v1
    v_mul_u32_u24 v3, 8192, v2
    v_lshl_add_u32 v15, v1, 4, v3
    v_mul_u32_u24 v3, 288, v2
    v_lshl_add_u32 v23, v1, 4, v3
    v_add_u32 v23, 18432, v23
    v_lshrrev_b32 v1, 6, v0
    v_and_b32 v2, 63, v0
    v_lshrrev_b32 v3, 1, v1
    v_mul_u32_u24 v3, 64, v3
    v_and_b32 v24, 15, v2
    v_add_u32 v3, v3, v24
    v_mul_u32_u24 v3, 144, v3
    v_lshrrev_b32 v24, 4, v2
    v_lshl_add_u32 v24, v24, 3, v3
    v_lshrrev_b32 v3, 4, v2
    v_lshlrev_b32 v3, 2, v3
    v_bfe_u32 v25, v2, 2, 2
    v_add_u32 v3, v3, v25
    v_mul_u32_u24 v3, 288, v3
    v_and_b32 v1, 1, v1
    v_mul_u32_u24 v1, 128, v1
    v_add_u32 v3, v3, v1
    v_and_b32 v1, 3, v2
    v_lshl_add_u32 v25, v1, 3, v3
    v_add_u32 v25, 18432, v25
    v_add_u32 v26, 36864, v24
    v_add_u32 v27, 36864, v25
    v_mov_b32 v156, 0
    v_mov_b32 v157, 0
    v_mov_b32 v158, 0
    v_mov_b32 v159, 0
    v_mov_b32 v160, 0
    v_mov_b32 v161, 0
    v_mov_b32 v162, 0
    v_mov_b32 v163, 0
    v_mov_b32 v164, 0
    v_mov_b32 v165, 0
    v_mov_b32 v166, 0
    v_mov_b32 v167, 0
    v_mov_b32 v168, 0
    v_mov_b32 v169, 0
    v_mov_b32 v170, 0
    v_mov_b32 v171, 0
    v_mov_b32 v172, 0
    v_mov_b32 v173, 0
    v_mov_b32 v174, 0
    v_mov_b32 v175, 0
    v_mov_b32 v176, 0
    v_mov_b32 v177, 0
    v_mov_b32 v178, 0
    v_mov_b32 v179, 0
    v_mov_b32 v180, 0
    v_mov_b32 v181, 0
    v_mov_b32 v182, 0
    v_mov_b32 v183, 0
    v_mov_b32 v184, 0
    v_mov_b32 v185, 0
    v_mov_b32 v186, 0
    v_mov_b32 v187, 0
    v_mov_b32 v188, 0
    v_mov_b32 v189, 0
    v_mov_b32 v190, 0
    v_mov_b32 v191, 0
    v_mov_b32 v192, 0
    v_mov_b32 v193, 0
    v_mov_b32 v194, 0
    v_mov_b32 v195, 0
    v_mov_b32 v196, 0
    v_mov_b32 v197, 0
    v_mov_b32 v198, 0
    v_mov_b32 v199, 0
    v_mov_b32 v200, 0
    v_mov_b32 v201, 0
    v_mov_b32 v202, 0
    v_mov_b32 v203, 0
    v_mov_b32 v204, 0
    v_mov_b32 v205, 0
    v_mov_b32 v206, 0
    v_mov_b32 v207, 0
    v_mov_b32 v208, 0
    v_mov_b32 v209, 0
    v_mov_b32 v210, 0
    v_mov_b32 v211, 0
    v_mov_b32 v212, 0
    v_mov_b32 v213, 0
    v_mov_b32 v214, 0
    v_mov_b32 v215, 0
    v_mov_b32 v216, 0
    v_mov_b32 v217, 0
    v_mov_b32 v218, 0
    v_mov_b32 v219, 0
    s_mov_b32 s48, 0
    s_mov_b32 s49, 0
    buffer_load_dwordx4 v[28:31], v8, s[40:43], s48 offen
    buffer_load_dwordx4 v[32:35], v9, s[40:43], s48 offen
    buffer_load_dwordx4 v[36:39], v10, s[40:43], s48 offen
    buffer_load_dwordx4 v[40:43], v11, s[40:43], s48 offen
    buffer_load_dwordx4 v[44:47], v12, s[44:47], s49 offen
    buffer_load_dwordx4 v[48:51], v13, s[44:47], s49 offen
    buffer_load_dwordx4 v[52:55], v14, s[44:47], s49 offen
    buffer_load_dwordx4 v[56:59], v15, s[44:47], s49 offen
    s_add_u32 s48, s48, 128
    s_add_u32 s49, s49, 0x80000
    buffer_load_dwordx4 v[60:63], v8, s[40:43], s48 offen
    buffer_load_dwordx4 v[64:67], v9, s[40:43], s48 offen
    buffer_load_dwordx4 v[68:71], v10, s[40:43], s48 offen
    buffer_load_dwordx4 v[72:75], v11, s[40:43], s48 offen
    buffer_load_dwordx4 v[76:79], v12, s[44:47], s49 offen
    buffer_load_dwordx4 v[80:83], v13, s[44:47], s49 offen
    buffer_load_dwordx4 v[84:87], v14, s[44:47], s49 offen
    buffer_load_dwordx4 v[88:91], v15, s[44:47], s49 offen
    s_add_u32 s48, s48, 128
    s_add_u32 s49, s49, 0x80000
    s_waitcnt vmcnt(8)
    s_barrier
    ds_write_b128 v16, v[28:31] offset:0
    ds_write_b128 v17, v[32:35] offset:0
    ds_write_b128 v18, v[36:39] offset:0
    ds_write_b128 v19, v[40:43] offset:0
    ds_write_b128 v20, v[44:47] offset:0
    ds_write_b128 v21, v[48:51] offset:0
    ds_write_b128 v22, v[52:55] offset:0
    ds_write_b128 v23, v[56:59] offset:0
    s_waitcnt lgkmcnt(0)
    s_barrier
    s_mov_b32 s50, 9
GL_5:
    buffer_load_dwordx4 v[28:31], v8, s[40:43], s48 offen
    buffer_load_dwordx4 v[32:35], v9, s[40:43], s48 offen
    buffer_load_dwordx4 v[36:39], v10, s[40:43], s48 offen
    buffer_load_dwordx4 v[40:43], v11, s[40:43], s48 offen
    buffer_load_dwordx4 v[44:47], v12, s[44:47], s49 offen
    buffer_load_dwordx4 v[48:51], v13, s[44:47], s49 offen
    buffer_load_dwordx4 v[52:55], v14, s[44:47], s49 offen
    buffer_load_dwordx4 v[56:59], v15, s[44:47], s49 offen
    s_add_u32 s48, s48, 128
    s_add_u32 s49, s49, 0x80000
    ds_read_b64 v[92:93], v24 offset:0
    ds_read_b64 v[94:95], v24 offset:32
    ds_read_b64 v[96:97], v24 offset:2304
    ds_read_b64 v[98:99], v24 offset:2336
    ds_read_b64 v[100:101], v24 offset:4608
    ds_read_b64 v[102:103], v24 offset:4640
    ds_read_b64 v[104:105], v24 offset:6912
    ds_read_b64 v[106:107], v24 offset:6944
    ds_read_b64_tr_b16 v[124:125], v25 offset:0
    ds_read_b64_tr_b16 v[126:127], v25 offset:4608
    ds_read_b64_tr_b16 v[128:129], v25 offset:32
    ds_read_b64_tr_b16 v[130:131], v25 offset:4640
    ds_read_b64_tr_b16 v[132:133], v25 offset:64
    ds_read_b64_tr_b16 v[134:135], v25 offset:4672
    ds_read_b64_tr_b16 v[136:137], v25 offset:96
    ds_read_b64_tr_b16 v[138:139], v25 offset:4704
    ds_read_b64 v[108:109], v24 offset:64
    ds_read_b64 v[110:111], v24 offset:96
    ds_read_b64 v[112:113], v24 offset:2368
    ds_read_b64 v[114:115], v24 offset:2400
    ds_read_b64 v[116:117], v24 offset:4672
    ds_read_b64 v[118:119], v24 offset:4704
    ds_read_b64 v[120:121], v24 offset:6976
    ds_read_b64 v[122:123], v24 offset:7008
    ds_read_b64_tr_b16 v[140:141], v25 offset:9216
    ds_read_b64_tr_b16 v[142:143], v25 offset:13824
    ds_read_b64_tr_b16 v[144:145], v25 offset:9248
    ds_read_b64_tr_b16 v[146:147], v25 offset:13856
    ds_read_b64_tr_b16 v[148:149], v25 offset:9280
    ds_read_b64_tr_b16 v[150:151], v25 offset:13888
    ds_read_b64_tr_b16 v[152:153], v25 offset:9312
    ds_read_b64_tr_b16 v[154:155], v25 offset:13920
    s_waitcnt lgkmcnt(15)
    v_mfma_f32_16x16x32_bf16 v[156:159], v[92:95], v[124:127], v[156:159]
    v_mfma_f32_16x16x32_bf16 v[160:163], v[92:95], v[128:131], v[160:163]
    v_mfma_f32_16x16x32_bf16 v[164:167], v[92:95], v[132:135], v[164:167]
    v_mfma_f32_16x16x32_bf16 v[168:171], v[92:95], v[136:139], v[168:171]
    v_mfma_f32_16x16x32_bf16 v[172:175], v[96:99], v[124:127], v[172:175]
    v_mfma_f32_16x16x32_bf16 v[176:179], v[96:99], v[128:131], v[176:179]
    v_mfma_f32_16x16x32_bf16 v[180:183], v[96:99], v[132:135], v[180:183]
    v_mfma_f32_16x16x32_bf16 v[184:187], v[96:99], v[136:139], v[184:187]
    v_mfma_f32_16x16x32_bf16 v[188:191], v[100:103], v[124:127], v[188:191]
    v_mfma_f32_16x16x32_bf16 v[192:195], v[100:103], v[128:131], v[192:195]
    v_mfma_f32_16x16x32_bf16 v[196:199], v[100:103], v[132:135], v[196:199]
    v_mfma_f32_16x16x32_bf16 v[200:203], v[100:103], v[136:139], v[200:203]
    v_mfma_f32_16x16x32_bf16 v[204:207], v[104:107], v[124:127], v[204:207]
    v_mfma_f32_16x16x32_bf16 v[208:211], v[104:107], v[128:131], v[208:211]
    v_mfma_f32_16x16x32_bf16 v[212:215], v[104:107], v[132:135], v[212:215]
    v_mfma_f32_16x16x32_bf16 v[216:219], v[104:107], v[136:139], v[216:219]
    s_waitcnt lgkmcnt(0)
    v_mfma_f32_16x16x32_bf16 v[156:159], v[108:111], v[140:143], v[156:159]
    v_mfma_f32_16x16x32_bf16 v[160:163], v[108:111], v[144:147], v[160:163]
    v_mfma_f32_16x16x32_bf16 v[164:167], v[108:111], v[148:151], v[164:167]
    v_mfma_f32_16x16x32_bf16 v[168:171], v[108:111], v[152:155], v[168:171]
    v_mfma_f32_16x16x32_bf16 v[172:175], v[112:115], v[140:143], v[172:175]
    v_mfma_f32_16x16x32_bf16 v[176:179], v[112:115], v[144:147], v[176:179]
    v_mfma_f32_16x16x32_bf16 v[180:183], v[112:115], v[148:151], v[180:183]
    v_mfma_f32_16x16x32_bf16 v[184:187], v[112:115], v[152:155], v[184:187]
    v_mfma_f32_16x16x32_bf16 v[188:191], v[116:119], v[140:143], v[188:191]
    v_mfma_f32_16x16x32_bf16 v[192:195], v[116:119], v[144:147], v[192:195]
    v_mfma_f32_16x16x32_bf16 v[196:199], v[116:119], v[148:151], v[196:199]
    v_mfma_f32_16x16x32_bf16 v[200:203], v[116:119], v[152:155], v[200:203]
    v_mfma_f32_16x16x32_bf16 v[204:207], v[120:123], v[140:143], v[204:207]
    v_mfma_f32_16x16x32_bf16 v[208:211], v[120:123], v[144:147], v[208:211]
    v_mfma_f32_16x16x32_bf16 v[212:215], v[120:123], v[148:151], v[212:215]
    v_mfma_f32_16x16x32_bf16 v[216:219], v[120:123], v[152:155], v[216:219]
    s_waitcnt vmcnt(8)
    ds_write_b128 v16, v[60:63] offset:36864
    ds_write_b128 v17, v[64:67] offset:36864
    ds_write_b128 v18, v[68:71] offset:36864
    ds_write_b128 v19, v[72:75] offset:36864
    ds_write_b128 v20, v[76:79] offset:36864
    ds_write_b128 v21, v[80:83] offset:36864
    ds_write_b128 v22, v[84:87] offset:36864
    ds_write_b128 v23, v[88:91] offset:36864
    s_waitcnt lgkmcnt(0)
    s_barrier
    s_sub_u32 s50, s50, 1
    s_cmp_eq_u32 s50, 0
    s_cbranch_scc1 GE_6
    buffer_load_dwordx4 v[60:63], v8, s[40:43], s48 offen
    buffer_load_dwordx4 v[64:67], v9, s[40:43], s48 offen
    buffer_load_dwordx4 v[68:71], v10, s[40:43], s48 offen
    buffer_load_dwordx4 v[72:75], v11, s[40:43], s48 offen
    buffer_load_dwordx4 v[76:79], v12, s[44:47], s49 offen
    buffer_load_dwordx4 v[80:83], v13, s[44:47], s49 offen
    buffer_load_dwordx4 v[84:87], v14, s[44:47], s49 offen
    buffer_load_dwordx4 v[88:91], v15, s[44:47], s49 offen
    s_add_u32 s48, s48, 128
    s_add_u32 s49, s49, 0x80000
    ds_read_b64 v[92:93], v26 offset:0
    ds_read_b64 v[94:95], v26 offset:32
    ds_read_b64 v[96:97], v26 offset:2304
    ds_read_b64 v[98:99], v26 offset:2336
    ds_read_b64 v[100:101], v26 offset:4608
    ds_read_b64 v[102:103], v26 offset:4640
    ds_read_b64 v[104:105], v26 offset:6912
    ds_read_b64 v[106:107], v26 offset:6944
    ds_read_b64_tr_b16 v[124:125], v27 offset:0
    ds_read_b64_tr_b16 v[126:127], v27 offset:4608
    ds_read_b64_tr_b16 v[128:129], v27 offset:32
    ds_read_b64_tr_b16 v[130:131], v27 offset:4640
    ds_read_b64_tr_b16 v[132:133], v27 offset:64
    ds_read_b64_tr_b16 v[134:135], v27 offset:4672
    ds_read_b64_tr_b16 v[136:137], v27 offset:96
    ds_read_b64_tr_b16 v[138:139], v27 offset:4704
    ds_read_b64 v[108:109], v26 offset:64
    ds_read_b64 v[110:111], v26 offset:96
    ds_read_b64 v[112:113], v26 offset:2368
    ds_read_b64 v[114:115], v26 offset:2400
    ds_read_b64 v[116:117], v26 offset:4672
    ds_read_b64 v[118:119], v26 offset:4704
    ds_read_b64 v[120:121], v26 offset:6976
    ds_read_b64 v[122:123], v26 offset:7008
    ds_read_b64_tr_b16 v[140:141], v27 offset:9216
    ds_read_b64_tr_b16 v[142:143], v27 offset:13824
    ds_read_b64_tr_b16 v[144:145], v27 offset:9248
    ds_read_b64_tr_b16 v[146:147], v27 offset:13856
    ds_read_b64_tr_b16 v[148:149], v27 offset:9280
    ds_read_b64_tr_b16 v[150:151], v27 offset:13888
    ds_read_b64_tr_b16 v[152:153], v27 offset:9312
    ds_read_b64_tr_b16 v[154:155], v27 offset:13920
    s_waitcnt lgkmcnt(15)
    v_mfma_f32_16x16x32_bf16 v[156:159], v[92:95], v[124:127], v[156:159]
    v_mfma_f32_16x16x32_bf16 v[160:163], v[92:95], v[128:131], v[160:163]
    v_mfma_f32_16x16x32_bf16 v[164:167], v[92:95], v[132:135], v[164:167]
    v_mfma_f32_16x16x32_bf16 v[168:171], v[92:95], v[136:139], v[168:171]
    v_mfma_f32_16x16x32_bf16 v[172:175], v[96:99], v[124:127], v[172:175]
    v_mfma_f32_16x16x32_bf16 v[176:179], v[96:99], v[128:131], v[176:179]
    v_mfma_f32_16x16x32_bf16 v[180:183], v[96:99], v[132:135], v[180:183]
    v_mfma_f32_16x16x32_bf16 v[184:187], v[96:99], v[136:139], v[184:187]
    v_mfma_f32_16x16x32_bf16 v[188:191], v[100:103], v[124:127], v[188:191]
    v_mfma_f32_16x16x32_bf16 v[192:195], v[100:103], v[128:131], v[192:195]
    v_mfma_f32_16x16x32_bf16 v[196:199], v[100:103], v[132:135], v[196:199]
    v_mfma_f32_16x16x32_bf16 v[200:203], v[100:103], v[136:139], v[200:203]
    v_mfma_f32_16x16x32_bf16 v[204:207], v[104:107], v[124:127], v[204:207]
    v_mfma_f32_16x16x32_bf16 v[208:211], v[104:107], v[128:131], v[208:211]
    v_mfma_f32_16x16x32_bf16 v[212:215], v[104:107], v[132:135], v[212:215]
    v_mfma_f32_16x16x32_bf16 v[216:219], v[104:107], v[136:139], v[216:219]
    s_waitcnt lgkmcnt(0)
    v_mfma_f32_16x16x32_bf16 v[156:159], v[108:111], v[140:143], v[156:159]
    v_mfma_f32_16x16x32_bf16 v[160:163], v[108:111], v[144:147], v[160:163]
    v_mfma_f32_16x16x32_bf16 v[164:167], v[108:111], v[148:151], v[164:167]
    v_mfma_f32_16x16x32_bf16 v[168:171], v[108:111], v[152:155], v[168:171]
    v_mfma_f32_16x16x32_bf16 v[172:175], v[112:115], v[140:143], v[172:175]
    v_mfma_f32_16x16x32_bf16 v[176:179], v[112:115], v[144:147], v[176:179]
    v_mfma_f32_16x16x32_bf16 v[180:183], v[112:115], v[148:151], v[180:183]
    v_mfma_f32_16x16x32_bf16 v[184:187], v[112:115], v[152:155], v[184:187]
    v_mfma_f32_16x16x32_bf16 v[188:191], v[116:119], v[140:143], v[188:191]
    v_mfma_f32_16x16x32_bf16 v[192:195], v[116:119], v[144:147], v[192:195]
    v_mfma_f32_16x16x32_bf16 v[196:199], v[116:119], v[148:151], v[196:199]
    v_mfma_f32_16x16x32_bf16 v[200:203], v[116:119], v[152:155], v[200:203]
    v_mfma_f32_16x16x32_bf16 v[204:207], v[120:123], v[140:143], v[204:207]
    v_mfma_f32_16x16x32_bf16 v[208:211], v[120:123], v[144:147], v[208:211]
    v_mfma_f32_16x16x32_bf16 v[212:215], v[120:123], v[148:151], v[212:215]
    v_mfma_f32_16x16x32_bf16 v[216:219], v[120:123], v[152:155], v[216:219]
    s_waitcnt vmcnt(8)
    ds_write_b128 v16, v[28:31] offset:0
    ds_write_b128 v17, v[32:35] offset:0
    ds_write_b128 v18, v[36:39] offset:0
    ds_write_b128 v19, v[40:43] offset:0
    ds_write_b128 v20, v[44:47] offset:0
    ds_write_b128 v21, v[48:51] offset:0
    ds_write_b128 v22, v[52:55] offset:0
    ds_write_b128 v23, v[56:59] offset:0
    s_waitcnt lgkmcnt(0)
    s_barrier
    s_sub_u32 s50, s50, 1
    s_cmp_lg_u32 s50, 0
    s_cbranch_scc1 GL_5
GE_6:
    s_waitcnt vmcnt(0)
    s_nop 7
    s_nop 7
    s_lshl_b32 s39, s38, 19
    s_lshl_b32 s52, s37, 8
    s_add_u32 s39, s39, s52
    s_add_u32 s39, s39, 0x2000000
    s_add_u32 s52, s34, s39
    s_addc_u32 s53, s35, 0
    s_mov_b32 s54, 0x80000
    s_mov_b32 s55, 0x00020000
    v_lshrrev_b32 v1, 6, v0
    v_and_b32 v2, 63, v0
    v_lshrrev_b32 v3, 1, v1
    v_and_b32 v1, 1, v1
    v_mul_u32_u24 v3, 64, v3
    v_mul_u32_u24 v1, 64, v1
    v_and_b32 v4, 15, v2
    v_lshrrev_b32 v2, 4, v2
    v_lshlrev_b32 v2, 2, v2
    v_add_u32 v1, v1, v4
    v_add_u32 v3, v3, v2
    v_mul_u32_u24 v1, 4096, v1
    v_lshl_add_u32 v4, v3, 1, v1
    v_cvt_pk_bf16_f32 v156, v156, v157
    v_cvt_pk_bf16_f32 v157, v158, v159
    s_mov_b32 s51, 0x0
    buffer_store_dwordx2 v[156:157], v4, s[52:55], s51 offen offset:0 sc1
    v_cvt_pk_bf16_f32 v160, v160, v161
    v_cvt_pk_bf16_f32 v161, v162, v163
    s_mov_b32 s51, 0x10000
    buffer_store_dwordx2 v[160:161], v4, s[52:55], s51 offen offset:0 sc1
    v_cvt_pk_bf16_f32 v164, v164, v165
    v_cvt_pk_bf16_f32 v165, v166, v167
    s_mov_b32 s51, 0x20000
    buffer_store_dwordx2 v[164:165], v4, s[52:55], s51 offen offset:0 sc1
    v_cvt_pk_bf16_f32 v168, v168, v169
    v_cvt_pk_bf16_f32 v169, v170, v171
    s_mov_b32 s51, 0x30000
    buffer_store_dwordx2 v[168:169], v4, s[52:55], s51 offen offset:0 sc1
    v_cvt_pk_bf16_f32 v172, v172, v173
    v_cvt_pk_bf16_f32 v173, v174, v175
    s_mov_b32 s51, 0x0
    buffer_store_dwordx2 v[172:173], v4, s[52:55], s51 offen offset:32 sc1
    v_cvt_pk_bf16_f32 v176, v176, v177
    v_cvt_pk_bf16_f32 v177, v178, v179
    s_mov_b32 s51, 0x10000
    buffer_store_dwordx2 v[176:177], v4, s[52:55], s51 offen offset:32 sc1
    v_cvt_pk_bf16_f32 v180, v180, v181
    v_cvt_pk_bf16_f32 v181, v182, v183
    s_mov_b32 s51, 0x20000
    buffer_store_dwordx2 v[180:181], v4, s[52:55], s51 offen offset:32 sc1
    v_cvt_pk_bf16_f32 v184, v184, v185
    v_cvt_pk_bf16_f32 v185, v186, v187
    s_mov_b32 s51, 0x30000
    buffer_store_dwordx2 v[184:185], v4, s[52:55], s51 offen offset:32 sc1
    v_cvt_pk_bf16_f32 v188, v188, v189
    v_cvt_pk_bf16_f32 v189, v190, v191
    s_mov_b32 s51, 0x0
    buffer_store_dwordx2 v[188:189], v4, s[52:55], s51 offen offset:64 sc1
    v_cvt_pk_bf16_f32 v192, v192, v193
    v_cvt_pk_bf16_f32 v193, v194, v195
    s_mov_b32 s51, 0x10000
    buffer_store_dwordx2 v[192:193], v4, s[52:55], s51 offen offset:64 sc1
    v_cvt_pk_bf16_f32 v196, v196, v197
    v_cvt_pk_bf16_f32 v197, v198, v199
    s_mov_b32 s51, 0x20000
    buffer_store_dwordx2 v[196:197], v4, s[52:55], s51 offen offset:64 sc1
    v_cvt_pk_bf16_f32 v200, v200, v201
    v_cvt_pk_bf16_f32 v201, v202, v203
    s_mov_b32 s51, 0x30000
    buffer_store_dwordx2 v[200:201], v4, s[52:55], s51 offen offset:64 sc1
    v_cvt_pk_bf16_f32 v204, v204, v205
    v_cvt_pk_bf16_f32 v205, v206, v207
    s_mov_b32 s51, 0x0
    buffer_store_dwordx2 v[204:205], v4, s[52:55], s51 offen offset:96 sc1
    v_cvt_pk_bf16_f32 v208, v208, v209
    v_cvt_pk_bf16_f32 v209, v210, v211
    s_mov_b32 s51, 0x10000
    buffer_store_dwordx2 v[208:209], v4, s[52:55], s51 offen offset:96 sc1
    v_cvt_pk_bf16_f32 v212, v212, v213
    v_cvt_pk_bf16_f32 v213, v214, v215
    s_mov_b32 s51, 0x20000
    buffer_store_dwordx2 v[212:213], v4, s[52:55], s51 offen offset:96 sc1
    v_cvt_pk_bf16_f32 v216, v216, v217
    v_cvt_pk_bf16_f32 v217, v218, v219
    s_mov_b32 s51, 0x30000
    buffer_store_dwordx2 v[216:217], v4, s[52:55], s51 offen offset:96 sc1
TE_2:
    s_cmp_ge_u32 s89, 1024
    s_cbranch_scc1 KW_next
    s_waitcnt vmcnt(0)
    s_barrier
    s_cmp_lg_u32 s4, 0
    s_cbranch_scc1 KW_next
    s_mov_b32 exec_lo, 1
    s_mov_b32 exec_hi, 0
    s_lshl_b32 s39, s37, 2
    s_add_u32 s39, s39, 64
    v_mov_b32 v2, s39
    v_mov_b32 v3, 1
    global_atomic_add v2, v3, s[32:33]
    s_mov_b64 exec, -1
    s_branch KW_next
KW_b:
    s_sub_u32 s39, s89, 1024
    s_and_b32 s37, s39, 15
    s_lshr_b32 s38, s39, 4
    s_mul_i32 s39, s37, 147456
    s_add_u32 s40, s8, s39
    s_addc_u32 s41, s9, 0
    s_mov_b32 s42, 147456
    s_mov_b32 s43, 0x00020000
    s_mul_i32 s39, s38, 384
    s_add_u32 s44, s24, s39
    s_addc_u32 s45, s25, 0
    s_sub_u32 s46, 1990656, s39
    s_mov_b32 s47, 0x00020000
    s_cmp_ge_u32 s38, 6
    s_cbranch_scc1 TV_7
    v_lshrrev_b32 v1, 3, v0
    v_add_u32 v1, 0, v1
    v_and_b32 v2, 7, v0
    v_mul_u32_u24 v3, 1152, v1
    v_lshl_add_u32 v8, v2, 4, v3
    v_mul_u32_u24 v3, 144, v1
    v_lshl_add_u32 v18, v2, 4, v3
    v_lshrrev_b32 v1, 3, v0
    v_add_u32 v1, 32, v1
    v_and_b32 v2, 7, v0
    v_mul_u32_u24 v3, 1152, v1
    v_lshl_add_u32 v9, v2, 4, v3
    v_mul_u32_u24 v3, 144, v1
    v_lshl_add_u32 v19, v2, 4, v3
    v_lshrrev_b32 v1, 3, v0
    v_add_u32 v1, 64, v1
    v_and_b32 v2, 7, v0
    v_mul_u32_u24 v3, 1152, v1
    v_lshl_add_u32 v10, v2, 4, v3
    v_mul_u32_u24 v3, 144, v1
    v_lshl_add_u32 v20, v2, 4, v3
    v_lshrrev_b32 v1, 3, v0
    v_add_u32 v1, 96, v1
    v_and_b32 v2, 7, v0
    v_mul_u32_u24 v3, 1152, v1
    v_lshl_add_u32 v11, v2, 4, v3
    v_mul_u32_u24 v3, 144, v1
    v_lshl_add_u32 v21, v2, 4, v3
    v_add_u32 v1, 0, v0
    v_mul_u32_u24 v2, 43691, v1
    v_lshrrev_b32 v2, 20, v2
    v_mul_u32_u24 v3, 24, v2
    v_sub_u32 v1, v1, v3
    v_mul_u32_u24 v3, 3456, v2
    v_lshl_add_u32 v12, v1, 4, v3
    v_mul_u32_u24 v3, 416, v2
    v_lshl_add_u32 v22, v1, 4, v3
    v_add_u32 v22, 18432, v22
    v_add_u32 v1, 256, v0
    v_mul_u32_u24 v2, 43691, v1
    v_lshrrev_b32 v2, 20, v2
    v_mul_u32_u24 v3, 24, v2
    v_sub_u32 v1, v1, v3
    v_mul_u32_u24 v3, 3456, v2
    v_lshl_add_u32 v13, v1, 4, v3
    v_mul_u32_u24 v3, 416, v2
    v_lshl_add_u32 v23, v1, 4, v3
    v_add_u32 v23, 18432, v23
    v_add_u32 v1, 512, v0
    v_mul_u32_u24 v2, 43691, v1
    v_lshrrev_b32 v2, 20, v2
    v_mul_u32_u24 v3, 24, v2
    v_sub_u32 v1, v1, v3
    v_mul_u32_u24 v3, 3456, v2
    v_lshl_add_u32 v14, v1, 4, v3
    v_mul_u32_u24 v3, 416, v2
    v_lshl_add_u32 v24, v1, 4, v3
    v_add_u32 v24, 18432, v24
    v_add_u32 v1, 768, v0
    v_mul_u32_u24 v2, 43691, v1
    v_lshrrev_b32 v2, 20, v2
    v_mul_u32_u24 v3, 24, v2
    v_sub_u32 v1, v1, v3
    v_mul_u32_u24 v3, 3456, v2
    v_lshl_add_u32 v15, v1, 4, v3
    v_mul_u32_u24 v3, 416, v2
    v_lshl_add_u32 v25, v1, 4, v3
    v_add_u32 v25, 18432, v25
    v_add_u32 v1, 1024, v0
    v_mul_u32_u24 v2, 43691, v1
    v_lshrrev_b32 v2, 20, v2
    v_mul_u32_u24 v3, 24, v2
    v_sub_u32 v1, v1, v3
    v_mul_u32_u24 v3, 3456, v2
    v_lshl_add_u32 v16, v1, 4, v3
    v_mul_u32_u24 v3, 416, v2
    v_lshl_add_u32 v26, v1, 4, v3
    v_add_u32 v26, 18432, v26
    v_add_u32 v1, 1280, v0
    v_mul_u32_u24 v2, 43691, v1
    v_lshrrev_b32 v2, 20, v2
    v_mul_u32_u24 v3, 24, v2
    v_sub_u32 v1, v1, v3
    v_mul_u32_u24 v3, 3456, v2
    v_lshl_add_u32 v17, v1, 4, v3
    v_mul_u32_u24 v3, 416, v2
    v_lshl_add_u32 v27, v1, 4, v3
    v_add_u32 v27, 18432, v27
    v_lshrrev_b32 v1, 6, v0
    v_and_b32 v2, 63, v0
    v_lshrrev_b32 v3, 1, v1
    v_mul_u32_u24 v3, 64, v3
    v_and_b32 v28, 15, v2
    v_add_u32 v3, v3, v28
    v_mul_u32_u24 v3, 144, v3
    v_lshrrev_b32 v28, 4, v2
    v_lshl_add_u32 v28, v28, 3, v3
    v_lshrrev_b32 v3, 4, v2
    v_lshlrev_b32 v3, 2, v3
    v_bfe_u32 v29, v2, 2, 2
    v_add_u32 v3, v3, v29
    v_mul_u32_u24 v3, 416, v3
    v_and_b32 v1, 1, v1
    v_mul_u32_u24 v1, 192, v1
    v_add_u32 v3, v3, v1
    v_and_b32 v1, 3, v2
    v_lshl_add_u32 v29, v1, 3, v3
    v_add_u32 v29, 18432, v29
    v_add_u32 v30, 45056, v28
    v_add_u32 v31, 45056, v29
    v_mov_b32 v152, 0
    v_mov_b32 v153, 0
    v_mov_b32 v154, 0
    v_mov_b32 v155, 0
    v_mov_b32 v156, 0
    v_mov_b32 v157, 0
    v_mov_b32 v158, 0
    v_mov_b32 v159, 0
    v_mov_b32 v160, 0
    v_mov_b32 v161, 0
    v_mov_b32 v162, 0
    v_mov_b32 v163, 0
    v_mov_b32 v164, 0
    v_mov_b32 v165, 0
    v_mov_b32 v166, 0
    v_mov_b32 v167, 0
    v_mov_b32 v168, 0
    v_mov_b32 v169, 0
    v_mov_b32 v170, 0
    v_mov_b32 v171, 0
    v_mov_b32 v172, 0
    v_mov_b32 v173, 0
    v_mov_b32 v174, 0
    v_mov_b32 v175, 0
    v_mov_b32 v176, 0
    v_mov_b32 v177, 0
    v_mov_b32 v178, 0
    v_mov_b32 v179, 0
    v_mov_b32 v180, 0
    v_mov_b32 v181, 0
    v_mov_b32 v182, 0
    v_mov_b32 v183, 0
    v_mov_b32 v184, 0
    v_mov_b32 v185, 0
    v_mov_b32 v186, 0
    v_mov_b32 v187, 0
    v_mov_b32 v188, 0
    v_mov_b32 v189, 0
    v_mov_b32 v190, 0
    v_mov_b32 v191, 0
    v_mov_b32 v192, 0
    v_mov_b32 v193, 0
    v_mov_b32 v194, 0
    v_mov_b32 v195, 0
    v_mov_b32 v196, 0
    v_mov_b32 v197, 0
    v_mov_b32 v198, 0
    v_mov_b32 v199, 0
    v_mov_b32 v200, 0
    v_mov_b32 v201, 0
    v_mov_b32 v202, 0
    v_mov_b32 v203, 0
    v_mov_b32 v204, 0
    v_mov_b32 v205, 0
    v_mov_b32 v206, 0
    v_mov_b32 v207, 0
    v_mov_b32 v208, 0
    v_mov_b32 v209, 0
    v_mov_b32 v210, 0
    v_mov_b32 v211, 0
    v_mov_b32 v212, 0
    v_mov_b32 v213, 0
    v_mov_b32 v214, 0
    v_mov_b32 v215, 0
    v_mov_b32 v216, 0
    v_mov_b32 v217, 0
    v_mov_b32 v218, 0
    v_mov_b32 v219, 0
    v_mov_b32 v220, 0
    v_mov_b32 v221, 0
    v_mov_b32 v222, 0
    v_mov_b32 v223, 0
    v_mov_b32 v224, 0
    v_mov_b32 v225, 0
    v_mov_b32 v226, 0
    v_mov_b32 v227, 0
    v_mov_b32 v228, 0
    v_mov_b32 v229, 0
    v_mov_b32 v230, 0
    v_mov_b32 v231, 0
    v_mov_b32 v232, 0
    v_mov_b32 v233, 0
    v_mov_b32 v234, 0
    v_mov_b32 v235, 0
    v_mov_b32 v236, 0
    v_mov_b32 v237, 0
    v_mov_b32 v238, 0
    v_mov_b32 v239, 0
    v_mov_b32 v240, 0
    v_mov_b32 v241, 0
    v_mov_b32 v242, 0
    v_mov_b32 v243, 0
    v_mov_b32 v244, 0
    v_mov_b32 v245, 0
    v_mov_b32 v246, 0
    v_mov_b32 v247, 0
    s_mov_b32 s48, 0
    s_mov_b32 s49, 0
    buffer_load_dwordx4 v[32:35], v8, s[40:43], s48 offen
    buffer_load_dwordx4 v[36:39], v9, s[40:43], s48 offen
    buffer_load_dwordx4 v[40:43], v10, s[40:43], s48 offen
    buffer_load_dwordx4 v[44:47], v11, s[40:43], s48 offen
    buffer_load_dwordx4 v[48:51], v12, s[44:47], s49 offen
    buffer_load_dwordx4 v[52:55], v13, s[44:47], s49 offen
    buffer_load_dwordx4 v[56:59], v14, s[44:47], s49 offen
    buffer_load_dwordx4 v[60:63], v15, s[44:47], s49 offen
    buffer_load_dwordx4 v[64:67], v16, s[44:47], s49 offen
    buffer_load_dwordx4 v[68:71], v17, s[44:47], s49 offen
    s_add_u32 s48, s48, 128
    s_add_u32 s49, s49, 0x36000
    buffer_load_dwordx4 v[72:75], v8, s[40:43], s48 offen
    buffer_load_dwordx4 v[76:79], v9, s[40:43], s48 offen
    buffer_load_dwordx4 v[80:83], v10, s[40:43], s48 offen
    buffer_load_dwordx4 v[84:87], v11, s[40:43], s48 offen
    buffer_load_dwordx4 v[88:91], v12, s[44:47], s49 offen
    buffer_load_dwordx4 v[92:95], v13, s[44:47], s49 offen
    buffer_load_dwordx4 v[96:99], v14, s[44:47], s49 offen
    buffer_load_dwordx4 v[100:103], v15, s[44:47], s49 offen
    buffer_load_dwordx4 v[104:107], v16, s[44:47], s49 offen
    buffer_load_dwordx4 v[108:111], v17, s[44:47], s49 offen
    s_add_u32 s48, s48, 128
    s_add_u32 s49, s49, 0x36000
    s_waitcnt vmcnt(10)
    s_barrier
    ds_write_b128 v18, v[32:35] offset:0
    ds_write_b128 v19, v[36:39] offset:0
    ds_write_b128 v20, v[40:43] offset:0
    ds_write_b128 v21, v[44:47] offset:0
    ds_write_b128 v22, v[48:51] offset:0
    ds_write_b128 v23, v[52:55] offset:0
    ds_write_b128 v24, v[56:59] offset:0
    ds_write_b128 v25, v[60:63] offset:0
    ds_write_b128 v26, v[64:67] offset:0
    ds_write_b128 v27, v[68:71] offset:0
    s_waitcnt lgkmcnt(0)
    s_barrier
    s_mov_b32 s50, 9
GL_9:
    buffer_load_dwordx4 v[32:35], v8, s[40:43], s48 offen
    buffer_load_dwordx4 v[36:39], v9, s[40:43], s48 offen
    buffer_load_dwordx4 v[40:43], v10, s[40:43], s48 offen
    buffer_load_dwordx4 v[44:47], v11, s[40:43], s48 offen
    buffer_load_dwordx4 v[48:51], v12, s[44:47], s49 offen
    buffer_load_dwordx4 v[52:55], v13, s[44:47], s49 offen
    buffer_load_dwordx4 v[56:59], v14, s[44:47], s49 offen
    buffer_load_dwordx4 v[60:63], v15, s[44:47], s49 offen
    buffer_load_dwordx4 v[64:67], v16, s[44:47], s49 offen
    buffer_load_dwordx4 v[68:71], v17, s[44:47], s49 offen
    s_add_u32 s48, s48, 128
    s_add_u32 s49, s49, 0x36000
    ds_read_b64 v[112:113], v28 offset:0
    ds_read_b64 v[114:115], v28 offset:32
    ds_read_b64 v[116:117], v28 offset:2304
    ds_read_b64 v[118:119], v28 offset:2336
    ds_read_b64 v[120:121], v28 offset:4608
    ds_read_b64 v[122:123], v28 offset:4640
    ds_read_b64 v[124:125], v28 offset:6912
    ds_read_b64 v[126:127], v28 offset:6944
    ds_read_b64_tr_b16 v[128:129], v29 offset:0
    ds_read_b64_tr_b16 v[130:131], v29 offset:6656
    ds_read_b64_tr_b16 v[132:133], v29 offset:32
    ds_read_b64_tr_b16 v[134:135], v29 offset:6688
    ds_read_b64_tr_b16 v[136:137], v29 offset:64
    ds_read_b64_tr_b16 v[138:139], v29 offset:6720
    ds_read_b64_tr_b16 v[140:141], v29 offset:96
    ds_read_b64_tr_b16 v[142:143], v29 offset:6752
    ds_read_b64_tr_b16 v[144:145], v29 offset:128
    ds_read_b64_tr_b16 v[146:147], v29 offset:6784
    ds_read_b64_tr_b16 v[148:149], v29 offset:160
    ds_read_b64_tr_b16 v[150:151], v29 offset:6816
    s_waitcnt lgkmcnt(0)
    v_mfma_f32_16x16x32_bf16 v[152:155], v[128:131], v[112:115], v[152:155]
    v_mfma_f32_16x16x32_bf16 v[156:159], v[132:135], v[112:115], v[156:159]
    v_mfma_f32_16x16x32_bf16 v[160:163], v[136:139], v[112:115], v[160:163]
    v_mfma_f32_16x16x32_bf16 v[164:167], v[140:143], v[112:115], v[164:167]
    v_mfma_f32_16x16x32_bf16 v[168:171], v[144:147], v[112:115], v[168:171]
    v_mfma_f32_16x16x32_bf16 v[172:175], v[148:151], v[112:115], v[172:175]
    v_mfma_f32_16x16x32_bf16 v[176:179], v[128:131], v[116:119], v[176:179]
    v_mfma_f32_16x16x32_bf16 v[180:183], v[132:135], v[116:119], v[180:183]
    v_mfma_f32_16x16x32_bf16 v[184:187], v[136:139], v[116:119], v[184:187]
    v_mfma_f32_16x16x32_bf16 v[188:191], v[140:143], v[116:119], v[188:191]
    v_mfma_f32_16x16x32_bf16 v[192:195], v[144:147], v[116:119], v[192:195]
    v_mfma_f32_16x16x32_bf16 v[196:199], v[148:151], v[116:119], v[196:199]
    v_mfma_f32_16x16x32_bf16 v[200:203], v[128:131], v[120:123], v[200:203]
    v_mfma_f32_16x16x32_bf16 v[204:207], v[132:135], v[120:123], v[204:207]
    v_mfma_f32_16x16x32_bf16 v[208:211], v[136:139], v[120:123], v[208:211]
    v_mfma_f32_16x16x32_bf16 v[212:215], v[140:143], v[120:123], v[212:215]
    v_mfma_f32_16x16x32_bf16 v[216:219], v[144:147], v[120:123], v[216:219]
    v_mfma_f32_16x16x32_bf16 v[220:223], v[148:151], v[120:123], v[220:223]
    v_mfma_f32_16x16x32_bf16 v[224:227], v[128:131], v[124:127], v[224:227]
    v_mfma_f32_16x16x32_bf16 v[228:231], v[132:135], v[124:127], v[228:231]
    v_mfma_f32_16x16x32_bf16 v[232:235], v[136:139], v[124:127], v[232:235]
    v_mfma_f32_16x16x32_bf16 v[236:239], v[140:143], v[124:127], v[236:239]
    v_mfma_f32_16x16x32_bf16 v[240:243], v[144:147], v[124:127], v[240:243]
    v_mfma_f32_16x16x32_bf16 v[244:247], v[148:151], v[124:127], v[244:247]
    ds_read_b64 v[112:113], v28 offset:64
    ds_read_b64 v[114:115], v28 offset:96
    ds_read_b64 v[116:117], v28 offset:2368
    ds_read_b64 v[118:119], v28 offset:2400
    ds_read_b64 v[120:121], v28 offset:4672
    ds_read_b64 v[122:123], v28 offset:4704
    ds_read_b64 v[124:125], v28 offset:6976
    ds_read_b64 v[126:127], v28 offset:7008
    ds_read_b64_tr_b16 v[128:129], v29 offset:13312
    ds_read_b64_tr_b16 v[130:131], v29 offset:19968
    ds_read_b64_tr_b16 v[132:133], v29 offset:13344
    ds_read_b64_tr_b16 v[134:135], v29 offset:20000
    ds_read_b64_tr_b16 v[136:137], v29 offset:13376
    ds_read_b64_tr_b16 v[138:139], v29 offset:20032
    ds_read_b64_tr_b16 v[140:141], v29 offset:13408
    ds_read_b64_tr_b16 v[142:143], v29 offset:20064
    ds_read_b64_tr_b16 v[144:145], v29 offset:13440
    ds_read_b64_tr_b16 v[146:147], v29 offset:20096
    ds_read_b64_tr_b16 v[148:149], v29 offset:13472
    ds_read_b64_tr_b16 v[150:151], v29 offset:20128
    s_waitcnt lgkmcnt(0)
    v_mfma_f32_16x16x32_bf16 v[152:155], v[128:131], v[112:115], v[152:155]
    v_mfma_f32_16x16x32_bf16 v[156:159], v[132:135], v[112:115], v[156:159]
    v_mfma_f32_16x16x32_bf16 v[160:163], v[136:139], v[112:115], v[160:163]
    v_mfma_f32_16x16x32_bf16 v[164:167], v[140:143], v[112:115], v[164:167]
    v_mfma_f32_16x16x32_bf16 v[168:171], v[144:147], v[112:115], v[168:171]
    v_mfma_f32_16x16x32_bf16 v[172:175], v[148:151], v[112:115], v[172:175]
    v_mfma_f32_16x16x32_bf16 v[176:179], v[128:131], v[116:119], v[176:179]
    v_mfma_f32_16x16x32_bf16 v[180:183], v[132:135], v[116:119], v[180:183]
    v_mfma_f32_16x16x32_bf16 v[184:187], v[136:139], v[116:119], v[184:187]
    v_mfma_f32_16x16x32_bf16 v[188:191], v[140:143], v[116:119], v[188:191]
    v_mfma_f32_16x16x32_bf16 v[192:195], v[144:147], v[116:119], v[192:195]
    v_mfma_f32_16x16x32_bf16 v[196:199], v[148:151], v[116:119], v[196:199]
    v_mfma_f32_16x16x32_bf16 v[200:203], v[128:131], v[120:123], v[200:203]
    v_mfma_f32_16x16x32_bf16 v[204:207], v[132:135], v[120:123], v[204:207]
    v_mfma_f32_16x16x32_bf16 v[208:211], v[136:139], v[120:123], v[208:211]
    v_mfma_f32_16x16x32_bf16 v[212:215], v[140:143], v[120:123], v[212:215]
    v_mfma_f32_16x16x32_bf16 v[216:219], v[144:147], v[120:123], v[216:219]
    v_mfma_f32_16x16x32_bf16 v[220:223], v[148:151], v[120:123], v[220:223]
    v_mfma_f32_16x16x32_bf16 v[224:227], v[128:131], v[124:127], v[224:227]
    v_mfma_f32_16x16x32_bf16 v[228:231], v[132:135], v[124:127], v[228:231]
    v_mfma_f32_16x16x32_bf16 v[232:235], v[136:139], v[124:127], v[232:235]
    v_mfma_f32_16x16x32_bf16 v[236:239], v[140:143], v[124:127], v[236:239]
    v_mfma_f32_16x16x32_bf16 v[240:243], v[144:147], v[124:127], v[240:243]
    v_mfma_f32_16x16x32_bf16 v[244:247], v[148:151], v[124:127], v[244:247]
    s_waitcnt vmcnt(10)
    ds_write_b128 v18, v[72:75] offset:45056
    ds_write_b128 v19, v[76:79] offset:45056
    ds_write_b128 v20, v[80:83] offset:45056
    ds_write_b128 v21, v[84:87] offset:45056
    ds_write_b128 v22, v[88:91] offset:45056
    ds_write_b128 v23, v[92:95] offset:45056
    ds_write_b128 v24, v[96:99] offset:45056
    ds_write_b128 v25, v[100:103] offset:45056
    ds_write_b128 v26, v[104:107] offset:45056
    ds_write_b128 v27, v[108:111] offset:45056
    s_waitcnt lgkmcnt(0)
    s_barrier
    s_sub_u32 s50, s50, 1
    s_cmp_eq_u32 s50, 0
    s_cbranch_scc1 GE_10
    buffer_load_dwordx4 v[72:75], v8, s[40:43], s48 offen
    buffer_load_dwordx4 v[76:79], v9, s[40:43], s48 offen
    buffer_load_dwordx4 v[80:83], v10, s[40:43], s48 offen
    buffer_load_dwordx4 v[84:87], v11, s[40:43], s48 offen
    buffer_load_dwordx4 v[88:91], v12, s[44:47], s49 offen
    buffer_load_dwordx4 v[92:95], v13, s[44:47], s49 offen
    buffer_load_dwordx4 v[96:99], v14, s[44:47], s49 offen
    buffer_load_dwordx4 v[100:103], v15, s[44:47], s49 offen
    buffer_load_dwordx4 v[104:107], v16, s[44:47], s49 offen
    buffer_load_dwordx4 v[108:111], v17, s[44:47], s49 offen
    s_add_u32 s48, s48, 128
    s_add_u32 s49, s49, 0x36000
    ds_read_b64 v[112:113], v30 offset:0
    ds_read_b64 v[114:115], v30 offset:32
    ds_read_b64 v[116:117], v30 offset:2304
    ds_read_b64 v[118:119], v30 offset:2336
    ds_read_b64 v[120:121], v30 offset:4608
    ds_read_b64 v[122:123], v30 offset:4640
    ds_read_b64 v[124:125], v30 offset:6912
    ds_read_b64 v[126:127], v30 offset:6944
    ds_read_b64_tr_b16 v[128:129], v31 offset:0
    ds_read_b64_tr_b16 v[130:131], v31 offset:6656
    ds_read_b64_tr_b16 v[132:133], v31 offset:32
    ds_read_b64_tr_b16 v[134:135], v31 offset:6688
    ds_read_b64_tr_b16 v[136:137], v31 offset:64
    ds_read_b64_tr_b16 v[138:139], v31 offset:6720
    ds_read_b64_tr_b16 v[140:141], v31 offset:96
    ds_read_b64_tr_b16 v[142:143], v31 offset:6752
    ds_read_b64_tr_b16 v[144:145], v31 offset:128
    ds_read_b64_tr_b16 v[146:147], v31 offset:6784
    ds_read_b64_tr_b16 v[148:149], v31 offset:160
    ds_read_b64_tr_b16 v[150:151], v31 offset:6816
    s_waitcnt lgkmcnt(0)
    v_mfma_f32_16x16x32_bf16 v[152:155], v[128:131], v[112:115], v[152:155]
    v_mfma_f32_16x16x32_bf16 v[156:159], v[132:135], v[112:115], v[156:159]
    v_mfma_f32_16x16x32_bf16 v[160:163], v[136:139], v[112:115], v[160:163]
    v_mfma_f32_16x16x32_bf16 v[164:167], v[140:143], v[112:115], v[164:167]
    v_mfma_f32_16x16x32_bf16 v[168:171], v[144:147], v[112:115], v[168:171]
    v_mfma_f32_16x16x32_bf16 v[172:175], v[148:151], v[112:115], v[172:175]
    v_mfma_f32_16x16x32_bf16 v[176:179], v[128:131], v[116:119], v[176:179]
    v_mfma_f32_16x16x32_bf16 v[180:183], v[132:135], v[116:119], v[180:183]
    v_mfma_f32_16x16x32_bf16 v[184:187], v[136:139], v[116:119], v[184:187]
    v_mfma_f32_16x16x32_bf16 v[188:191], v[140:143], v[116:119], v[188:191]
    v_mfma_f32_16x16x32_bf16 v[192:195], v[144:147], v[116:119], v[192:195]
    v_mfma_f32_16x16x32_bf16 v[196:199], v[148:151], v[116:119], v[196:199]
    v_mfma_f32_16x16x32_bf16 v[200:203], v[128:131], v[120:123], v[200:203]
    v_mfma_f32_16x16x32_bf16 v[204:207], v[132:135], v[120:123], v[204:207]
    v_mfma_f32_16x16x32_bf16 v[208:211], v[136:139], v[120:123], v[208:211]
    v_mfma_f32_16x16x32_bf16 v[212:215], v[140:143], v[120:123], v[212:215]
    v_mfma_f32_16x16x32_bf16 v[216:219], v[144:147], v[120:123], v[216:219]
    v_mfma_f32_16x16x32_bf16 v[220:223], v[148:151], v[120:123], v[220:223]
    v_mfma_f32_16x16x32_bf16 v[224:227], v[128:131], v[124:127], v[224:227]
    v_mfma_f32_16x16x32_bf16 v[228:231], v[132:135], v[124:127], v[228:231]
    v_mfma_f32_16x16x32_bf16 v[232:235], v[136:139], v[124:127], v[232:235]
    v_mfma_f32_16x16x32_bf16 v[236:239], v[140:143], v[124:127], v[236:239]
    v_mfma_f32_16x16x32_bf16 v[240:243], v[144:147], v[124:127], v[240:243]
    v_mfma_f32_16x16x32_bf16 v[244:247], v[148:151], v[124:127], v[244:247]
    ds_read_b64 v[112:113], v30 offset:64
    ds_read_b64 v[114:115], v30 offset:96
    ds_read_b64 v[116:117], v30 offset:2368
    ds_read_b64 v[118:119], v30 offset:2400
    ds_read_b64 v[120:121], v30 offset:4672
    ds_read_b64 v[122:123], v30 offset:4704
    ds_read_b64 v[124:125], v30 offset:6976
    ds_read_b64 v[126:127], v30 offset:7008
    ds_read_b64_tr_b16 v[128:129], v31 offset:13312
    ds_read_b64_tr_b16 v[130:131], v31 offset:19968
    ds_read_b64_tr_b16 v[132:133], v31 offset:13344
    ds_read_b64_tr_b16 v[134:135], v31 offset:20000
    ds_read_b64_tr_b16 v[136:137], v31 offset:13376
    ds_read_b64_tr_b16 v[138:139], v31 offset:20032
    ds_read_b64_tr_b16 v[140:141], v31 offset:13408
    ds_read_b64_tr_b16 v[142:143], v31 offset:20064
    ds_read_b64_tr_b16 v[144:145], v31 offset:13440
    ds_read_b64_tr_b16 v[146:147], v31 offset:20096
    ds_read_b64_tr_b16 v[148:149], v31 offset:13472
    ds_read_b64_tr_b16 v[150:151], v31 offset:20128
    s_waitcnt lgkmcnt(0)
    v_mfma_f32_16x16x32_bf16 v[152:155], v[128:131], v[112:115], v[152:155]
    v_mfma_f32_16x16x32_bf16 v[156:159], v[132:135], v[112:115], v[156:159]
    v_mfma_f32_16x16x32_bf16 v[160:163], v[136:139], v[112:115], v[160:163]
    v_mfma_f32_16x16x32_bf16 v[164:167], v[140:143], v[112:115], v[164:167]
    v_mfma_f32_16x16x32_bf16 v[168:171], v[144:147], v[112:115], v[168:171]
    v_mfma_f32_16x16x32_bf16 v[172:175], v[148:151], v[112:115], v[172:175]
    v_mfma_f32_16x16x32_bf16 v[176:179], v[128:131], v[116:119], v[176:179]
    v_mfma_f32_16x16x32_bf16 v[180:183], v[132:135], v[116:119], v[180:183]
    v_mfma_f32_16x16x32_bf16 v[184:187], v[136:139], v[116:119], v[184:187]
    v_mfma_f32_16x16x32_bf16 v[188:191], v[140:143], v[116:119], v[188:191]
    v_mfma_f32_16x16x32_bf16 v[192:195], v[144:147], v[116:119], v[192:195]
    v_mfma_f32_16x16x32_bf16 v[196:199], v[148:151], v[116:119], v[196:199]
    v_mfma_f32_16x16x32_bf16 v[200:203], v[128:131], v[120:123], v[200:203]
    v_mfma_f32_16x16x32_bf16 v[204:207], v[132:135], v[120:123], v[204:207]
    v_mfma_f32_16x16x32_bf16 v[208:211], v[136:139], v[120:123], v[208:211]
    v_mfma_f32_16x16x32_bf16 v[212:215], v[140:143], v[120:123], v[212:215]
    v_mfma_f32_16x16x32_bf16 v[216:219], v[144:147], v[120:123], v[216:219]
    v_mfma_f32_16x16x32_bf16 v[220:223], v[148:151], v[120:123], v[220:223]
    v_mfma_f32_16x16x32_bf16 v[224:227], v[128:131], v[124:127], v[224:227]
    v_mfma_f32_16x16x32_bf16 v[228:231], v[132:135], v[124:127], v[228:231]
    v_mfma_f32_16x16x32_bf16 v[232:235], v[136:139], v[124:127], v[232:235]
    v_mfma_f32_16x16x32_bf16 v[236:239], v[140:143], v[124:127], v[236:239]
    v_mfma_f32_16x16x32_bf16 v[240:243], v[144:147], v[124:127], v[240:243]
    v_mfma_f32_16x16x32_bf16 v[244:247], v[148:151], v[124:127], v[244:247]
    s_waitcnt vmcnt(10)
    ds_write_b128 v18, v[32:35] offset:0
    ds_write_b128 v19, v[36:39] offset:0
    ds_write_b128 v20, v[40:43] offset:0
    ds_write_b128 v21, v[44:47] offset:0
    ds_write_b128 v22, v[48:51] offset:0
    ds_write_b128 v23, v[52:55] offset:0
    ds_write_b128 v24, v[56:59] offset:0
    ds_write_b128 v25, v[60:63] offset:0
    ds_write_b128 v26, v[64:67] offset:0
    ds_write_b128 v27, v[68:71] offset:0
    s_waitcnt lgkmcnt(0)
    s_barrier
    s_sub_u32 s50, s50, 1
    s_cmp_lg_u32 s50, 0
    s_cbranch_scc1 GL_9
GE_10:
    s_waitcnt vmcnt(0)
    s_nop 7
    s_nop 7
    s_mul_i32 s39, s37, 294912
    s_mul_i32 s52, s38, 384
    s_add_u32 s39, s39, s52
    s_add_u32 s39, s39, 0x3000000
    s_add_u32 s52, s34, s39
    s_addc_u32 s53, s35, 0
    s_mov_b32 s54, 0x48000
    s_mov_b32 s55, 0x00020000
    v_lshrrev_b32 v1, 6, v0
    v_and_b32 v2, 63, v0
    v_lshrrev_b32 v3, 1, v1
    v_and_b32 v1, 1, v1
    v_mul_u32_u24 v3, 64, v3
    v_mul_u32_u24 v1, 96, v1
    v_and_b32 v4, 15, v2
    v_lshrrev_b32 v2, 4, v2
    v_lshlrev_b32 v2, 2, v2
    v_add_u32 v3, v3, v4
    v_add_u32 v1, v1, v2
    v_mul_u32_u24 v3, 2304, v3
    v_lshl_add_u32 v4, v1, 1, v3
    v_cvt_pk_bf16_f32 v152, v152, v153
    v_cvt_pk_bf16_f32 v153, v154, v155
    s_mov_b32 s51, 0x0
    buffer_store_dwordx2 v[152:153], v4, s[52:55], s51 offen offset:0 sc1
    v_cvt_pk_bf16_f32 v156, v156, v157
    v_cvt_pk_bf16_f32 v157, v158, v159
    s_mov_b32 s51, 0x0
    buffer_store_dwordx2 v[156:157], v4, s[52:55], s51 offen offset:32 sc1
    v_cvt_pk_bf16_f32 v160, v160, v161
    v_cvt_pk_bf16_f32 v161, v162, v163
    s_mov_b32 s51, 0x0
    buffer_store_dwordx2 v[160:161], v4, s[52:55], s51 offen offset:64 sc1
    v_cvt_pk_bf16_f32 v164, v164, v165
    v_cvt_pk_bf16_f32 v165, v166, v167
    s_mov_b32 s51, 0x0
    buffer_store_dwordx2 v[164:165], v4, s[52:55], s51 offen offset:96 sc1
    v_cvt_pk_bf16_f32 v168, v168, v169
    v_cvt_pk_bf16_f32 v169, v170, v171
    s_mov_b32 s51, 0x0
    buffer_store_dwordx2 v[168:169], v4, s[52:55], s51 offen offset:128 sc1
    v_cvt_pk_bf16_f32 v172, v172, v173
    v_cvt_pk_bf16_f32 v173, v174, v175
    s_mov_b32 s51, 0x0
    buffer_store_dwordx2 v[172:173], v4, s[52:55], s51 offen offset:160 sc1
    v_cvt_pk_bf16_f32 v176, v176, v177
    v_cvt_pk_bf16_f32 v177, v178, v179
    s_mov_b32 s51, 0x9000
    buffer_store_dwordx2 v[176:177], v4, s[52:55], s51 offen offset:0 sc1
    v_cvt_pk_bf16_f32 v180, v180, v181
    v_cvt_pk_bf16_f32 v181, v182, v183
    s_mov_b32 s51, 0x9000
    buffer_store_dwordx2 v[180:181], v4, s[52:55], s51 offen offset:32 sc1
    v_cvt_pk_bf16_f32 v184, v184, v185
    v_cvt_pk_bf16_f32 v185, v186, v187
    s_mov_b32 s51, 0x9000
    buffer_store_dwordx2 v[184:185], v4, s[52:55], s51 offen offset:64 sc1
    v_cvt_pk_bf16_f32 v188, v188, v189
    v_cvt_pk_bf16_f32 v189, v190, v191
    s_mov_b32 s51, 0x9000
    buffer_store_dwordx2 v[188:189], v4, s[52:55], s51 offen offset:96 sc1
    v_cvt_pk_bf16_f32 v192, v192, v193
    v_cvt_pk_bf16_f32 v193, v194, v195
    s_mov_b32 s51, 0x9000
    buffer_store_dwordx2 v[192:193], v4, s[52:55], s51 offen offset:128 sc1
    v_cvt_pk_bf16_f32 v196, v196, v197
    v_cvt_pk_bf16_f32 v197, v198, v199
    s_mov_b32 s51, 0x9000
    buffer_store_dwordx2 v[196:197], v4, s[52:55], s51 offen offset:160 sc1
    v_cvt_pk_bf16_f32 v200, v200, v201
    v_cvt_pk_bf16_f32 v201, v202, v203
    s_mov_b32 s51, 0x12000
    buffer_store_dwordx2 v[200:201], v4, s[52:55], s51 offen offset:0 sc1
    v_cvt_pk_bf16_f32 v204, v204, v205
    v_cvt_pk_bf16_f32 v205, v206, v207
    s_mov_b32 s51, 0x12000
    buffer_store_dwordx2 v[204:205], v4, s[52:55], s51 offen offset:32 sc1
    v_cvt_pk_bf16_f32 v208, v208, v209
    v_cvt_pk_bf16_f32 v209, v210, v211
    s_mov_b32 s51, 0x12000
    buffer_store_dwordx2 v[208:209], v4, s[52:55], s51 offen offset:64 sc1
    v_cvt_pk_bf16_f32 v212, v212, v213
    v_cvt_pk_bf16_f32 v213, v214, v215
    s_mov_b32 s51, 0x12000
    buffer_store_dwordx2 v[212:213], v4, s[52:55], s51 offen offset:96 sc1
    v_cvt_pk_bf16_f32 v216, v216, v217
    v_cvt_pk_bf16_f32 v217, v218, v219
    s_mov_b32 s51, 0x12000
    buffer_store_dwordx2 v[216:217], v4, s[52:55], s51 offen offset:128 sc1
    v_cvt_pk_bf16_f32 v220, v220, v221
    v_cvt_pk_bf16_f32 v221, v222, v223
    s_mov_b32 s51, 0x12000
    buffer_store_dwordx2 v[220:221], v4, s[52:55], s51 offen offset:160 sc1
    v_cvt_pk_bf16_f32 v224, v224, v225
    v_cvt_pk_bf16_f32 v225, v226, v227
    s_mov_b32 s51, 0x1b000
    buffer_store_dwordx2 v[224:225], v4, s[52:55], s51 offen offset:0 sc1
    v_cvt_pk_bf16_f32 v228, v228, v229
    v_cvt_pk_bf16_f32 v229, v230, v231
    s_mov_b32 s51, 0x1b000
    buffer_store_dwordx2 v[228:229], v4, s[52:55], s51 offen offset:32 sc1
    v_cvt_pk_bf16_f32 v232, v232, v233
    v_cvt_pk_bf16_f32 v233, v234, v235
    s_mov_b32 s51, 0x1b000
    buffer_store_dwordx2 v[232:233], v4, s[52:55], s51 offen offset:64 sc1
    v_cvt_pk_bf16_f32 v236, v236, v237
    v_cvt_pk_bf16_f32 v237, v238, v239
    s_mov_b32 s51, 0x1b000
    buffer_store_dwordx2 v[236:237], v4, s[52:55], s51 offen offset:96 sc1
    v_cvt_pk_bf16_f32 v240, v240, v241
    v_cvt_pk_bf16_f32 v241, v242, v243
    s_mov_b32 s51, 0x1b000
    buffer_store_dwordx2 v[240:241], v4, s[52:55], s51 offen offset:128 sc1
    v_cvt_pk_bf16_f32 v244, v244, v245
    v_cvt_pk_bf16_f32 v245, v246, v247
    s_mov_b32 s51, 0x1b000
    buffer_store_dwordx2 v[244:245], v4, s[52:55], s51 offen offset:160 sc1
    s_branch TE_8
TV_7:
    v_lshrrev_b32 v1, 3, v0
    v_add_u32 v1, 0, v1
    v_and_b32 v2, 7, v0
    v_mul_u32_u24 v3, 1152, v1
    v_lshl_add_u32 v8, v2, 4, v3
    v_mul_u32_u24 v3, 144, v1
    v_lshl_add_u32 v18, v2, 4, v3
    v_lshrrev_b32 v1, 3, v0
    v_add_u32 v1, 32, v1
    v_and_b32 v2, 7, v0
    v_mul_u32_u24 v3, 1152, v1
    v_lshl_add_u32 v9, v2, 4, v3
    v_mul_u32_u24 v3, 144, v1
    v_lshl_add_u32 v19, v2, 4, v3
    v_lshrrev_b32 v1, 3, v0
    v_add_u32 v1, 64, v1
    v_and_b32 v2, 7, v0
    v_mul_u32_u24 v3, 1152, v1
    v_lshl_add_u32 v10, v2, 4, v3
    v_mul_u32_u24 v3, 144, v1
    v_lshl_add_u32 v20, v2, 4, v3
    v_lshrrev_b32 v1, 3, v0
    v_add_u32 v1, 96, v1
    v_and_b32 v2, 7, v0
    v_mul_u32_u24 v3, 1152, v1
    v_lshl_add_u32 v11, v2, 4, v3
    v_mul_u32_u24 v3, 144, v1
    v_lshl_add_u32 v21, v2, 4, v3
    v_add_u32 v1, 0, v0
    v_mul_u32_u24 v2, 43691, v1
    v_lshrrev_b32 v2, 20, v2
    v_mul_u32_u24 v3, 24, v2
    v_sub_u32 v1, v1, v3
    v_mul_u32_u24 v3, 3456, v2
    v_lshl_add_u32 v12, v1, 4, v3
    v_mul_u32_u24 v3, 416, v2
    v_lshl_add_u32 v22, v1, 4, v3
    v_add_u32 v22, 18432, v22
    v_add_u32 v1, 256, v0
    v_mul_u32_u24 v2, 43691, v1
    v_lshrrev_b32 v2, 20, v2
    v_mul_u32_u24 v3, 24, v2
    v_sub_u32 v1, v1, v3
    v_mul_u32_u24 v3, 3456, v2
    v_lshl_add_u32 v13, v1, 4, v3
    v_mul_u32_u24 v3, 416, v2
    v_lshl_add_u32 v23, v1, 4, v3
    v_add_u32 v23, 18432, v23
    v_add_u32 v1, 512, v0
    v_mul_u32_u24 v2, 43691, v1
    v_lshrrev_b32 v2, 20, v2
    v_mul_u32_u24 v3, 24, v2
    v_sub_u32 v1, v1, v3
    v_mul_u32_u24 v3, 3456, v2
    v_lshl_add_u32 v14, v1, 4, v3
    v_mul_u32_u24 v3, 416, v2
    v_lshl_add_u32 v24, v1, 4, v3
    v_add_u32 v24, 18432, v24
    v_add_u32 v1, 768, v0
    v_mul_u32_u24 v2, 43691, v1
    v_lshrrev_b32 v2, 20, v2
    v_mul_u32_u24 v3, 24, v2
    v_sub_u32 v1, v1, v3
    v_mul_u32_u24 v3, 3456, v2
    v_lshl_add_u32 v15, v1, 4, v3
    v_mul_u32_u24 v3, 416, v2
    v_lshl_add_u32 v25, v1, 4, v3
    v_add_u32 v25, 18432, v25
    v_add_u32 v1, 1024, v0
    v_mul_u32_u24 v2, 43691, v1
    v_lshrrev_b32 v2, 20, v2
    v_mul_u32_u24 v3, 24, v2
    v_sub_u32 v1, v1, v3
    v_mul_u32_u24 v3, 3456, v2
    v_lshl_add_u32 v16, v1, 4, v3
    v_mul_u32_u24 v3, 416, v2
    v_lshl_add_u32 v26, v1, 4, v3
    v_add_u32 v26, 18432, v26
    v_add_u32 v1, 1280, v0
    v_mul_u32_u24 v2, 43691, v1
    v_lshrrev_b32 v2, 20, v2
    v_mul_u32_u24 v3, 24, v2
    v_sub_u32 v1, v1, v3
    v_mul_u32_u24 v3, 3456, v2
    v_lshl_add_u32 v17, v1, 4, v3
    v_mul_u32_u24 v3, 416, v2
    v_lshl_add_u32 v27, v1, 4, v3
    v_add_u32 v27, 18432, v27
    v_lshrrev_b32 v1, 6, v0
    v_and_b32 v2, 63, v0
    v_lshrrev_b32 v3, 1, v1
    v_mul_u32_u24 v3, 64, v3
    v_and_b32 v28, 15, v2
    v_add_u32 v3, v3, v28
    v_mul_u32_u24 v3, 144, v3
    v_lshrrev_b32 v28, 4, v2
    v_lshl_add_u32 v28, v28, 3, v3
    v_lshrrev_b32 v3, 4, v2
    v_lshlrev_b32 v3, 2, v3
    v_bfe_u32 v29, v2, 2, 2
    v_add_u32 v3, v3, v29
    v_mul_u32_u24 v3, 416, v3
    v_and_b32 v1, 1, v1
    v_mul_u32_u24 v1, 192, v1
    v_add_u32 v3, v3, v1
    v_and_b32 v1, 3, v2
    v_lshl_add_u32 v29, v1, 3, v3
    v_add_u32 v29, 18432, v29
    v_add_u32 v30, 45056, v28
    v_add_u32 v31, 45056, v29
    v_mov_b32 v152, 0
    v_mov_b32 v153, 0
    v_mov_b32 v154, 0
    v_mov_b32 v155, 0
    v_mov_b32 v156, 0
    v_mov_b32 v157, 0
    v_mov_b32 v158, 0
    v_mov_b32 v159, 0
    v_mov_b32 v160, 0
    v_mov_b32 v161, 0
    v_mov_b32 v162, 0
    v_mov_b32 v163, 0
    v_mov_b32 v164, 0
    v_mov_b32 v165, 0
    v_mov_b32 v166, 0
    v_mov_b32 v167, 0
    v_mov_b32 v168, 0
    v_mov_b32 v169, 0
    v_mov_b32 v170, 0
    v_mov_b32 v171, 0
    v_mov_b32 v172, 0
    v_mov_b32 v173, 0
    v_mov_b32 v174, 0
    v_mov_b32 v175, 0
    v_mov_b32 v176, 0
    v_mov_b32 v177, 0
    v_mov_b32 v178, 0
    v_mov_b32 v179, 0
    v_mov_b32 v180, 0
    v_mov_b32 v181, 0
    v_mov_b32 v182, 0
    v_mov_b32 v183, 0
    v_mov_b32 v184, 0
    v_mov_b32 v185, 0
    v_mov_b32 v186, 0
    v_mov_b32 v187, 0
    v_mov_b32 v188, 0
    v_mov_b32 v189, 0
    v_mov_b32 v190, 0
    v_mov_b32 v191, 0
    v_mov_b32 v192, 0
    v_mov_b32 v193, 0
    v_mov_b32 v194, 0
    v_mov_b32 v195, 0
    v_mov_b32 v196, 0
    v_mov_b32 v197, 0
    v_mov_b32 v198, 0
    v_mov_b32 v199, 0
    v_mov_b32 v200, 0
    v_mov_b32 v201, 0
    v_mov_b32 v202, 0
    v_mov_b32 v203, 0
    v_mov_b32 v204, 0
    v_mov_b32 v205, 0
    v_mov_b32 v206, 0
    v_mov_b32 v207, 0
    v_mov_b32 v208, 0
    v_mov_b32 v209, 0
    v_mov_b32 v210, 0
    v_mov_b32 v211, 0
    v_mov_b32 v212, 0
    v_mov_b32 v213, 0
    v_mov_b32 v214, 0
    v_mov_b32 v215, 0
    v_mov_b32 v216, 0
    v_mov_b32 v217, 0
    v_mov_b32 v218, 0
    v_mov_b32 v219, 0
    v_mov_b32 v220, 0
    v_mov_b32 v221, 0
    v_mov_b32 v222, 0
    v_mov_b32 v223, 0
    v_mov_b32 v224, 0
    v_mov_b32 v225, 0
    v_mov_b32 v226, 0
    v_mov_b32 v227, 0
    v_mov_b32 v228, 0
    v_mov_b32 v229, 0
    v_mov_b32 v230, 0
    v_mov_b32 v231, 0
    v_mov_b32 v232, 0
    v_mov_b32 v233, 0
    v_mov_b32 v234, 0
    v_mov_b32 v235, 0
    v_mov_b32 v236, 0
    v_mov_b32 v237, 0
    v_mov_b32 v238, 0
    v_mov_b32 v239, 0
    v_mov_b32 v240, 0
    v_mov_b32 v241, 0
    v_mov_b32 v242, 0
    v_mov_b32 v243, 0
    v_mov_b32 v244, 0
    v_mov_b32 v245, 0
    v_mov_b32 v246, 0
    v_mov_b32 v247, 0
    s_mov_b32 s48, 0
    s_mov_b32 s49, 0
    buffer_load_dwordx4 v[32:35], v8, s[40:43], s48 offen
    buffer_load_dwordx4 v[36:39], v9, s[40:43], s48 offen
    buffer_load_dwordx4 v[40:43], v10, s[40:43], s48 offen
    buffer_load_dwordx4 v[44:47], v11, s[40:43], s48 offen
    buffer_load_dwordx4 v[48:51], v12, s[44:47], s49 offen
    buffer_load_dwordx4 v[52:55], v13, s[44:47], s49 offen
    buffer_load_dwordx4 v[56:59], v14, s[44:47], s49 offen
    buffer_load_dwordx4 v[60:63], v15, s[44:47], s49 offen
    buffer_load_dwordx4 v[64:67], v16, s[44:47], s49 offen
    buffer_load_dwordx4 v[68:71], v17, s[44:47], s49 offen
    s_add_u32 s48, s48, 128
    s_add_u32 s49, s49, 0x36000
    buffer_load_dwordx4 v[72:75], v8, s[40:43], s48 offen
    buffer_load_dwordx4 v[76:79], v9, s[40:43], s48 offen
    buffer_load_dwordx4 v[80:83], v10, s[40:43], s48 offen
    buffer_load_dwordx4 v[84:87], v11, s[40:43], s48 offen
    buffer_load_dwordx4 v[88:91], v12, s[44:47], s49 offen
    buffer_load_dwordx4 v[92:95], v13, s[44:47], s49 offen
    buffer_load_dwordx4 v[96:99], v14, s[44:47], s49 offen
    buffer_load_dwordx4 v[100:103], v15, s[44:47], s49 offen
    buffer_load_dwordx4 v[104:107], v16, s[44:47], s49 offen
    buffer_load_dwordx4 v[108:111], v17, s[44:47], s49 offen
    s_add_u32 s48, s48, 128
    s_add_u32 s49, s49, 0x36000
    s_waitcnt vmcnt(10)
    s_barrier
    ds_write_b128 v18, v[32:35] offset:0
    ds_write_b128 v19, v[36:39] offset:0
    ds_write_b128 v20, v[40:43] offset:0
    ds_write_b128 v21, v[44:47] offset:0
    ds_write_b128 v22, v[48:51] offset:0
    ds_write_b128 v23, v[52:55] offset:0
    ds_write_b128 v24, v[56:59] offset:0
    ds_write_b128 v25, v[60:63] offset:0
    ds_write_b128 v26, v[64:67] offset:0
    ds_write_b128 v27, v[68:71] offset:0
    s_waitcnt lgkmcnt(0)
    s_barrier
    s_mov_b32 s50, 9
GL_11:
    buffer_load_dwordx4 v[32:35], v8, s[40:43], s48 offen
    buffer_load_dwordx4 v[36:39], v9, s[40:43], s48 offen
    buffer_load_dwordx4 v[40:43], v10, s[40:43], s48 offen
    buffer_load_dwordx4 v[44:47], v11, s[40:43], s48 offen
    buffer_load_dwordx4 v[48:51], v12, s[44:47], s49 offen
    buffer_load_dwordx4 v[52:55], v13, s[44:47], s49 offen
    buffer_load_dwordx4 v[56:59], v14, s[44:47], s49 offen
    buffer_load_dwordx4 v[60:63], v15, s[44:47], s49 offen
    buffer_load_dwordx4 v[64:67], v16, s[44:47], s49 offen
    buffer_load_dwordx4 v[68:71], v17, s[44:47], s49 offen
    s_add_u32 s48, s48, 128
    s_add_u32 s49, s49, 0x36000
    ds_read_b64 v[112:113], v28 offset:0
    ds_read_b64 v[114:115], v28 offset:32
    ds_read_b64 v[116:117], v28 offset:2304
    ds_read_b64 v[118:119], v28 offset:2336
    ds_read_b64 v[120:121], v28 offset:4608
    ds_read_b64 v[122:123], v28 offset:4640
    ds_read_b64 v[124:125], v28 offset:6912
    ds_read_b64 v[126:127], v28 offset:6944
    ds_read_b64_tr_b16 v[128:129], v29 offset:0
    ds_read_b64_tr_b16 v[130:131], v29 offset:6656
    ds_read_b64_tr_b16 v[132:133], v29 offset:32
    ds_read_b64_tr_b16 v[134:135], v29 offset:6688
    ds_read_b64_tr_b16 v[136:137], v29 offset:64
    ds_read_b64_tr_b16 v[138:139], v29 offset:6720
    ds_read_b64_tr_b16 v[140:141], v29 offset:96
    ds_read_b64_tr_b16 v[142:143], v29 offset:6752
    ds_read_b64_tr_b16 v[144:145], v29 offset:128
    ds_read_b64_tr_b16 v[146:147], v29 offset:6784
    ds_read_b64_tr_b16 v[148:149], v29 offset:160
    ds_read_b64_tr_b16 v[150:151], v29 offset:6816
    s_waitcnt lgkmcnt(0)
    v_mfma_f32_16x16x32_bf16 v[152:155], v[112:115], v[128:131], v[152:155]
    v_mfma_f32_16x16x32_bf16 v[156:159], v[112:115], v[132:135], v[156:159]
    v_mfma_f32_16x16x32_bf16 v[160:163], v[112:115], v[136:139], v[160:163]
    v_mfma_f32_16x16x32_bf16 v[164:167], v[112:115], v[140:143], v[164:167]
    v_mfma_f32_16x16x32_bf16 v[168:171], v[112:115], v[144:147], v[168:171]
    v_mfma_f32_16x16x32_bf16 v[172:175], v[112:115], v[148:151], v[172:175]
    v_mfma_f32_16x16x32_bf16 v[176:179], v[116:119], v[128:131], v[176:179]
    v_mfma_f32_16x16x32_bf16 v[180:183], v[116:119], v[132:135], v[180:183]
    v_mfma_f32_16x16x32_bf16 v[184:187], v[116:119], v[136:139], v[184:187]
    v_mfma_f32_16x16x32_bf16 v[188:191], v[116:119], v[140:143], v[188:191]
    v_mfma_f32_16x16x32_bf16 v[192:195], v[116:119], v[144:147], v[192:195]
    v_mfma_f32_16x16x32_bf16 v[196:199], v[116:119], v[148:151], v[196:199]
    v_mfma_f32_16x16x32_bf16 v[200:203], v[120:123], v[128:131], v[200:203]
    v_mfma_f32_16x16x32_bf16 v[204:207], v[120:123], v[132:135], v[204:207]
    v_mfma_f32_16x16x32_bf16 v[208:211], v[120:123], v[136:139], v[208:211]
    v_mfma_f32_16x16x32_bf16 v[212:215], v[120:123], v[140:143], v[212:215]
    v_mfma_f32_16x16x32_bf16 v[216:219], v[120:123], v[144:147], v[216:219]
    v_mfma_f32_16x16x32_bf16 v[220:223], v[120:123], v[148:151], v[220:223]
    v_mfma_f32_16x16x32_bf16 v[224:227], v[124:127], v[128:131], v[224:227]
    v_mfma_f32_16x16x32_bf16 v[228:231], v[124:127], v[132:135], v[228:231]
    v_mfma_f32_16x16x32_bf16 v[232:235], v[124:127], v[136:139], v[232:235]
    v_mfma_f32_16x16x32_bf16 v[236:239], v[124:127], v[140:143], v[236:239]
    v_mfma_f32_16x16x32_bf16 v[240:243], v[124:127], v[144:147], v[240:243]
    v_mfma_f32_16x16x32_bf16 v[244:247], v[124:127], v[148:151], v[244:247]
    ds_read_b64 v[112:113], v28 offset:64
    ds_read_b64 v[114:115], v28 offset:96
    ds_read_b64 v[116:117], v28 offset:2368
    ds_read_b64 v[118:119], v28 offset:2400
    ds_read_b64 v[120:121], v28 offset:4672
    ds_read_b64 v[122:123], v28 offset:4704
    ds_read_b64 v[124:125], v28 offset:6976
    ds_read_b64 v[126:127], v28 offset:7008
    ds_read_b64_tr_b16 v[128:129], v29 offset:13312
    ds_read_b64_tr_b16 v[130:131], v29 offset:19968
    ds_read_b64_tr_b16 v[132:133], v29 offset:13344
    ds_read_b64_tr_b16 v[134:135], v29 offset:20000
    ds_read_b64_tr_b16 v[136:137], v29 offset:13376
    ds_read_b64_tr_b16 v[138:139], v29 offset:20032
    ds_read_b64_tr_b16 v[140:141], v29 offset:13408
    ds_read_b64_tr_b16 v[142:143], v29 offset:20064
    ds_read_b64_tr_b16 v[144:145], v29 offset:13440
    ds_read_b64_tr_b16 v[146:147], v29 offset:20096
    ds_read_b64_tr_b16 v[148:149], v29 offset:13472
    ds_read_b64_tr_b16 v[150:151], v29 offset:20128
    s_waitcnt lgkmcnt(0)
    v_mfma_f32_16x16x32_bf16 v[152:155], v[112:115], v[128:131], v[152:155]
    v_mfma_f32_16x16x32_bf16 v[156:159], v[112:115], v[132:135], v[156:159]
    v_mfma_f32_16x16x32_bf16 v[160:163], v[112:115], v[136:139], v[160:163]
    v_mfma_f32_16x16x32_bf16 v[164:167], v[112:115], v[140:143], v[164:167]
    v_mfma_f32_16x16x32_bf16 v[168:171], v[112:115], v[144:147], v[168:171]
    v_mfma_f32_16x16x32_bf16 v[172:175], v[112:115], v[148:151], v[172:175]
    v_mfma_f32_16x16x32_bf16 v[176:179], v[116:119], v[128:131], v[176:179]
    v_mfma_f32_16x16x32_bf16 v[180:183], v[116:119], v[132:135], v[180:183]
    v_mfma_f32_16x16x32_bf16 v[184:187], v[116:119], v[136:139], v[184:187]
    v_mfma_f32_16x16x32_bf16 v[188:191], v[116:119], v[140:143], v[188:191]
    v_mfma_f32_16x16x32_bf16 v[192:195], v[116:119], v[144:147], v[192:195]
    v_mfma_f32_16x16x32_bf16 v[196:199], v[116:119], v[148:151], v[196:199]
    v_mfma_f32_16x16x32_bf16 v[200:203], v[120:123], v[128:131], v[200:203]
    v_mfma_f32_16x16x32_bf16 v[204:207], v[120:123], v[132:135], v[204:207]
    v_mfma_f32_16x16x32_bf16 v[208:211], v[120:123], v[136:139], v[208:211]
    v_mfma_f32_16x16x32_bf16 v[212:215], v[120:123], v[140:143], v[212:215]
    v_mfma_f32_16x16x32_bf16 v[216:219], v[120:123], v[144:147], v[216:219]
    v_mfma_f32_16x16x32_bf16 v[220:223], v[120:123], v[148:151], v[220:223]
    v_mfma_f32_16x16x32_bf16 v[224:227], v[124:127], v[128:131], v[224:227]
    v_mfma_f32_16x16x32_bf16 v[228:231], v[124:127], v[132:135], v[228:231]
    v_mfma_f32_16x16x32_bf16 v[232:235], v[124:127], v[136:139], v[232:235]
    v_mfma_f32_16x16x32_bf16 v[236:239], v[124:127], v[140:143], v[236:239]
    v_mfma_f32_16x16x32_bf16 v[240:243], v[124:127], v[144:147], v[240:243]
    v_mfma_f32_16x16x32_bf16 v[244:247], v[124:127], v[148:151], v[244:247]
    s_waitcnt vmcnt(10)
    ds_write_b128 v18, v[72:75] offset:45056
    ds_write_b128 v19, v[76:79] offset:45056
    ds_write_b128 v20, v[80:83] offset:45056
    ds_write_b128 v21, v[84:87] offset:45056
    ds_write_b128 v22, v[88:91] offset:45056
    ds_write_b128 v23, v[92:95] offset:45056
    ds_write_b128 v24, v[96:99] offset:45056
    ds_write_b128 v25, v[100:103] offset:45056
    ds_write_b128 v26, v[104:107] offset:45056
    ds_write_b128 v27, v[108:111] offset:45056
    s_waitcnt lgkmcnt(0)
    s_barrier
    s_sub_u32 s50, s50, 1
    s_cmp_eq_u32 s50, 0
    s_cbranch_scc1 GE_12
    buffer_load_dwordx4 v[72:75], v8, s[40:43], s48 offen
    buffer_load_dwordx4 v[76:79], v9, s[40:43], s48 offen
    buffer_load_dwordx4 v[80:83], v10, s[40:43], s48 offen
    buffer_load_dwordx4 v[84:87], v11, s[40:43], s48 offen
    buffer_load_dwordx4 v[88:91], v12, s[44:47], s49 offen
    buffer_load_dwordx4 v[92:95], v13, s[44:47], s49 offen
    buffer_load_dwordx4 v[96:99], v14, s[44:47], s49 offen
    buffer_load_dwordx4 v[100:103], v15, s[44:47], s49 offen
    buffer_load_dwordx4 v[104:107], v16, s[44:47], s49 offen
    buffer_load_dwordx4 v[108:111], v17, s[44:47], s49 offen
    s_add_u32 s48, s48, 128
    s_add_u32 s49, s49, 0x36000
    ds_read_b64 v[112:113], v30 offset:0
    ds_read_b64 v[114:115], v30 offset:32
    ds_read_b64 v[116:117], v30 offset:2304
    ds_read_b64 v[118:119], v30 offset:2336
    ds_read_b64 v[120:121], v30 offset:4608
    ds_read_b64 v[122:123], v30 offset:4640
    ds_read_b64 v[124:125], v30 offset:6912
    ds_read_b64 v[126:127], v30 offset:6944
    ds_read_b64_tr_b16 v[128:129], v31 offset:0
    ds_read_b64_tr_b16 v[130:131], v31 offset:6656
    ds_read_b64_tr_b16 v[132:133], v31 offset:32
    ds_read_b64_tr_b16 v[134:135], v31 offset:6688
    ds_read_b64_tr_b16 v[136:137], v31 offset:64
    ds_read_b64_tr_b16 v[138:139], v31 offset:6720
    ds_read_b64_tr_b16 v[140:141], v31 offset:96
    ds_read_b64_tr_b16 v[142:143], v31 offset:6752
    ds_read_b64_tr_b16 v[144:145], v31 offset:128
    ds_read_b64_tr_b16 v[146:147], v31 offset:6784
    ds_read_b64_tr_b16 v[148:149], v31 offset:160
    ds_read_b64_tr_b16 v[150:151], v31 offset:6816
    s_waitcnt lgkmcnt(0)
    v_mfma_f32_16x16x32_bf16 v[152:155], v[112:115], v[128:131], v[152:155]
    v_mfma_f32_16x16x32_bf16 v[156:159], v[112:115], v[132:135], v[156:159]
    v_mfma_f32_16x16x32_bf16 v[160:163], v[112:115], v[136:139], v[160:163]
    v_mfma_f32_16x16x32_bf16 v[164:167], v[112:115], v[140:143], v[164:167]
    v_mfma_f32_16x16x32_bf16 v[168:171], v[112:115], v[144:147], v[168:171]
    v_mfma_f32_16x16x32_bf16 v[172:175], v[112:115], v[148:151], v[172:175]
    v_mfma_f32_16x16x32_bf16 v[176:179], v[116:119], v[128:131], v[176:179]
    v_mfma_f32_16x16x32_bf16 v[180:183], v[116:119], v[132:135], v[180:183]
    v_mfma_f32_16x16x32_bf16 v[184:187], v[116:119], v[136:139], v[184:187]
    v_mfma_f32_16x16x32_bf16 v[188:191], v[116:119], v[140:143], v[188:191]
    v_mfma_f32_16x16x32_bf16 v[192:195], v[116:119], v[144:147], v[192:195]
    v_mfma_f32_16x16x32_bf16 v[196:199], v[116:119], v[148:151], v[196:199]
    v_mfma_f32_16x16x32_bf16 v[200:203], v[120:123], v[128:131], v[200:203]
    v_mfma_f32_16x16x32_bf16 v[204:207], v[120:123], v[132:135], v[204:207]
    v_mfma_f32_16x16x32_bf16 v[208:211], v[120:123], v[136:139], v[208:211]
    v_mfma_f32_16x16x32_bf16 v[212:215], v[120:123], v[140:143], v[212:215]
    v_mfma_f32_16x16x32_bf16 v[216:219], v[120:123], v[144:147], v[216:219]
    v_mfma_f32_16x16x32_bf16 v[220:223], v[120:123], v[148:151], v[220:223]
    v_mfma_f32_16x16x32_bf16 v[224:227], v[124:127], v[128:131], v[224:227]
    v_mfma_f32_16x16x32_bf16 v[228:231], v[124:127], v[132:135], v[228:231]
    v_mfma_f32_16x16x32_bf16 v[232:235], v[124:127], v[136:139], v[232:235]
    v_mfma_f32_16x16x32_bf16 v[236:239], v[124:127], v[140:143], v[236:239]
    v_mfma_f32_16x16x32_bf16 v[240:243], v[124:127], v[144:147], v[240:243]
    v_mfma_f32_16x16x32_bf16 v[244:247], v[124:127], v[148:151], v[244:247]
    ds_read_b64 v[112:113], v30 offset:64
    ds_read_b64 v[114:115], v30 offset:96
    ds_read_b64 v[116:117], v30 offset:2368
    ds_read_b64 v[118:119], v30 offset:2400
    ds_read_b64 v[120:121], v30 offset:4672
    ds_read_b64 v[122:123], v30 offset:4704
    ds_read_b64 v[124:125], v30 offset:6976
    ds_read_b64 v[126:127], v30 offset:7008
    ds_read_b64_tr_b16 v[128:129], v31 offset:13312
    ds_read_b64_tr_b16 v[130:131], v31 offset:19968
    ds_read_b64_tr_b16 v[132:133], v31 offset:13344
    ds_read_b64_tr_b16 v[134:135], v31 offset:20000
    ds_read_b64_tr_b16 v[136:137], v31 offset:13376
    ds_read_b64_tr_b16 v[138:139], v31 offset:20032
    ds_read_b64_tr_b16 v[140:141], v31 offset:13408
    ds_read_b64_tr_b16 v[142:143], v31 offset:20064
    ds_read_b64_tr_b16 v[144:145], v31 offset:13440
    ds_read_b64_tr_b16 v[146:147], v31 offset:20096
    ds_read_b64_tr_b16 v[148:149], v31 offset:13472
    ds_read_b64_tr_b16 v[150:151], v31 offset:20128
    s_waitcnt lgkmcnt(0)
    v_mfma_f32_16x16x32_bf16 v[152:155], v[112:115], v[128:131], v[152:155]
    v_mfma_f32_16x16x32_bf16 v[156:159], v[112:115], v[132:135], v[156:159]
    v_mfma_f32_16x16x32_bf16 v[160:163], v[112:115], v[136:139], v[160:163]
    v_mfma_f32_16x16x32_bf16 v[164:167], v[112:115], v[140:143], v[164:167]
    v_mfma_f32_16x16x32_bf16 v[168:171], v[112:115], v[144:147], v[168:171]
    v_mfma_f32_16x16x32_bf16 v[172:175], v[112:115], v[148:151], v[172:175]
    v_mfma_f32_16x16x32_bf16 v[176:179], v[116:119], v[128:131], v[176:179]
    v_mfma_f32_16x16x32_bf16 v[180:183], v[116:119], v[132:135], v[180:183]
    v_mfma_f32_16x16x32_bf16 v[184:187], v[116:119], v[136:139], v[184:187]
    v_mfma_f32_16x16x32_bf16 v[188:191], v[116:119], v[140:143], v[188:191]
    v_mfma_f32_16x16x32_bf16 v[192:195], v[116:119], v[144:147], v[192:195]
    v_mfma_f32_16x16x32_bf16 v[196:199], v[116:119], v[148:151], v[196:199]
    v_mfma_f32_16x16x32_bf16 v[200:203], v[120:123], v[128:131], v[200:203]
    v_mfma_f32_16x16x32_bf16 v[204:207], v[120:123], v[132:135], v[204:207]
    v_mfma_f32_16x16x32_bf16 v[208:211], v[120:123], v[136:139], v[208:211]
    v_mfma_f32_16x16x32_bf16 v[212:215], v[120:123], v[140:143], v[212:215]
    v_mfma_f32_16x16x32_bf16 v[216:219], v[120:123], v[144:147], v[216:219]
    v_mfma_f32_16x16x32_bf16 v[220:223], v[120:123], v[148:151], v[220:223]
    v_mfma_f32_16x16x32_bf16 v[224:227], v[124:127], v[128:131], v[224:227]
    v_mfma_f32_16x16x32_bf16 v[228:231], v[124:127], v[132:135], v[228:231]
    v_mfma_f32_16x16x32_bf16 v[232:235], v[124:127], v[136:139], v[232:235]
    v_mfma_f32_16x16x32_bf16 v[236:239], v[124:127], v[140:143], v[236:239]
    v_mfma_f32_16x16x32_bf16 v[240:243], v[124:127], v[144:147], v[240:243]
    v_mfma_f32_16x16x32_bf16 v[244:247], v[124:127], v[148:151], v[244:247]
    s_waitcnt vmcnt(10)
    ds_write_b128 v18, v[32:35] offset:0
    ds_write_b128 v19, v[36:39] offset:0
    ds_write_b128 v20, v[40:43] offset:0
    ds_write_b128 v21, v[44:47] offset:0
    ds_write_b128 v22, v[48:51] offset:0
    ds_write_b128 v23, v[52:55] offset:0
    ds_write_b128 v24, v[56:59] offset:0
    ds_write_b128 v25, v[60:63] offset:0
    ds_write_b128 v26, v[64:67] offset:0
    ds_write_b128 v27, v[68:71] offset:0
    s_waitcnt lgkmcnt(0)
    s_barrier
    s_sub_u32 s50, s50, 1
    s_cmp_lg_u32 s50, 0
    s_cbranch_scc1 GL_11
GE_12:
    s_waitcnt vmcnt(0)
    s_nop 7
    s_nop 7
    s_sub_u32 s39, s38, 6
    s_mul_i32 s39, s39, 786432
    s_lshl_b32 s52, s37, 8
    s_add_u32 s39, s39, s52
    s_add_u32 s39, s39, 0x3500000
    s_add_u32 s52, s34, s39
    s_addc_u32 s53, s35, 0
    s_mov_b32 s54, 0xc0000
    s_mov_b32 s55, 0x00020000
    v_lshrrev_b32 v1, 6, v0
    v_and_b32 v2, 63, v0
    v_lshrrev_b32 v3, 1, v1
    v_and_b32 v1, 1, v1
    v_mul_u32_u24 v3, 64, v3
    v_mul_u32_u24 v1, 96, v1
    v_and_b32 v4, 15, v2
    v_lshrrev_b32 v2, 4, v2
    v_lshlrev_b32 v2, 2, v2
    v_add_u32 v1, v1, v4
    v_add_u32 v3, v3, v2
    v_mul_u32_u24 v1, 4096, v1
    v_lshl_add_u32 v4, v3, 1, v1
    v_cvt_pk_bf16_f32 v152, v152, v153
    v_cvt_pk_bf16_f32 v153, v154, v155
    s_mov_b32 s51, 0x0
    buffer_store_dwordx2 v[152:153], v4, s[52:55], s51 offen offset:0 sc1
    v_cvt_pk_bf16_f32 v156, v156, v157
    v_cvt_pk_bf16_f32 v157, v158, v159
    s_mov_b32 s51, 0x10000
    buffer_store_dwordx2 v[156:157], v4, s[52:55], s51 offen offset:0 sc1
    v_cvt_pk_bf16_f32 v160, v160, v161
    v_cvt_pk_bf16_f32 v161, v162, v163
    s_mov_b32 s51, 0x20000
    buffer_store_dwordx2 v[160:161], v4, s[52:55], s51 offen offset:0 sc1
    v_cvt_pk_bf16_f32 v164, v164, v165
    v_cvt_pk_bf16_f32 v165, v166, v167
    s_mov_b32 s51, 0x30000
    buffer_store_dwordx2 v[164:165], v4, s[52:55], s51 offen offset:0 sc1
    v_cvt_pk_bf16_f32 v168, v168, v169
    v_cvt_pk_bf16_f32 v169, v170, v171
    s_mov_b32 s51, 0x40000
    buffer_store_dwordx2 v[168:169], v4, s[52:55], s51 offen offset:0 sc1
    v_cvt_pk_bf16_f32 v172, v172, v173
    v_cvt_pk_bf16_f32 v173, v174, v175
    s_mov_b32 s51, 0x50000
    buffer_store_dwordx2 v[172:173], v4, s[52:55], s51 offen offset:0 sc1
    v_cvt_pk_bf16_f32 v176, v176, v177
    v_cvt_pk_bf16_f32 v177, v178, v179
    s_mov_b32 s51, 0x0
    buffer_store_dwordx2 v[176:177], v4, s[52:55], s51 offen offset:32 sc1
    v_cvt_pk_bf16_f32 v180, v180, v181
    v_cvt_pk_bf16_f32 v181, v182, v183
    s_mov_b32 s51, 0x10000
    buffer_store_dwordx2 v[180:181], v4, s[52:55], s51 offen offset:32 sc1
    v_cvt_pk_bf16_f32 v184, v184, v185
    v_cvt_pk_bf16_f32 v185, v186, v187
    s_mov_b32 s51, 0x20000
    buffer_store_dwordx2 v[184:185], v4, s[52:55], s51 offen offset:32 sc1
    v_cvt_pk_bf16_f32 v188, v188, v189
    v_cvt_pk_bf16_f32 v189, v190, v191
    s_mov_b32 s51, 0x30000
    buffer_store_dwordx2 v[188:189], v4, s[52:55], s51 offen offset:32 sc1
    v_cvt_pk_bf16_f32 v192, v192, v193
    v_cvt_pk_bf16_f32 v193, v194, v195
    s_mov_b32 s51, 0x40000
    buffer_store_dwordx2 v[192:193], v4, s[52:55], s51 offen offset:32 sc1
    v_cvt_pk_bf16_f32 v196, v196, v197
    v_cvt_pk_bf16_f32 v197, v198, v199
    s_mov_b32 s51, 0x50000
    buffer_store_dwordx2 v[196:197], v4, s[52:55], s51 offen offset:32 sc1
    v_cvt_pk_bf16_f32 v200, v200, v201
    v_cvt_pk_bf16_f32 v201, v202, v203
    s_mov_b32 s51, 0x0
    buffer_store_dwordx2 v[200:201], v4, s[52:55], s51 offen offset:64 sc1
    v_cvt_pk_bf16_f32 v204, v204, v205
    v_cvt_pk_bf16_f32 v205, v206, v207
    s_mov_b32 s51, 0x10000
    buffer_store_dwordx2 v[204:205], v4, s[52:55], s51 offen offset:64 sc1
    v_cvt_pk_bf16_f32 v208, v208, v209
    v_cvt_pk_bf16_f32 v209, v210, v211
    s_mov_b32 s51, 0x20000
    buffer_store_dwordx2 v[208:209], v4, s[52:55], s51 offen offset:64 sc1
    v_cvt_pk_bf16_f32 v212, v212, v213
    v_cvt_pk_bf16_f32 v213, v214, v215
    s_mov_b32 s51, 0x30000
    buffer_store_dwordx2 v[212:213], v4, s[52:55], s51 offen offset:64 sc1
    v_cvt_pk_bf16_f32 v216, v216, v217
    v_cvt_pk_bf16_f32 v217, v218, v219
    s_mov_b32 s51, 0x40000
    buffer_store_dwordx2 v[216:217], v4, s[52:55], s51 offen offset:64 sc1
    v_cvt_pk_bf16_f32 v220, v220, v221
    v_cvt_pk_bf16_f32 v221, v222, v223
    s_mov_b32 s51, 0x50000
    buffer_store_dwordx2 v[220:221], v4, s[52:55], s51 offen offset:64 sc1
    v_cvt_pk_bf16_f32 v224, v224, v225
    v_cvt_pk_bf16_f32 v225, v226, v227
    s_mov_b32 s51, 0x0
    buffer_store_dwordx2 v[224:225], v4, s[52:55], s51 offen offset:96 sc1
    v_cvt_pk_bf16_f32 v228, v228, v229
    v_cvt_pk_bf16_f32 v229, v230, v231
    s_mov_b32 s51, 0x10000
    buffer_store_dwordx2 v[228:229], v4, s[52:55], s51 offen offset:96 sc1
    v_cvt_pk_bf16_f32 v232, v232, v233
    v_cvt_pk_bf16_f32 v233, v234, v235
    s_mov_b32 s51, 0x20000
    buffer_store_dwordx2 v[232:233], v4, s[52:55], s51 offen offset:96 sc1
    v_cvt_pk_bf16_f32 v236, v236, v237
    v_cvt_pk_bf16_f32 v237, v238, v239
    s_mov_b32 s51, 0x30000
    buffer_store_dwordx2 v[236:237], v4, s[52:55], s51 offen offset:96 sc1
    v_cvt_pk_bf16_f32 v240, v240, v241
    v_cvt_pk_bf16_f32 v241, v242, v243
    s_mov_b32 s51, 0x40000
    buffer_store_dwordx2 v[240:241], v4, s[52:55], s51 offen offset:96 sc1
    v_cvt_pk_bf16_f32 v244, v244, v245
    v_cvt_pk_bf16_f32 v245, v246, v247
    s_mov_b32 s51, 0x50000
    buffer_store_dwordx2 v[244:245], v4, s[52:55], s51 offen offset:96 sc1
TE_8:
    s_branch KW_next
KW_gate:
    v_and_b32 v1, 63, v0
    v_lshrrev_b32 v2, 4, v1
    v_and_b32 v3, 15, v1
    v_and_b32 v4, 7, v1
    v_lshlrev_b32 v5, 2, v2
    v_add_u32 v6, 0, v5
    v_cmp_le_u32 s[76:77], v6, v3
    v_add_u32 v6, 1, v5
    v_cmp_le_u32 s[78:79], v6, v3
    v_add_u32 v6, 2, v5
    v_cmp_le_u32 s[80:81], v6, v3
    v_add_u32 v6, 3, v5
    v_cmp_le_u32 s[82:83], v6, v3
    s_mov_b32 s72, 0
    s_mov_b32 s73, -1
    s_mov_b32 s74, 0xff800000
    s_sub_u32 s36, s89, 1680
    s_lshl_b32 s36, s36, 2
    s_add_u32 s36, s36, s4
    s_mov_b32 s40, s8
    s_mov_b32 s41, s9
    s_mov_b32 s42, 0x240000
    s_mov_b32 s43, 0x00020000
    s_mov_b32 s44, s28
    s_mov_b32 s45, s29
    s_mov_b32 s46, 0x480
    s_mov_b32 s47, 0x00020000
    s_add_u32 s48, s34, 0x5700000
    s_addc_u32 s49, s35, 0
    s_mov_b32 s50, 0x2000
    s_mov_b32 s51, 0x00020000
    v_lshrrev_b32 v8, 3, v1
    v_mul_u32_u24 v9, 144, v4
    v_mul_u32_u24 v10, 1152, v8
    v_add_u32 v10, v10, v9
    s_mul_i32 s64, s36, 9216
    buffer_load_dwordx4 v[16:19], v10, s[40:43], s64 offen offset:0
    buffer_load_dwordx4 v[52:55], v9, s[44:47], 0 offen offset:0
    buffer_load_dwordx4 v[20:23], v10, s[40:43], s64 offen offset:16
    buffer_load_dwordx4 v[56:59], v9, s[44:47], 0 offen offset:16
    buffer_load_dwordx4 v[24:27], v10, s[40:43], s64 offen offset:32
    buffer_load_dwordx4 v[60:63], v9, s[44:47], 0 offen offset:32
    buffer_load_dwordx4 v[28:31], v10, s[40:43], s64 offen offset:48
    buffer_load_dwordx4 v[64:67], v9, s[44:47], 0 offen offset:48
    buffer_load_dwordx4 v[32:35], v10, s[40:43], s64 offen offset:64
    buffer_load_dwordx4 v[68:71], v9, s[44:47], 0 offen offset:64
    buffer_load_dwordx4 v[36:39], v10, s[40:43], s64 offen offset:80
    buffer_load_dwordx4 v[72:75], v9, s[44:47], 0 offen offset:80
    buffer_load_dwordx4 v[40:43], v10, s[40:43], s64 offen offset:96
    buffer_load_dwordx4 v[76:79], v9, s[44:47], 0 offen offset:96
    buffer_load_dwordx4 v[44:47], v10, s[40:43], s64 offen offset:112
    buffer_load_dwordx4 v[80:83], v9, s[44:47], 0 offen offset:112
    buffer_load_dwordx4 v[48:51], v10, s[40:43], s64 offen offset:128
    buffer_load_dwordx4 v[84:87], v9, s[44:47], 0 offen offset:128
    v_mov_b32 v12, 0
    s_waitcnt vmcnt(0)
    v_lshlrev_b32 v13, 16, v16
    v_lshlrev_b32 v14, 16, v52
    v_mul_f32 v13, v13, v14
    v_and_b32 v14, 0xffff0000, v16
    v_and_b32 v15, 0xffff0000, v52
    v_mul_f32 v14, v14, v15
    v_cvt_pk_bf16_f32 v15, v13, v14
    v_lshlrev_b32 v13, 16, v15
    v_and_b32 v14, 0xffff0000, v15
    v_add_f32 v12, v12, v13
    v_add_f32 v12, v12, v14
    v_lshlrev_b32 v13, 16, v17
    v_lshlrev_b32 v14, 16, v53
    v_mul_f32 v13, v13, v14
    v_and_b32 v14, 0xffff0000, v17
    v_and_b32 v15, 0xffff0000, v53
    v_mul_f32 v14, v14, v15
    v_cvt_pk_bf16_f32 v15, v13, v14
    v_lshlrev_b32 v13, 16, v15
    v_and_b32 v14, 0xffff0000, v15
    v_add_f32 v12, v12, v13
    v_add_f32 v12, v12, v14
    v_lshlrev_b32 v13, 16, v18
    v_lshlrev_b32 v14, 16, v54
    v_mul_f32 v13, v13, v14
    v_and_b32 v14, 0xffff0000, v18
    v_and_b32 v15, 0xffff0000, v54
    v_mul_f32 v14, v14, v15
    v_cvt_pk_bf16_f32 v15, v13, v14
    v_lshlrev_b32 v13, 16, v15
    v_and_b32 v14, 0xffff0000, v15
    v_add_f32 v12, v12, v13
    v_add_f32 v12, v12, v14
    v_lshlrev_b32 v13, 16, v19
    v_lshlrev_b32 v14, 16, v55
    v_mul_f32 v13, v13, v14
    v_and_b32 v14, 0xffff0000, v19
    v_and_b32 v15, 0xffff0000, v55
    v_mul_f32 v14, v14, v15
    v_cvt_pk_bf16_f32 v15, v13, v14
    v_lshlrev_b32 v13, 16, v15
    v_and_b32 v14, 0xffff0000, v15
    v_add_f32 v12, v12, v13
    v_add_f32 v12, v12, v14
    v_lshlrev_b32 v13, 16, v20
    v_lshlrev_b32 v14, 16, v56
    v_mul_f32 v13, v13, v14
    v_and_b32 v14, 0xffff0000, v20
    v_and_b32 v15, 0xffff0000, v56
    v_mul_f32 v14, v14, v15
    v_cvt_pk_bf16_f32 v15, v13, v14
    v_lshlrev_b32 v13, 16, v15
    v_and_b32 v14, 0xffff0000, v15
    v_add_f32 v12, v12, v13
    v_add_f32 v12, v12, v14
    v_lshlrev_b32 v13, 16, v21
    v_lshlrev_b32 v14, 16, v57
    v_mul_f32 v13, v13, v14
    v_and_b32 v14, 0xffff0000, v21
    v_and_b32 v15, 0xffff0000, v57
    v_mul_f32 v14, v14, v15
    v_cvt_pk_bf16_f32 v15, v13, v14
    v_lshlrev_b32 v13, 16, v15
    v_and_b32 v14, 0xffff0000, v15
    v_add_f32 v12, v12, v13
    v_add_f32 v12, v12, v14
    v_lshlrev_b32 v13, 16, v22
    v_lshlrev_b32 v14, 16, v58
    v_mul_f32 v13, v13, v14
    v_and_b32 v14, 0xffff0000, v22
    v_and_b32 v15, 0xffff0000, v58
    v_mul_f32 v14, v14, v15
    v_cvt_pk_bf16_f32 v15, v13, v14
    v_lshlrev_b32 v13, 16, v15
    v_and_b32 v14, 0xffff0000, v15
    v_add_f32 v12, v12, v13
    v_add_f32 v12, v12, v14
    v_lshlrev_b32 v13, 16, v23
    v_lshlrev_b32 v14, 16, v59
    v_mul_f32 v13, v13, v14
    v_and_b32 v14, 0xffff0000, v23
    v_and_b32 v15, 0xffff0000, v59
    v_mul_f32 v14, v14, v15
    v_cvt_pk_bf16_f32 v15, v13, v14
    v_lshlrev_b32 v13, 16, v15
    v_and_b32 v14, 0xffff0000, v15
    v_add_f32 v12, v12, v13
    v_add_f32 v12, v12, v14
    v_lshlrev_b32 v13, 16, v24
    v_lshlrev_b32 v14, 16, v60
    v_mul_f32 v13, v13, v14
    v_and_b32 v14, 0xffff0000, v24
    v_and_b32 v15, 0xffff0000, v60
    v_mul_f32 v14, v14, v15
    v_cvt_pk_bf16_f32 v15, v13, v14
    v_lshlrev_b32 v13, 16, v15
    v_and_b32 v14, 0xffff0000, v15
    v_add_f32 v12, v12, v13
    v_add_f32 v12, v12, v14
    v_lshlrev_b32 v13, 16, v25
    v_lshlrev_b32 v14, 16, v61
    v_mul_f32 v13, v13, v14
    v_and_b32 v14, 0xffff0000, v25
    v_and_b32 v15, 0xffff0000, v61
    v_mul_f32 v14, v14, v15
    v_cvt_pk_bf16_f32 v15, v13, v14
    v_lshlrev_b32 v13, 16, v15
    v_and_b32 v14, 0xffff0000, v15
    v_add_f32 v12, v12, v13
    v_add_f32 v12, v12, v14
    v_lshlrev_b32 v13, 16, v26
    v_lshlrev_b32 v14, 16, v62
    v_mul_f32 v13, v13, v14
    v_and_b32 v14, 0xffff0000, v26
    v_and_b32 v15, 0xffff0000, v62
    v_mul_f32 v14, v14, v15
    v_cvt_pk_bf16_f32 v15, v13, v14
    v_lshlrev_b32 v13, 16, v15
    v_and_b32 v14, 0xffff0000, v15
    v_add_f32 v12, v12, v13
    v_add_f32 v12, v12, v14
    v_lshlrev_b32 v13, 16, v27
    v_lshlrev_b32 v14, 16, v63
    v_mul_f32 v13, v13, v14
    v_and_b32 v14, 0xffff0000, v27
    v_and_b32 v15, 0xffff0000, v63
    v_mul_f32 v14, v14, v15
    v_cvt_pk_bf16_f32 v15, v13, v14
    v_lshlrev_b32 v13, 16, v15
    v_and_b32 v14, 0xffff0000, v15
    v_add_f32 v12, v12, v13
    v_add_f32 v12, v12, v14
    v_lshlrev_b32 v13, 16, v28
    v_lshlrev_b32 v14, 16, v64
    v_mul_f32 v13, v13, v14
    v_and_b32 v14, 0xffff0000, v28
    v_and_b32 v15, 0xffff0000, v64
    v_mul_f32 v14, v14, v15
    v_cvt_pk_bf16_f32 v15, v13, v14
    v_lshlrev_b32 v13, 16, v15
    v_and_b32 v14, 0xffff0000, v15
    v_add_f32 v12, v12, v13
    v_add_f32 v12, v12, v14
    v_lshlrev_b32 v13, 16, v29
    v_lshlrev_b32 v14, 16, v65
    v_mul_f32 v13, v13, v14
    v_and_b32 v14, 0xffff0000, v29
    v_and_b32 v15, 0xffff0000, v65
    v_mul_f32 v14, v14, v15
    v_cvt_pk_bf16_f32 v15, v13, v14
    v_lshlrev_b32 v13, 16, v15
    v_and_b32 v14, 0xffff0000, v15
    v_add_f32 v12, v12, v13
    v_add_f32 v12, v12, v14
    v_lshlrev_b32 v13, 16, v30
    v_lshlrev_b32 v14, 16, v66
    v_mul_f32 v13, v13, v14
    v_and_b32 v14, 0xffff0000, v30
    v_and_b32 v15, 0xffff0000, v66
    v_mul_f32 v14, v14, v15
    v_cvt_pk_bf16_f32 v15, v13, v14
    v_lshlrev_b32 v13, 16, v15
    v_and_b32 v14, 0xffff0000, v15
    v_add_f32 v12, v12, v13
    v_add_f32 v12, v12, v14
    v_lshlrev_b32 v13, 16, v31
    v_lshlrev_b32 v14, 16, v67
    v_mul_f32 v13, v13, v14
    v_and_b32 v14, 0xffff0000, v31
    v_and_b32 v15, 0xffff0000, v67
    v_mul_f32 v14, v14, v15
    v_cvt_pk_bf16_f32 v15, v13, v14
    v_lshlrev_b32 v13, 16, v15
    v_and_b32 v14, 0xffff0000, v15
    v_add_f32 v12, v12, v13
    v_add_f32 v12, v12, v14
    v_lshlrev_b32 v13, 16, v32
    v_lshlrev_b32 v14, 16, v68
    v_mul_f32 v13, v13, v14
    v_and_b32 v14, 0xffff0000, v32
    v_and_b32 v15, 0xffff0000, v68
    v_mul_f32 v14, v14, v15
    v_cvt_pk_bf16_f32 v15, v13, v14
    v_lshlrev_b32 v13, 16, v15
    v_and_b32 v14, 0xffff0000, v15
    v_add_f32 v12, v12, v13
    v_add_f32 v12, v12, v14
    v_lshlrev_b32 v13, 16, v33
    v_lshlrev_b32 v14, 16, v69
    v_mul_f32 v13, v13, v14
    v_and_b32 v14, 0xffff0000, v33
    v_and_b32 v15, 0xffff0000, v69
    v_mul_f32 v14, v14, v15
    v_cvt_pk_bf16_f32 v15, v13, v14
    v_lshlrev_b32 v13, 16, v15
    v_and_b32 v14, 0xffff0000, v15
    v_add_f32 v12, v12, v13
    v_add_f32 v12, v12, v14
    v_lshlrev_b32 v13, 16, v34
    v_lshlrev_b32 v14, 16, v70
    v_mul_f32 v13, v13, v14
    v_and_b32 v14, 0xffff0000, v34
    v_and_b32 v15, 0xffff0000, v70
    v_mul_f32 v14, v14, v15
    v_cvt_pk_bf16_f32 v15, v13, v14
    v_lshlrev_b32 v13, 16, v15
    v_and_b32 v14, 0xffff0000, v15
    v_add_f32 v12, v12, v13
    v_add_f32 v12, v12, v14
    v_lshlrev_b32 v13, 16, v35
    v_lshlrev_b32 v14, 16, v71
    v_mul_f32 v13, v13, v14
    v_and_b32 v14, 0xffff0000, v35
    v_and_b32 v15, 0xffff0000, v71
    v_mul_f32 v14, v14, v15
    v_cvt_pk_bf16_f32 v15, v13, v14
    v_lshlrev_b32 v13, 16, v15
    v_and_b32 v14, 0xffff0000, v15
    v_add_f32 v12, v12, v13
    v_add_f32 v12, v12, v14
    v_lshlrev_b32 v13, 16, v36
    v_lshlrev_b32 v14, 16, v72
    v_mul_f32 v13, v13, v14
    v_and_b32 v14, 0xffff0000, v36
    v_and_b32 v15, 0xffff0000, v72
    v_mul_f32 v14, v14, v15
    v_cvt_pk_bf16_f32 v15, v13, v14
    v_lshlrev_b32 v13, 16, v15
    v_and_b32 v14, 0xffff0000, v15
    v_add_f32 v12, v12, v13
    v_add_f32 v12, v12, v14
    v_lshlrev_b32 v13, 16, v37
    v_lshlrev_b32 v14, 16, v73
    v_mul_f32 v13, v13, v14
    v_and_b32 v14, 0xffff0000, v37
    v_and_b32 v15, 0xffff0000, v73
    v_mul_f32 v14, v14, v15
    v_cvt_pk_bf16_f32 v15, v13, v14
    v_lshlrev_b32 v13, 16, v15
    v_and_b32 v14, 0xffff0000, v15
    v_add_f32 v12, v12, v13
    v_add_f32 v12, v12, v14
    v_lshlrev_b32 v13, 16, v38
    v_lshlrev_b32 v14, 16, v74
    v_mul_f32 v13, v13, v14
    v_and_b32 v14, 0xffff0000, v38
    v_and_b32 v15, 0xffff0000, v74
    v_mul_f32 v14, v14, v15
    v_cvt_pk_bf16_f32 v15, v13, v14
    v_lshlrev_b32 v13, 16, v15
    v_and_b32 v14, 0xffff0000, v15
    v_add_f32 v12, v12, v13
    v_add_f32 v12, v12, v14
    v_lshlrev_b32 v13, 16, v39
    v_lshlrev_b32 v14, 16, v75
    v_mul_f32 v13, v13, v14
    v_and_b32 v14, 0xffff0000, v39
    v_and_b32 v15, 0xffff0000, v75
    v_mul_f32 v14, v14, v15
    v_cvt_pk_bf16_f32 v15, v13, v14
    v_lshlrev_b32 v13, 16, v15
    v_and_b32 v14, 0xffff0000, v15
    v_add_f32 v12, v12, v13
    v_add_f32 v12, v12, v14
    v_lshlrev_b32 v13, 16, v40
    v_lshlrev_b32 v14, 16, v76
    v_mul_f32 v13, v13, v14
    v_and_b32 v14, 0xffff0000, v40
    v_and_b32 v15, 0xffff0000, v76
    v_mul_f32 v14, v14, v15
    v_cvt_pk_bf16_f32 v15, v13, v14
    v_lshlrev_b32 v13, 16, v15
    v_and_b32 v14, 0xffff0000, v15
    v_add_f32 v12, v12, v13
    v_add_f32 v12, v12, v14
    v_lshlrev_b32 v13, 16, v41
    v_lshlrev_b32 v14, 16, v77
    v_mul_f32 v13, v13, v14
    v_and_b32 v14, 0xffff0000, v41
    v_and_b32 v15, 0xffff0000, v77
    v_mul_f32 v14, v14, v15
    v_cvt_pk_bf16_f32 v15, v13, v14
    v_lshlrev_b32 v13, 16, v15
    v_and_b32 v14, 0xffff0000, v15
    v_add_f32 v12, v12, v13
    v_add_f32 v12, v12, v14
    v_lshlrev_b32 v13, 16, v42
    v_lshlrev_b32 v14, 16, v78
    v_mul_f32 v13, v13, v14
    v_and_b32 v14, 0xffff0000, v42
    v_and_b32 v15, 0xffff0000, v78
    v_mul_f32 v14, v14, v15
    v_cvt_pk_bf16_f32 v15, v13, v14
    v_lshlrev_b32 v13, 16, v15
    v_and_b32 v14, 0xffff0000, v15
    v_add_f32 v12, v12, v13
    v_add_f32 v12, v12, v14
    v_lshlrev_b32 v13, 16, v43
    v_lshlrev_b32 v14, 16, v79
    v_mul_f32 v13, v13, v14
    v_and_b32 v14, 0xffff0000, v43
    v_and_b32 v15, 0xffff0000, v79
    v_mul_f32 v14, v14, v15
    v_cvt_pk_bf16_f32 v15, v13, v14
    v_lshlrev_b32 v13, 16, v15
    v_and_b32 v14, 0xffff0000, v15
    v_add_f32 v12, v12, v13
    v_add_f32 v12, v12, v14
    v_lshlrev_b32 v13, 16, v44
    v_lshlrev_b32 v14, 16, v80
    v_mul_f32 v13, v13, v14
    v_and_b32 v14, 0xffff0000, v44
    v_and_b32 v15, 0xffff0000, v80
    v_mul_f32 v14, v14, v15
    v_cvt_pk_bf16_f32 v15, v13, v14
    v_lshlrev_b32 v13, 16, v15
    v_and_b32 v14, 0xffff0000, v15
    v_add_f32 v12, v12, v13
    v_add_f32 v12, v12, v14
    v_lshlrev_b32 v13, 16, v45
    v_lshlrev_b32 v14, 16, v81
    v_mul_f32 v13, v13, v14
    v_and_b32 v14, 0xffff0000, v45
    v_and_b32 v15, 0xffff0000, v81
    v_mul_f32 v14, v14, v15
    v_cvt_pk_bf16_f32 v15, v13, v14
    v_lshlrev_b32 v13, 16, v15
    v_and_b32 v14, 0xffff0000, v15
    v_add_f32 v12, v12, v13
    v_add_f32 v12, v12, v14
    v_lshlrev_b32 v13, 16, v46
    v_lshlrev_b32 v14, 16, v82
    v_mul_f32 v13, v13, v14
    v_and_b32 v14, 0xffff0000, v46
    v_and_b32 v15, 0xffff0000, v82
    v_mul_f32 v14, v14, v15
    v_cvt_pk_bf16_f32 v15, v13, v14
    v_lshlrev_b32 v13, 16, v15
    v_and_b32 v14, 0xffff0000, v15
    v_add_f32 v12, v12, v13
    v_add_f32 v12, v12, v14
    v_lshlrev_b32 v13, 16, v47
    v_lshlrev_b32 v14, 16, v83
    v_mul_f32 v13, v13, v14
    v_and_b32 v14, 0xffff0000, v47
    v_and_b32 v15, 0xffff0000, v83
    v_mul_f32 v14, v14, v15
    v_cvt_pk_bf16_f32 v15, v13, v14
    v_lshlrev_b32 v13, 16, v15
    v_and_b32 v14, 0xffff0000, v15
    v_add_f32 v12, v12, v13
    v_add_f32 v12, v12, v14
    v_lshlrev_b32 v13, 16, v48
    v_lshlrev_b32 v14, 16, v84
    v_mul_f32 v13, v13, v14
    v_and_b32 v14, 0xffff0000, v48
    v_and_b32 v15, 0xffff0000, v84
    v_mul_f32 v14, v14, v15
    v_cvt_pk_bf16_f32 v15, v13, v14
    v_lshlrev_b32 v13, 16, v15
    v_and_b32 v14, 0xffff0000, v15
    v_add_f32 v12, v12, v13
    v_add_f32 v12, v12, v14
    v_lshlrev_b32 v13, 16, v49
    v_lshlrev_b32 v14, 16, v85
    v_mul_f32 v13, v13, v14
    v_and_b32 v14, 0xffff0000, v49
    v_and_b32 v15, 0xffff0000, v85
    v_mul_f32 v14, v14, v15
    v_cvt_pk_bf16_f32 v15, v13, v14
    v_lshlrev_b32 v13, 16, v15
    v_and_b32 v14, 0xffff0000, v15
    v_add_f32 v12, v12, v13
    v_add_f32 v12, v12, v14
    v_lshlrev_b32 v13, 16, v50
    v_lshlrev_b32 v14, 16, v86
    v_mul_f32 v13, v13, v14
    v_and_b32 v14, 0xffff0000, v50
    v_and_b32 v15, 0xffff0000, v86
    v_mul_f32 v14, v14, v15
    v_cvt_pk_bf16_f32 v15, v13, v14
    v_lshlrev_b32 v13, 16, v15
    v_and_b32 v14, 0xffff0000, v15
    v_add_f32 v12, v12, v13
    v_add_f32 v12, v12, v14
    v_lshlrev_b32 v13, 16, v51
    v_lshlrev_b32 v14, 16, v87
    v_mul_f32 v13, v13, v14
    v_and_b32 v14, 0xffff0000, v51
    v_and_b32 v15, 0xffff0000, v87
    v_mul_f32 v14, v14, v15
    v_cvt_pk_bf16_f32 v15, v13, v14
    v_lshlrev_b32 v13, 16, v15
    v_and_b32 v14, 0xffff0000, v15
    v_add_f32 v12, v12, v13
    v_add_f32 v12, v12, v14
    ds_swizzle_b32 v13, v12 offset:0x41f
    s_waitcnt lgkmcnt(0)
    v_add_f32 v12, v12, v13
    ds_swizzle_b32 v13, v12 offset:0x81f
    s_waitcnt lgkmcnt(0)
    v_add_f32 v12, v12, v13
    ds_swizzle_b32 v13, v12 offset:0x101f
    s_waitcnt lgkmcnt(0)
    v_add_f32 v12, v12, v13
    v_mov_b32 v13, 0
    v_cvt_pk_bf16_f32 v15, v12, v13
    v_lshlrev_b32 v12, 16, v15
    v_and_b32 v13, 0xffff0000, v15
    v_mul_f32 v12, 0xbfb8aa3b, v12
    v_exp_f32 v12, v12
    s_nop 0
    v_add_f32 v12, 1.0, v12
    v_rcp_f32 v12, v12
    s_nop 0
    v_mov_b32 v13, 0
    v_cvt_pk_bf16_f32 v15, v12, v13
    v_lshlrev_b32 v12, 16, v15
    v_and_b32 v13, 0xffff0000, v15
    v_lshlrev_b32 v8, 2, v8
    s_lshl_b32 s64, s36, 5
    buffer_store_dword v12, v8, s[48:51], s64 offen sc1
KW_next:
    s_add_u32 s89, s89, 224
    s_branch KW_loop
KW_gemm_done:
    s_waitcnt vmcnt(0)
    s_barrier
    s_cmp_lg_u32 s4, 0
    s_cbranch_scc1 KW_bw1
    s_mov_b32 exec_lo, 1
    s_mov_b32 exec_hi, 0
    v_mov_b32 v2, 40
    v_mov_b32 v3, 1
    global_atomic_add v2, v3, s[32:33]
    s_mov_b32 s6, 0
KW_bs1:
    global_load_dword v6, v2, s[32:33] sc1
    s_add_u32 s6, s6, 1
    s_waitcnt vmcnt(0)
    v_readfirstlane_b32 s7, v6
    s_cmp_ge_u32 s6, 0x200000
    s_cbranch_scc1 KW_bg1
    s_cmp_ge_u32 s7, 224
    s_cbranch_scc1 KW_bg1
    s_sleep 8
    s_branch KW_bs1
KW_bg1:
    s_mov_b64 exec, -1
KW_bw1:
    s_barrier
    v_and_b32 v1, 63, v0
    v_lshrrev_b32 v2, 4, v1
    v_and_b32 v3, 15, v1
    v_and_b32 v4, 7, v1
    v_lshlrev_b32 v5, 2, v2
    v_add_u32 v6, 0, v5
    v_cmp_le_u32 s[76:77], v6, v3
    v_add_u32 v6, 1, v5
    v_cmp_le_u32 s[78:79], v6, v3
    v_add_u32 v6, 2, v5
    v_cmp_le_u32 s[80:81], v6, v3
    v_add_u32 v6, 3, v5
    v_cmp_le_u32 s[82:83], v6, v3
    s_mov_b32 s72, 0
    s_mov_b32 s73, -1
    s_mov_b32 s74, 0xff800000
    s_lshl_b32 s89, s88, 2
    s_add_u32 s89, s89, s4
KB_loop:
    s_cmp_ge_u32 s89, 2048
    s_cbranch_scc1 KB_done
    s_mov_b32 s36, s89
    s_add_u32 s40, s34, 0x3000000
    s_addc_u32 s41, s35, 0
    s_mov_b32 s42, 0x480000
    s_mov_b32 s43, 0x00020000
    s_add_u32 s44, s34, 0x3500000
    s_addc_u32 s45, s35, 0
    s_mov_b32 s46, 0x260000
    s_mov_b32 s47, 0x00020000
    s_add_u32 s48, s34, 0x5400000
    s_addc_u32 s49, s35, 0
    s_mov_b32 s50, 0x240000
    s_mov_b32 s51, 0x00020000
    s_and_b32 s38, s36, 31
    s_lshr_b32 s37, s36, 5
    v_mul_u32_u24 v8, 2304, v3
    v_lshl_add_u32 v8, v2, 4, v8
    s_mul_i32 s64, s38, 36
    v_add_u32 v8, s64, v8
    s_mul_i32 s64, s37, 73728
    s_add_u32 s65, s64, 36864
    buffer_load_dwordx4 v[16:19], v8, s[40:43], s64 offen
    buffer_load_dwordx4 v[20:23], v8, s[40:43], s65 offen
    s_sub_u32 s66, s64, 588672
    v_add_u32 v9, s66, v8
    buffer_load_dwordx4 v[24:27], v9, s[40:43], 0 offen
    v_add_u32 v9, 36864, v9
    buffer_load_dwordx4 v[28:31], v9, s[40:43], 0 offen
    v_add_u32 v9, 36864, v9
    buffer_load_dwordx4 v[32:35], v9, s[40:43], 0 offen
    v_add_u32 v9, 36864, v9
    buffer_load_dwordx4 v[36:39], v9, s[40:43], 0 offen
    v_add_u32 v9, 36864, v9
    buffer_load_dwordx4 v[40:43], v9, s[40:43], 0 offen
    v_add_u32 v9, 36864, v9
    buffer_load_dwordx4 v[44:47], v9, s[40:43], 0 offen
    v_add_u32 v9, 36864, v9
    buffer_load_dwordx4 v[48:51], v9, s[40:43], 0 offen
    v_add_u32 v9, 36864, v9
    buffer_load_dwordx4 v[52:55], v9, s[40:43], 0 offen
    v_add_u32 v9, 36864, v9
    buffer_load_dwordx4 v[56:59], v9, s[40:43], 0 offen
    v_add_u32 v9, 36864, v9
    buffer_load_dwordx4 v[60:63], v9, s[40:43], 0 offen
    v_add_u32 v9, 36864, v9
    buffer_load_dwordx4 v[64:67], v9, s[40:43], 0 offen
    v_add_u32 v9, 36864, v9
    buffer_load_dwordx4 v[68:71], v9, s[40:43], 0 offen
    v_add_u32 v9, 36864, v9
    buffer_load_dwordx4 v[72:75], v9, s[40:43], 0 offen
    v_add_u32 v9, 36864, v9
    buffer_load_dwordx4 v[76:79], v9, s[40:43], 0 offen
    v_add_u32 v9, 36864, v9
    buffer_load_dwordx4 v[80:83], v9, s[40:43], 0 offen
    v_add_u32 v9, 36864, v9
    buffer_load_dwordx4 v[84:87], v9, s[40:43], 0 offen
    v_add_u32 v9, 36864, v9
    buffer_load_dwordx4 v[88:91], v9, s[40:43], 0 offen
    v_add_u32 v9, 36864, v9
    buffer_load_dwordx4 v[92:95], v9, s[40:43], 0 offen
    v_cmp_gt_u32 s[84:85], 3, v2
    v_cmp_gt_u32 s[86:87], 2, v2
    s_waitcnt vmcnt(18)
    v_cndmask_b32 v16, 0, v16, s[84:85]
    v_cndmask_b32 v17, 0, v17, s[86:87]
    v_cndmask_b32 v18, 0, v18, s[86:87]
    v_cndmask_b32 v19, 0, v19, s[86:87]
    v_cndmask_b32 v20, 0, v20, s[84:85]
    v_cndmask_b32 v21, 0, v21, s[86:87]
    v_cndmask_b32 v22, 0, v22, s[86:87]
    v_cndmask_b32 v23, 0, v23, s[86:87]
    s_waitcnt vmcnt(0)
    v_mfma_f32_16x16x32_bf16 v[96:99], v[24:27], v[16:19], 0
    v_mfma_f32_16x16x32_bf16 v[100:103], v[28:31], v[16:19], 0
    v_mfma_f32_16x16x32_bf16 v[104:107], v[32:35], v[16:19], 0
    v_mfma_f32_16x16x32_bf16 v[108:111], v[36:39], v[16:19], 0
    v_mfma_f32_16x16x32_bf16 v[112:115], v[40:43], v[16:19], 0
    v_mfma_f32_16x16x32_bf16 v[116:119], v[44:47], v[16:19], 0
    v_mfma_f32_16x16x32_bf16 v[120:123], v[48:51], v[16:19], 0
    v_mfma_f32_16x16x32_bf16 v[124:127], v[52:55], v[16:19], 0
    v_mfma_f32_16x16x32_bf16 v[128:131], v[56:59], v[16:19], 0
    v_mfma_f32_16x16x32_bf16 v[132:135], v[60:63], v[16:19], 0
    v_mfma_f32_16x16x32_bf16 v[136:139], v[64:67], v[16:19], 0
    v_mfma_f32_16x16x32_bf16 v[140:143], v[68:71], v[16:19], 0
    v_mfma_f32_16x16x32_bf16 v[144:147], v[72:75], v[16:19], 0
    v_mfma_f32_16x16x32_bf16 v[148:151], v[76:79], v[16:19], 0
    v_mfma_f32_16x16x32_bf16 v[152:155], v[80:83], v[16:19], 0
    v_mfma_f32_16x16x32_bf16 v[156:159], v[84:87], v[16:19], 0
    v_mfma_f32_16x16x32_bf16 v[160:163], v[88:91], v[16:19], 0
    v_mfma_f32_16x16x32_bf16 v[164:167], v[28:31], v[20:23], 0
    v_mfma_f32_16x16x32_bf16 v[168:171], v[32:35], v[20:23], 0
    v_mfma_f32_16x16x32_bf16 v[172:175], v[36:39], v[20:23], 0
    v_mfma_f32_16x16x32_bf16 v[176:179], v[40:43], v[20:23], 0
    v_mfma_f32_16x16x32_bf16 v[180:183], v[44:47], v[20:23], 0
    v_mfma_f32_16x16x32_bf16 v[184:187], v[48:51], v[20:23], 0
    v_mfma_f32_16x16x32_bf16 v[188:191], v[52:55], v[20:23], 0
    v_mfma_f32_16x16x32_bf16 v[192:195], v[56:59], v[20:23], 0
    v_mfma_f32_16x16x32_bf16 v[196:199], v[60:63], v[20:23], 0
    v_mfma_f32_16x16x32_bf16 v[200:203], v[64:67], v[20:23], 0
    v_mfma_f32_16x16x32_bf16 v[204:207], v[68:71], v[20:23], 0
    v_mfma_f32_16x16x32_bf16 v[208:211], v[72:75], v[20:23], 0
    v_mfma_f32_16x16x32_bf16 v[212:215], v[76:79], v[20:23], 0
    v_mfma_f32_16x16x32_bf16 v[216:219], v[80:83], v[20:23], 0
    v_mfma_f32_16x16x32_bf16 v[220:223], v[84:87], v[20:23], 0
    v_mfma_f32_16x16x32_bf16 v[224:227], v[88:91], v[20:23], 0
    v_mfma_f32_16x16x32_bf16 v[228:231], v[92:95], v[20:23], 0
    s_nop 7
    s_nop 7
    s_mul_i32 s64, s38, 18
    v_add_u32 v10, s64, v3
    v_lshlrev_b32 v10, 12, v10
    v_lshl_add_u32 v10, v2, 3, v10
    s_lshl_b32 s64, s37, 6
    s_sub_u32 s64, s64, 512
    v_add_u32 v10, s64, v10
    v_add_u32 v11, 0x10000, v10
    buffer_load_dwordx2 v[24:25], v10, s[44:47], 0 offen offset:0
    buffer_load_dwordx2 v[26:27], v10, s[44:47], 0 offen offset:32
    buffer_load_dwordx2 v[28:29], v10, s[44:47], 0 offen offset:64
    buffer_load_dwordx2 v[30:31], v10, s[44:47], 0 offen offset:96
    buffer_load_dwordx2 v[32:33], v10, s[44:47], 0 offen offset:128
    buffer_load_dwordx2 v[34:35], v10, s[44:47], 0 offen offset:160
    buffer_load_dwordx2 v[36:37], v10, s[44:47], 0 offen offset:192
    buffer_load_dwordx2 v[38:39], v10, s[44:47], 0 offen offset:224
    buffer_load_dwordx2 v[40:41], v10, s[44:47], 0 offen offset:256
    buffer_load_dwordx2 v[42:43], v10, s[44:47], 0 offen offset:288
    buffer_load_dwordx2 v[44:45], v10, s[44:47], 0 offen offset:320
    buffer_load_dwordx2 v[46:47], v10, s[44:47], 0 offen offset:352
    buffer_load_dwordx2 v[48:49], v10, s[44:47], 0 offen offset:384
    buffer_load_dwordx2 v[50:51], v10, s[44:47], 0 offen offset:416
    buffer_load_dwordx2 v[52:53], v10, s[44:47], 0 offen offset:448
    buffer_load_dwordx2 v[54:55], v10, s[44:47], 0 offen offset:480
    buffer_load_dwordx2 v[56:57], v10, s[44:47], 0 offen offset:512
    buffer_load_dwordx2 v[58:59], v10, s[44:47], 0 offen offset:544
    buffer_load_dwordx2 v[60:61], v11, s[44:47], 0 offen offset:0
    buffer_load_dwordx2 v[62:63], v11, s[44:47], 0 offen offset:32
    buffer_load_dwordx2 v[64:65], v11, s[44:47], 0 offen offset:64
    buffer_load_dwordx2 v[66:67], v11, s[44:47], 0 offen offset:96
    buffer_load_dwordx2 v[68:69], v11, s[44:47], 0 offen offset:128
    buffer_load_dwordx2 v[70:71], v11, s[44:47], 0 offen offset:160
    buffer_load_dwordx2 v[72:73], v11, s[44:47], 0 offen offset:192
    buffer_load_dwordx2 v[74:75], v11, s[44:47], 0 offen offset:224
    buffer_load_dwordx2 v[76:77], v11, s[44:47], 0 offen offset:256
    buffer_load_dwordx2 v[78:79], v11, s[44:47], 0 offen offset:288
    buffer_load_dwordx2 v[80:81], v11, s[44:47], 0 offen offset:320
    buffer_load_dwordx2 v[82:83], v11, s[44:47], 0 offen offset:352
    buffer_load_dwordx2 v[84:85], v11, s[44:47], 0 offen offset:384
    buffer_load_dwordx2 v[86:87], v11, s[44:47], 0 offen offset:416
    buffer_load_dwordx2 v[88:89], v11, s[44:47], 0 offen offset:448
    buffer_load_dwordx2 v[90:91], v11, s[44:47], 0 offen offset:480
    buffer_load_dwordx2 v[92:93], v11, s[44:47], 0 offen offset:512
    buffer_load_dwordx2 v[94:95], v11, s[44:47], 0 offen offset:544
    s_mov_b32 s68, 0x3e715bef
    s_mov_b32 s69, 0x3fb8aa3b
    v_mov_b32 v12, s74
    s_lshl_b32 s70, s37, 1
    v_cvt_pk_bf16_f32 v14, v96, v97
    v_lshlrev_b32 v96, 16, v14
    v_and_b32 v97, 0xffff0000, v14
    v_mul_f32 v96, s68, v96
    v_mul_f32 v97, s68, v97
    v_cvt_pk_bf16_f32 v14, v96, v97
    v_lshlrev_b32 v96, 16, v14
    v_and_b32 v97, 0xffff0000, v14
    v_cvt_pk_bf16_f32 v14, v98, v99
    v_lshlrev_b32 v98, 16, v14
    v_and_b32 v99, 0xffff0000, v14
    v_mul_f32 v98, s68, v98
    v_mul_f32 v99, s68, v99
    v_cvt_pk_bf16_f32 v14, v98, v99
    v_lshlrev_b32 v98, 16, v14
    v_and_b32 v99, 0xffff0000, v14
    v_cvt_pk_bf16_f32 v14, v100, v101
    v_lshlrev_b32 v100, 16, v14
    v_and_b32 v101, 0xffff0000, v14
    v_mul_f32 v100, s68, v100
    v_mul_f32 v101, s68, v101
    v_cvt_pk_bf16_f32 v14, v100, v101
    v_lshlrev_b32 v100, 16, v14
    v_and_b32 v101, 0xffff0000, v14
    v_cvt_pk_bf16_f32 v14, v102, v103
    v_lshlrev_b32 v102, 16, v14
    v_and_b32 v103, 0xffff0000, v14
    v_mul_f32 v102, s68, v102
    v_mul_f32 v103, s68, v103
    v_cvt_pk_bf16_f32 v14, v102, v103
    v_lshlrev_b32 v102, 16, v14
    v_and_b32 v103, 0xffff0000, v14
    v_cvt_pk_bf16_f32 v14, v104, v105
    v_lshlrev_b32 v104, 16, v14
    v_and_b32 v105, 0xffff0000, v14
    v_mul_f32 v104, s68, v104
    v_mul_f32 v105, s68, v105
    v_cvt_pk_bf16_f32 v14, v104, v105
    v_lshlrev_b32 v104, 16, v14
    v_and_b32 v105, 0xffff0000, v14
    v_cvt_pk_bf16_f32 v14, v106, v107
    v_lshlrev_b32 v106, 16, v14
    v_and_b32 v107, 0xffff0000, v14
    v_mul_f32 v106, s68, v106
    v_mul_f32 v107, s68, v107
    v_cvt_pk_bf16_f32 v14, v106, v107
    v_lshlrev_b32 v106, 16, v14
    v_and_b32 v107, 0xffff0000, v14
    v_cvt_pk_bf16_f32 v14, v108, v109
    v_lshlrev_b32 v108, 16, v14
    v_and_b32 v109, 0xffff0000, v14
    v_mul_f32 v108, s68, v108
    v_mul_f32 v109, s68, v109
    v_cvt_pk_bf16_f32 v14, v108, v109
    v_lshlrev_b32 v108, 16, v14
    v_and_b32 v109, 0xffff0000, v14
    v_cvt_pk_bf16_f32 v14, v110, v111
    v_lshlrev_b32 v110, 16, v14
    v_and_b32 v111, 0xffff0000, v14
    v_mul_f32 v110, s68, v110
    v_mul_f32 v111, s68, v111
    v_cvt_pk_bf16_f32 v14, v110, v111
    v_lshlrev_b32 v110, 16, v14
    v_and_b32 v111, 0xffff0000, v14
    v_cvt_pk_bf16_f32 v14, v112, v113
    v_lshlrev_b32 v112, 16, v14
    v_and_b32 v113, 0xffff0000, v14
    v_mul_f32 v112, s68, v112
    v_mul_f32 v113, s68, v113
    v_cvt_pk_bf16_f32 v14, v112, v113
    v_lshlrev_b32 v112, 16, v14
    v_and_b32 v113, 0xffff0000, v14
    v_cvt_pk_bf16_f32 v14, v114, v115
    v_lshlrev_b32 v114, 16, v14
    v_and_b32 v115, 0xffff0000, v14
    v_mul_f32 v114, s68, v114
    v_mul_f32 v115, s68, v115
    v_cvt_pk_bf16_f32 v14, v114, v115
    v_lshlrev_b32 v114, 16, v14
    v_and_b32 v115, 0xffff0000, v14
    v_cvt_pk_bf16_f32 v14, v116, v117
    v_lshlrev_b32 v116, 16, v14
    v_and_b32 v117, 0xffff0000, v14
    v_mul_f32 v116, s68, v116
    v_mul_f32 v117, s68, v117
    v_cvt_pk_bf16_f32 v14, v116, v117
    v_lshlrev_b32 v116, 16, v14
    v_and_b32 v117, 0xffff0000, v14
    v_cvt_pk_bf16_f32 v14, v118, v119
    v_lshlrev_b32 v118, 16, v14
    v_and_b32 v119, 0xffff0000, v14
    v_mul_f32 v118, s68, v118
    v_mul_f32 v119, s68, v119
    v_cvt_pk_bf16_f32 v14, v118, v119
    v_lshlrev_b32 v118, 16, v14
    v_and_b32 v119, 0xffff0000, v14
    v_cvt_pk_bf16_f32 v14, v120, v121
    v_lshlrev_b32 v120, 16, v14
    v_and_b32 v121, 0xffff0000, v14
    v_mul_f32 v120, s68, v120
    v_mul_f32 v121, s68, v121
    v_cvt_pk_bf16_f32 v14, v120, v121
    v_lshlrev_b32 v120, 16, v14
    v_and_b32 v121, 0xffff0000, v14
    v_cvt_pk_bf16_f32 v14, v122, v123
    v_lshlrev_b32 v122, 16, v14
    v_and_b32 v123, 0xffff0000, v14
    v_mul_f32 v122, s68, v122
    v_mul_f32 v123, s68, v123
    v_cvt_pk_bf16_f32 v14, v122, v123
    v_lshlrev_b32 v122, 16, v14
    v_and_b32 v123, 0xffff0000, v14
    v_cvt_pk_bf16_f32 v14, v124, v125
    v_lshlrev_b32 v124, 16, v14
    v_and_b32 v125, 0xffff0000, v14
    v_mul_f32 v124, s68, v124
    v_mul_f32 v125, s68, v125
    v_cvt_pk_bf16_f32 v14, v124, v125
    v_lshlrev_b32 v124, 16, v14
    v_and_b32 v125, 0xffff0000, v14
    v_cvt_pk_bf16_f32 v14, v126, v127
    v_lshlrev_b32 v126, 16, v14
    v_and_b32 v127, 0xffff0000, v14
    v_mul_f32 v126, s68, v126
    v_mul_f32 v127, s68, v127
    v_cvt_pk_bf16_f32 v14, v126, v127
    v_lshlrev_b32 v126, 16, v14
    v_and_b32 v127, 0xffff0000, v14
    v_cvt_pk_bf16_f32 v14, v128, v129
    v_lshlrev_b32 v128, 16, v14
    v_and_b32 v129, 0xffff0000, v14
    v_mul_f32 v128, s68, v128
    v_mul_f32 v129, s68, v129
    v_cvt_pk_bf16_f32 v14, v128, v129
    v_lshlrev_b32 v128, 16, v14
    v_and_b32 v129, 0xffff0000, v14
    v_cvt_pk_bf16_f32 v14, v130, v131
    v_lshlrev_b32 v130, 16, v14
    v_and_b32 v131, 0xffff0000, v14
    v_mul_f32 v130, s68, v130
    v_mul_f32 v131, s68, v131
    v_cvt_pk_bf16_f32 v14, v130, v131
    v_lshlrev_b32 v130, 16, v14
    v_and_b32 v131, 0xffff0000, v14
    v_cvt_pk_bf16_f32 v14, v132, v133
    v_lshlrev_b32 v132, 16, v14
    v_and_b32 v133, 0xffff0000, v14
    v_mul_f32 v132, s68, v132
    v_mul_f32 v133, s68, v133
    v_cvt_pk_bf16_f32 v14, v132, v133
    v_lshlrev_b32 v132, 16, v14
    v_and_b32 v133, 0xffff0000, v14
    v_cvt_pk_bf16_f32 v14, v134, v135
    v_lshlrev_b32 v134, 16, v14
    v_and_b32 v135, 0xffff0000, v14
    v_mul_f32 v134, s68, v134
    v_mul_f32 v135, s68, v135
    v_cvt_pk_bf16_f32 v14, v134, v135
    v_lshlrev_b32 v134, 16, v14
    v_and_b32 v135, 0xffff0000, v14
    v_cvt_pk_bf16_f32 v14, v136, v137
    v_lshlrev_b32 v136, 16, v14
    v_and_b32 v137, 0xffff0000, v14
    v_mul_f32 v136, s68, v136
    v_mul_f32 v137, s68, v137
    v_cvt_pk_bf16_f32 v14, v136, v137
    v_lshlrev_b32 v136, 16, v14
    v_and_b32 v137, 0xffff0000, v14
    v_cvt_pk_bf16_f32 v14, v138, v139
    v_lshlrev_b32 v138, 16, v14
    v_and_b32 v139, 0xffff0000, v14
    v_mul_f32 v138, s68, v138
    v_mul_f32 v139, s68, v139
    v_cvt_pk_bf16_f32 v14, v138, v139
    v_lshlrev_b32 v138, 16, v14
    v_and_b32 v139, 0xffff0000, v14
    v_cvt_pk_bf16_f32 v14, v140, v141
    v_lshlrev_b32 v140, 16, v14
    v_and_b32 v141, 0xffff0000, v14
    v_mul_f32 v140, s68, v140
    v_mul_f32 v141, s68, v141
    v_cvt_pk_bf16_f32 v14, v140, v141
    v_lshlrev_b32 v140, 16, v14
    v_and_b32 v141, 0xffff0000, v14
    v_cvt_pk_bf16_f32 v14, v142, v143
    v_lshlrev_b32 v142, 16, v14
    v_and_b32 v143, 0xffff0000, v14
    v_mul_f32 v142, s68, v142
    v_mul_f32 v143, s68, v143
    v_cvt_pk_bf16_f32 v14, v142, v143
    v_lshlrev_b32 v142, 16, v14
    v_and_b32 v143, 0xffff0000, v14
    v_cvt_pk_bf16_f32 v14, v144, v145
    v_lshlrev_b32 v144, 16, v14
    v_and_b32 v145, 0xffff0000, v14
    v_mul_f32 v144, s68, v144
    v_mul_f32 v145, s68, v145
    v_cvt_pk_bf16_f32 v14, v144, v145
    v_lshlrev_b32 v144, 16, v14
    v_and_b32 v145, 0xffff0000, v14
    v_cvt_pk_bf16_f32 v14, v146, v147
    v_lshlrev_b32 v146, 16, v14
    v_and_b32 v147, 0xffff0000, v14
    v_mul_f32 v146, s68, v146
    v_mul_f32 v147, s68, v147
    v_cvt_pk_bf16_f32 v14, v146, v147
    v_lshlrev_b32 v146, 16, v14
    v_and_b32 v147, 0xffff0000, v14
    v_cvt_pk_bf16_f32 v14, v148, v149
    v_lshlrev_b32 v148, 16, v14
    v_and_b32 v149, 0xffff0000, v14
    v_mul_f32 v148, s68, v148
    v_mul_f32 v149, s68, v149
    v_cvt_pk_bf16_f32 v14, v148, v149
    v_lshlrev_b32 v148, 16, v14
    v_and_b32 v149, 0xffff0000, v14
    v_cvt_pk_bf16_f32 v14, v150, v151
    v_lshlrev_b32 v150, 16, v14
    v_and_b32 v151, 0xffff0000, v14
    v_mul_f32 v150, s68, v150
    v_mul_f32 v151, s68, v151
    v_cvt_pk_bf16_f32 v14, v150, v151
    v_lshlrev_b32 v150, 16, v14
    v_and_b32 v151, 0xffff0000, v14
    v_cvt_pk_bf16_f32 v14, v152, v153
    v_lshlrev_b32 v152, 16, v14
    v_and_b32 v153, 0xffff0000, v14
    v_mul_f32 v152, s68, v152
    v_mul_f32 v153, s68, v153
    v_cvt_pk_bf16_f32 v14, v152, v153
    v_lshlrev_b32 v152, 16, v14
    v_and_b32 v153, 0xffff0000, v14
    v_cvt_pk_bf16_f32 v14, v154, v155
    v_lshlrev_b32 v154, 16, v14
    v_and_b32 v155, 0xffff0000, v14
    v_mul_f32 v154, s68, v154
    v_mul_f32 v155, s68, v155
    v_cvt_pk_bf16_f32 v14, v154, v155
    v_lshlrev_b32 v154, 16, v14
    v_and_b32 v155, 0xffff0000, v14
    v_cvt_pk_bf16_f32 v14, v156, v157
    v_lshlrev_b32 v156, 16, v14
    v_and_b32 v157, 0xffff0000, v14
    v_mul_f32 v156, s68, v156
    v_mul_f32 v157, s68, v157
    v_cvt_pk_bf16_f32 v14, v156, v157
    v_lshlrev_b32 v156, 16, v14
    v_and_b32 v157, 0xffff0000, v14
    v_cvt_pk_bf16_f32 v14, v158, v159
    v_lshlrev_b32 v158, 16, v14
    v_and_b32 v159, 0xffff0000, v14
    v_mul_f32 v158, s68, v158
    v_mul_f32 v159, s68, v159
    v_cvt_pk_bf16_f32 v14, v158, v159
    v_lshlrev_b32 v158, 16, v14
    v_and_b32 v159, 0xffff0000, v14
    v_cvt_pk_bf16_f32 v14, v160, v161
    v_lshlrev_b32 v160, 16, v14
    v_and_b32 v161, 0xffff0000, v14
    v_mul_f32 v160, s68, v160
    v_mul_f32 v161, s68, v161
    v_cvt_pk_bf16_f32 v14, v160, v161
    v_lshlrev_b32 v160, 16, v14
    v_and_b32 v161, 0xffff0000, v14
    v_cvt_pk_bf16_f32 v14, v162, v163
    v_lshlrev_b32 v162, 16, v14
    v_and_b32 v163, 0xffff0000, v14
    v_mul_f32 v162, s68, v162
    v_mul_f32 v163, s68, v163
    v_cvt_pk_bf16_f32 v14, v162, v163
    v_lshlrev_b32 v162, 16, v14
    v_and_b32 v163, 0xffff0000, v14
    v_cndmask_b32 v96, v96, v12, s[76:77]
    v_cndmask_b32 v97, v97, v12, s[78:79]
    v_cndmask_b32 v98, v98, v12, s[80:81]
    v_cndmask_b32 v99, v99, v12, s[82:83]
    v_cndmask_b32 v160, v12, v160, s[76:77]
    v_cndmask_b32 v161, v12, v161, s[78:79]
    v_cndmask_b32 v162, v12, v162, s[80:81]
    v_cndmask_b32 v163, v12, v163, s[82:83]
    s_add_u32 s71, s70, 0
    s_cmp_lt_u32 s71, 16
    s_cselect_b32 s71, s74, 0
    v_add_f32 v96, s71, v96
    v_add_f32 v97, s71, v97
    v_add_f32 v98, s71, v98
    v_add_f32 v99, s71, v99
    s_add_u32 s71, s70, 1
    s_cmp_lt_u32 s71, 16
    s_cselect_b32 s71, s74, 0
    v_add_f32 v100, s71, v100
    v_add_f32 v101, s71, v101
    v_add_f32 v102, s71, v102
    v_add_f32 v103, s71, v103
    s_add_u32 s71, s70, 2
    s_cmp_lt_u32 s71, 16
    s_cselect_b32 s71, s74, 0
    v_add_f32 v104, s71, v104
    v_add_f32 v105, s71, v105
    v_add_f32 v106, s71, v106
    v_add_f32 v107, s71, v107
    s_add_u32 s71, s70, 3
    s_cmp_lt_u32 s71, 16
    s_cselect_b32 s71, s74, 0
    v_add_f32 v108, s71, v108
    v_add_f32 v109, s71, v109
    v_add_f32 v110, s71, v110
    v_add_f32 v111, s71, v111
    s_add_u32 s71, s70, 4
    s_cmp_lt_u32 s71, 16
    s_cselect_b32 s71, s74, 0
    v_add_f32 v112, s71, v112
    v_add_f32 v113, s71, v113
    v_add_f32 v114, s71, v114
    v_add_f32 v115, s71, v115
    s_add_u32 s71, s70, 5
    s_cmp_lt_u32 s71, 16
    s_cselect_b32 s71, s74, 0
    v_add_f32 v116, s71, v116
    v_add_f32 v117, s71, v117
    v_add_f32 v118, s71, v118
    v_add_f32 v119, s71, v119
    s_add_u32 s71, s70, 6
    s_cmp_lt_u32 s71, 16
    s_cselect_b32 s71, s74, 0
    v_add_f32 v120, s71, v120
    v_add_f32 v121, s71, v121
    v_add_f32 v122, s71, v122
    v_add_f32 v123, s71, v123
    s_add_u32 s71, s70, 7
    s_cmp_lt_u32 s71, 16
    s_cselect_b32 s71, s74, 0
    v_add_f32 v124, s71, v124
    v_add_f32 v125, s71, v125
    v_add_f32 v126, s71, v126
    v_add_f32 v127, s71, v127
    s_add_u32 s71, s70, 8
    s_cmp_lt_u32 s71, 16
    s_cselect_b32 s71, s74, 0
    v_add_f32 v128, s71, v128
    v_add_f32 v129, s71, v129
    v_add_f32 v130, s71, v130
    v_add_f32 v131, s71, v131
    s_add_u32 s71, s70, 9
    s_cmp_lt_u32 s71, 16
    s_cselect_b32 s71, s74, 0
    v_add_f32 v132, s71, v132
    v_add_f32 v133, s71, v133
    v_add_f32 v134, s71, v134
    v_add_f32 v135, s71, v135
    s_add_u32 s71, s70, 10
    s_cmp_lt_u32 s71, 16
    s_cselect_b32 s71, s74, 0
    v_add_f32 v136, s71, v136
    v_add_f32 v137, s71, v137
    v_add_f32 v138, s71, v138
    v_add_f32 v139, s71, v139
    s_add_u32 s71, s70, 11
    s_cmp_lt_u32 s71, 16
    s_cselect_b32 s71, s74, 0
    v_add_f32 v140, s71, v140
    v_add_f32 v141, s71, v141
    v_add_f32 v142, s71, v142
    v_add_f32 v143, s71, v143
    s_add_u32 s71, s70, 12
    s_cmp_lt_u32 s71, 16
    s_cselect_b32 s71, s74, 0
    v_add_f32 v144, s71, v144
    v_add_f32 v145, s71, v145
    v_add_f32 v146, s71, v146
    v_add_f32 v147, s71, v147
    s_add_u32 s71, s70, 13
    s_cmp_lt_u32 s71, 16
    s_cselect_b32 s71, s74, 0
    v_add_f32 v148, s71, v148
    v_add_f32 v149, s71, v149
    v_add_f32 v150, s71, v150
    v_add_f32 v151, s71, v151
    s_add_u32 s71, s70, 14
    s_cmp_lt_u32 s71, 16
    s_cselect_b32 s71, s74, 0
    v_add_f32 v152, s71, v152
    v_add_f32 v153, s71, v153
    v_add_f32 v154, s71, v154
    v_add_f32 v155, s71, v155
    s_add_u32 s71, s70, 15
    s_cmp_lt_u32 s71, 16
    s_cselect_b32 s71, s74, 0
    v_add_f32 v156, s71, v156
    v_add_f32 v157, s71, v157
    v_add_f32 v158, s71, v158
    v_add_f32 v159, s71, v159
    v_max_f32 v13, v96, v97
    v_max3_f32 v13, v13, v98, v99
    v_max3_f32 v13, v13, v100, v101
    v_max3_f32 v13, v13, v102, v103
    v_max3_f32 v13, v13, v104, v105
    v_max3_f32 v13, v13, v106, v107
    v_max3_f32 v13, v13, v108, v109
    v_max3_f32 v13, v13, v110, v111
    v_max3_f32 v13, v13, v112, v113
    v_max3_f32 v13, v13, v114, v115
    v_max3_f32 v13, v13, v116, v117
    v_max3_f32 v13, v13, v118, v119
    v_max3_f32 v13, v13, v120, v121
    v_max3_f32 v13, v13, v122, v123
    v_max3_f32 v13, v13, v124, v125
    v_max3_f32 v13, v13, v126, v127
    v_max3_f32 v13, v13, v128, v129
    v_max3_f32 v13, v13, v130, v131
    v_max3_f32 v13, v13, v132, v133
    v_max3_f32 v13, v13, v134, v135
    v_max3_f32 v13, v13, v136, v137
    v_max3_f32 v13, v13, v138, v139
    v_max3_f32 v13, v13, v140, v141
    v_max3_f32 v13, v13, v142, v143
    v_max3_f32 v13, v13, v144, v145
    v_max3_f32 v13, v13, v146, v147
    v_max3_f32 v13, v13, v148, v149
    v_max3_f32 v13, v13, v150, v151
    v_max3_f32 v13, v13, v152, v153
    v_max3_f32 v13, v13, v154, v155
    v_max3_f32 v13, v13, v156, v157
    v_max3_f32 v13, v13, v158, v159
    v_max3_f32 v13, v13, v160, v161
    v_max3_f32 v13, v13, v162, v163
    v_mov_b32 v14, v13
    s_nop 1
    v_permlane16_swap_b32 v13, v14
    s_nop 1
    v_max_f32 v13, v13, v14
    v_mov_b32 v14, v13
    s_nop 1
    v_permlane32_swap_b32 v13, v14
    s_nop 1
    v_max_f32 v13, v13, v14
    v_sub_f32 v96, v96, v13
    v_mul_f32 v96, s69, v96
    v_exp_f32 v96, v96
    v_sub_f32 v97, v97, v13
    v_mul_f32 v97, s69, v97
    v_exp_f32 v97, v97
    v_sub_f32 v98, v98, v13
    v_mul_f32 v98, s69, v98
    v_exp_f32 v98, v98
    v_sub_f32 v99, v99, v13
    v_mul_f32 v99, s69, v99
    v_exp_f32 v99, v99
    v_sub_f32 v100, v100, v13
    v_mul_f32 v100, s69, v100
    v_exp_f32 v100, v100
    v_sub_f32 v101, v101, v13
    v_mul_f32 v101, s69, v101
    v_exp_f32 v101, v101
    v_sub_f32 v102, v102, v13
    v_mul_f32 v102, s69, v102
    v_exp_f32 v102, v102
    v_sub_f32 v103, v103, v13
    v_mul_f32 v103, s69, v103
    v_exp_f32 v103, v103
    v_sub_f32 v104, v104, v13
    v_mul_f32 v104, s69, v104
    v_exp_f32 v104, v104
    v_sub_f32 v105, v105, v13
    v_mul_f32 v105, s69, v105
    v_exp_f32 v105, v105
    v_sub_f32 v106, v106, v13
    v_mul_f32 v106, s69, v106
    v_exp_f32 v106, v106
    v_sub_f32 v107, v107, v13
    v_mul_f32 v107, s69, v107
    v_exp_f32 v107, v107
    v_sub_f32 v108, v108, v13
    v_mul_f32 v108, s69, v108
    v_exp_f32 v108, v108
    v_sub_f32 v109, v109, v13
    v_mul_f32 v109, s69, v109
    v_exp_f32 v109, v109
    v_sub_f32 v110, v110, v13
    v_mul_f32 v110, s69, v110
    v_exp_f32 v110, v110
    v_sub_f32 v111, v111, v13
    v_mul_f32 v111, s69, v111
    v_exp_f32 v111, v111
    v_sub_f32 v112, v112, v13
    v_mul_f32 v112, s69, v112
    v_exp_f32 v112, v112
    v_sub_f32 v113, v113, v13
    v_mul_f32 v113, s69, v113
    v_exp_f32 v113, v113
    v_sub_f32 v114, v114, v13
    v_mul_f32 v114, s69, v114
    v_exp_f32 v114, v114
    v_sub_f32 v115, v115, v13
    v_mul_f32 v115, s69, v115
    v_exp_f32 v115, v115
    v_sub_f32 v116, v116, v13
    v_mul_f32 v116, s69, v116
    v_exp_f32 v116, v116
    v_sub_f32 v117, v117, v13
    v_mul_f32 v117, s69, v117
    v_exp_f32 v117, v117
    v_sub_f32 v118, v118, v13
    v_mul_f32 v118, s69, v118
    v_exp_f32 v118, v118
    v_sub_f32 v119, v119, v13
    v_mul_f32 v119, s69, v119
    v_exp_f32 v119, v119
    v_sub_f32 v120, v120, v13
    v_mul_f32 v120, s69, v120
    v_exp_f32 v120, v120
    v_sub_f32 v121, v121, v13
    v_mul_f32 v121, s69, v121
    v_exp_f32 v121, v121
    v_sub_f32 v122, v122, v13
    v_mul_f32 v122, s69, v122
    v_exp_f32 v122, v122
    v_sub_f32 v123, v123, v13
    v_mul_f32 v123, s69, v123
    v_exp_f32 v123, v123
    v_sub_f32 v124, v124, v13
    v_mul_f32 v124, s69, v124
    v_exp_f32 v124, v124
    v_sub_f32 v125, v125, v13
    v_mul_f32 v125, s69, v125
    v_exp_f32 v125, v125
    v_sub_f32 v126, v126, v13
    v_mul_f32 v126, s69, v126
    v_exp_f32 v126, v126
    v_sub_f32 v127, v127, v13
    v_mul_f32 v127, s69, v127
    v_exp_f32 v127, v127
    v_sub_f32 v128, v128, v13
    v_mul_f32 v128, s69, v128
    v_exp_f32 v128, v128
    v_sub_f32 v129, v129, v13
    v_mul_f32 v129, s69, v129
    v_exp_f32 v129, v129
    v_sub_f32 v130, v130, v13
    v_mul_f32 v130, s69, v130
    v_exp_f32 v130, v130
    v_sub_f32 v131, v131, v13
    v_mul_f32 v131, s69, v131
    v_exp_f32 v131, v131
    v_sub_f32 v132, v132, v13
    v_mul_f32 v132, s69, v132
    v_exp_f32 v132, v132
    v_sub_f32 v133, v133, v13
    v_mul_f32 v133, s69, v133
    v_exp_f32 v133, v133
    v_sub_f32 v134, v134, v13
    v_mul_f32 v134, s69, v134
    v_exp_f32 v134, v134
    v_sub_f32 v135, v135, v13
    v_mul_f32 v135, s69, v135
    v_exp_f32 v135, v135
    v_sub_f32 v136, v136, v13
    v_mul_f32 v136, s69, v136
    v_exp_f32 v136, v136
    v_sub_f32 v137, v137, v13
    v_mul_f32 v137, s69, v137
    v_exp_f32 v137, v137
    v_sub_f32 v138, v138, v13
    v_mul_f32 v138, s69, v138
    v_exp_f32 v138, v138
    v_sub_f32 v139, v139, v13
    v_mul_f32 v139, s69, v139
    v_exp_f32 v139, v139
    v_sub_f32 v140, v140, v13
    v_mul_f32 v140, s69, v140
    v_exp_f32 v140, v140
    v_sub_f32 v141, v141, v13
    v_mul_f32 v141, s69, v141
    v_exp_f32 v141, v141
    v_sub_f32 v142, v142, v13
    v_mul_f32 v142, s69, v142
    v_exp_f32 v142, v142
    v_sub_f32 v143, v143, v13
    v_mul_f32 v143, s69, v143
    v_exp_f32 v143, v143
    v_sub_f32 v144, v144, v13
    v_mul_f32 v144, s69, v144
    v_exp_f32 v144, v144
    v_sub_f32 v145, v145, v13
    v_mul_f32 v145, s69, v145
    v_exp_f32 v145, v145
    v_sub_f32 v146, v146, v13
    v_mul_f32 v146, s69, v146
    v_exp_f32 v146, v146
    v_sub_f32 v147, v147, v13
    v_mul_f32 v147, s69, v147
    v_exp_f32 v147, v147
    v_sub_f32 v148, v148, v13
    v_mul_f32 v148, s69, v148
    v_exp_f32 v148, v148
    v_sub_f32 v149, v149, v13
    v_mul_f32 v149, s69, v149
    v_exp_f32 v149, v149
    v_sub_f32 v150, v150, v13
    v_mul_f32 v150, s69, v150
    v_exp_f32 v150, v150
    v_sub_f32 v151, v151, v13
    v_mul_f32 v151, s69, v151
    v_exp_f32 v151, v151
    v_sub_f32 v152, v152, v13
    v_mul_f32 v152, s69, v152
    v_exp_f32 v152, v152
    v_sub_f32 v153, v153, v13
    v_mul_f32 v153, s69, v153
    v_exp_f32 v153, v153
    v_sub_f32 v154, v154, v13
    v_mul_f32 v154, s69, v154
    v_exp_f32 v154, v154
    v_sub_f32 v155, v155, v13
    v_mul_f32 v155, s69, v155
    v_exp_f32 v155, v155
    v_sub_f32 v156, v156, v13
    v_mul_f32 v156, s69, v156
    v_exp_f32 v156, v156
    v_sub_f32 v157, v157, v13
    v_mul_f32 v157, s69, v157
    v_exp_f32 v157, v157
    v_sub_f32 v158, v158, v13
    v_mul_f32 v158, s69, v158
    v_exp_f32 v158, v158
    v_sub_f32 v159, v159, v13
    v_mul_f32 v159, s69, v159
    v_exp_f32 v159, v159
    v_sub_f32 v160, v160, v13
    v_mul_f32 v160, s69, v160
    v_exp_f32 v160, v160
    v_sub_f32 v161, v161, v13
    v_mul_f32 v161, s69, v161
    v_exp_f32 v161, v161
    v_sub_f32 v162, v162, v13
    v_mul_f32 v162, s69, v162
    v_exp_f32 v162, v162
    v_sub_f32 v163, v163, v13
    v_mul_f32 v163, s69, v163
    v_exp_f32 v163, v163
    s_nop 0
    v_add_f32 v13, v96, v97
    v_add_f32 v13, v13, v98
    v_add_f32 v13, v13, v99
    v_add_f32 v13, v13, v100
    v_add_f32 v13, v13, v101
    v_add_f32 v13, v13, v102
    v_add_f32 v13, v13, v103
    v_add_f32 v13, v13, v104
    v_add_f32 v13, v13, v105
    v_add_f32 v13, v13, v106
    v_add_f32 v13, v13, v107
    v_add_f32 v13, v13, v108
    v_add_f32 v13, v13, v109
    v_add_f32 v13, v13, v110
    v_add_f32 v13, v13, v111
    v_add_f32 v13, v13, v112
    v_add_f32 v13, v13, v113
    v_add_f32 v13, v13, v114
    v_add_f32 v13, v13, v115
    v_add_f32 v13, v13, v116
    v_add_f32 v13, v13, v117
    v_add_f32 v13, v13, v118
    v_add_f32 v13, v13, v119
    v_add_f32 v13, v13, v120
    v_add_f32 v13, v13, v121
    v_add_f32 v13, v13, v122
    v_add_f32 v13, v13, v123
    v_add_f32 v13, v13, v124
    v_add_f32 v13, v13, v125
    v_add_f32 v13, v13, v126
    v_add_f32 v13, v13, v127
    v_add_f32 v13, v13, v128
    v_add_f32 v13, v13, v129
    v_add_f32 v13, v13, v130
    v_add_f32 v13, v13, v131
    v_add_f32 v13, v13, v132
    v_add_f32 v13, v13, v133
    v_add_f32 v13, v13, v134
    v_add_f32 v13, v13, v135
    v_add_f32 v13, v13, v136
    v_add_f32 v13, v13, v137
    v_add_f32 v13, v13, v138
    v_add_f32 v13, v13, v139
    v_add_f32 v13, v13, v140
    v_add_f32 v13, v13, v141
    v_add_f32 v13, v13, v142
    v_add_f32 v13, v13, v143
    v_add_f32 v13, v13, v144
    v_add_f32 v13, v13, v145
    v_add_f32 v13, v13, v146
    v_add_f32 v13, v13, v147
    v_add_f32 v13, v13, v148
    v_add_f32 v13, v13, v149
    v_add_f32 v13, v13, v150
    v_add_f32 v13, v13, v151
    v_add_f32 v13, v13, v152
    v_add_f32 v13, v13, v153
    v_add_f32 v13, v13, v154
    v_add_f32 v13, v13, v155
    v_add_f32 v13, v13, v156
    v_add_f32 v13, v13, v157
    v_add_f32 v13, v13, v158
    v_add_f32 v13, v13, v159
    v_add_f32 v13, v13, v160
    v_add_f32 v13, v13, v161
    v_add_f32 v13, v13, v162
    v_add_f32 v13, v13, v163
    v_mov_b32 v14, v13
    s_nop 1
    v_permlane16_swap_b32 v13, v14
    s_nop 1
    v_add_f32 v13, v13, v14
    v_mov_b32 v14, v13
    s_nop 1
    v_permlane32_swap_b32 v13, v14
    s_nop 1
    v_add_f32 v13, v13, v14
    v_rcp_f32 v13, v13
    s_nop 0
    v_mul_f32 v96, v96, v13
    v_mul_f32 v97, v97, v13
    v_mul_f32 v98, v98, v13
    v_mul_f32 v99, v99, v13
    v_mul_f32 v100, v100, v13
    v_mul_f32 v101, v101, v13
    v_mul_f32 v102, v102, v13
    v_mul_f32 v103, v103, v13
    v_mul_f32 v104, v104, v13
    v_mul_f32 v105, v105, v13
    v_mul_f32 v106, v106, v13
    v_mul_f32 v107, v107, v13
    v_mul_f32 v108, v108, v13
    v_mul_f32 v109, v109, v13
    v_mul_f32 v110, v110, v13
    v_mul_f32 v111, v111, v13
    v_mul_f32 v112, v112, v13
    v_mul_f32 v113, v113, v13
    v_mul_f32 v114, v114, v13
    v_mul_f32 v115, v115, v13
    v_mul_f32 v116, v116, v13
    v_mul_f32 v117, v117, v13
    v_mul_f32 v118, v118, v13
    v_mul_f32 v119, v119, v13
    v_mul_f32 v120, v120, v13
    v_mul_f32 v121, v121, v13
    v_mul_f32 v122, v122, v13
    v_mul_f32 v123, v123, v13
    v_mul_f32 v124, v124, v13
    v_mul_f32 v125, v125, v13
    v_mul_f32 v126, v126, v13
    v_mul_f32 v127, v127, v13
    v_mul_f32 v128, v128, v13
    v_mul_f32 v129, v129, v13
    v_mul_f32 v130, v130, v13
    v_mul_f32 v131, v131, v13
    v_mul_f32 v132, v132, v13
    v_mul_f32 v133, v133, v13
    v_mul_f32 v134, v134, v13
    v_mul_f32 v135, v135, v13
    v_mul_f32 v136, v136, v13
    v_mul_f32 v137, v137, v13
    v_mul_f32 v138, v138, v13
    v_mul_f32 v139, v139, v13
    v_mul_f32 v140, v140, v13
    v_mul_f32 v141, v141, v13
    v_mul_f32 v142, v142, v13
    v_mul_f32 v143, v143, v13
    v_mul_f32 v144, v144, v13
    v_mul_f32 v145, v145, v13
    v_mul_f32 v146, v146, v13
    v_mul_f32 v147, v147, v13
    v_mul_f32 v148, v148, v13
    v_mul_f32 v149, v149, v13
    v_mul_f32 v150, v150, v13
    v_mul_f32 v151, v151, v13
    v_mul_f32 v152, v152, v13
    v_mul_f32 v153, v153, v13
    v_mul_f32 v154, v154, v13
    v_mul_f32 v155, v155, v13
    v_mul_f32 v156, v156, v13
    v_mul_f32 v157, v157, v13
    v_mul_f32 v158, v158, v13
    v_mul_f32 v159, v159, v13
    v_mul_f32 v160, v160, v13
    v_mul_f32 v161, v161, v13
    v_mul_f32 v162, v162, v13
    v_mul_f32 v163, v163, v13
    v_cvt_pk_bf16_f32 v96, v96, v97
    v_cvt_pk_bf16_f32 v97, v98, v99
    v_cvt_pk_bf16_f32 v100, v100, v101
    v_cvt_pk_bf16_f32 v101, v102, v103
    v_cvt_pk_bf16_f32 v104, v104, v105
    v_cvt_pk_bf16_f32 v105, v106, v107
    v_cvt_pk_bf16_f32 v108, v108, v109
    v_cvt_pk_bf16_f32 v109, v110, v111
    v_cvt_pk_bf16_f32 v112, v112, v113
    v_cvt_pk_bf16_f32 v113, v114, v115
    v_cvt_pk_bf16_f32 v116, v116, v117
    v_cvt_pk_bf16_f32 v117, v118, v119
    v_cvt_pk_bf16_f32 v120, v120, v121
    v_cvt_pk_bf16_f32 v121, v122, v123
    v_cvt_pk_bf16_f32 v124, v124, v125
    v_cvt_pk_bf16_f32 v125, v126, v127
    v_cvt_pk_bf16_f32 v128, v128, v129
    v_cvt_pk_bf16_f32 v129, v130, v131
    v_cvt_pk_bf16_f32 v132, v132, v133
    v_cvt_pk_bf16_f32 v133, v134, v135
    v_cvt_pk_bf16_f32 v136, v136, v137
    v_cvt_pk_bf16_f32 v137, v138, v139
    v_cvt_pk_bf16_f32 v140, v140, v141
    v_cvt_pk_bf16_f32 v141, v142, v143
    v_cvt_pk_bf16_f32 v144, v144, v145
    v_cvt_pk_bf16_f32 v145, v146, v147
    v_cvt_pk_bf16_f32 v148, v148, v149
    v_cvt_pk_bf16_f32 v149, v150, v151
    v_cvt_pk_bf16_f32 v152, v152, v153
    v_cvt_pk_bf16_f32 v153, v154, v155
    v_cvt_pk_bf16_f32 v156, v156, v157
    v_cvt_pk_bf16_f32 v157, v158, v159
    v_cvt_pk_bf16_f32 v160, v160, v161
    v_cvt_pk_bf16_f32 v161, v162, v163
    v_cvt_pk_bf16_f32 v14, v164, v165
    v_lshlrev_b32 v164, 16, v14
    v_and_b32 v165, 0xffff0000, v14
    v_mul_f32 v164, s68, v164
    v_mul_f32 v165, s68, v165
    v_cvt_pk_bf16_f32 v14, v164, v165
    v_lshlrev_b32 v164, 16, v14
    v_and_b32 v165, 0xffff0000, v14
    v_cvt_pk_bf16_f32 v14, v166, v167
    v_lshlrev_b32 v166, 16, v14
    v_and_b32 v167, 0xffff0000, v14
    v_mul_f32 v166, s68, v166
    v_mul_f32 v167, s68, v167
    v_cvt_pk_bf16_f32 v14, v166, v167
    v_lshlrev_b32 v166, 16, v14
    v_and_b32 v167, 0xffff0000, v14
    v_cvt_pk_bf16_f32 v14, v168, v169
    v_lshlrev_b32 v168, 16, v14
    v_and_b32 v169, 0xffff0000, v14
    v_mul_f32 v168, s68, v168
    v_mul_f32 v169, s68, v169
    v_cvt_pk_bf16_f32 v14, v168, v169
    v_lshlrev_b32 v168, 16, v14
    v_and_b32 v169, 0xffff0000, v14
    v_cvt_pk_bf16_f32 v14, v170, v171
    v_lshlrev_b32 v170, 16, v14
    v_and_b32 v171, 0xffff0000, v14
    v_mul_f32 v170, s68, v170
    v_mul_f32 v171, s68, v171
    v_cvt_pk_bf16_f32 v14, v170, v171
    v_lshlrev_b32 v170, 16, v14
    v_and_b32 v171, 0xffff0000, v14
    v_cvt_pk_bf16_f32 v14, v172, v173
    v_lshlrev_b32 v172, 16, v14
    v_and_b32 v173, 0xffff0000, v14
    v_mul_f32 v172, s68, v172
    v_mul_f32 v173, s68, v173
    v_cvt_pk_bf16_f32 v14, v172, v173
    v_lshlrev_b32 v172, 16, v14
    v_and_b32 v173, 0xffff0000, v14
    v_cvt_pk_bf16_f32 v14, v174, v175
    v_lshlrev_b32 v174, 16, v14
    v_and_b32 v175, 0xffff0000, v14
    v_mul_f32 v174, s68, v174
    v_mul_f32 v175, s68, v175
    v_cvt_pk_bf16_f32 v14, v174, v175
    v_lshlrev_b32 v174, 16, v14
    v_and_b32 v175, 0xffff0000, v14
    v_cvt_pk_bf16_f32 v14, v176, v177
    v_lshlrev_b32 v176, 16, v14
    v_and_b32 v177, 0xffff0000, v14
    v_mul_f32 v176, s68, v176
    v_mul_f32 v177, s68, v177
    v_cvt_pk_bf16_f32 v14, v176, v177
    v_lshlrev_b32 v176, 16, v14
    v_and_b32 v177, 0xffff0000, v14
    v_cvt_pk_bf16_f32 v14, v178, v179
    v_lshlrev_b32 v178, 16, v14
    v_and_b32 v179, 0xffff0000, v14
    v_mul_f32 v178, s68, v178
    v_mul_f32 v179, s68, v179
    v_cvt_pk_bf16_f32 v14, v178, v179
    v_lshlrev_b32 v178, 16, v14
    v_and_b32 v179, 0xffff0000, v14
    v_cvt_pk_bf16_f32 v14, v180, v181
    v_lshlrev_b32 v180, 16, v14
    v_and_b32 v181, 0xffff0000, v14
    v_mul_f32 v180, s68, v180
    v_mul_f32 v181, s68, v181
    v_cvt_pk_bf16_f32 v14, v180, v181
    v_lshlrev_b32 v180, 16, v14
    v_and_b32 v181, 0xffff0000, v14
    v_cvt_pk_bf16_f32 v14, v182, v183
    v_lshlrev_b32 v182, 16, v14
    v_and_b32 v183, 0xffff0000, v14
    v_mul_f32 v182, s68, v182
    v_mul_f32 v183, s68, v183
    v_cvt_pk_bf16_f32 v14, v182, v183
    v_lshlrev_b32 v182, 16, v14
    v_and_b32 v183, 0xffff0000, v14
    v_cvt_pk_bf16_f32 v14, v184, v185
    v_lshlrev_b32 v184, 16, v14
    v_and_b32 v185, 0xffff0000, v14
    v_mul_f32 v184, s68, v184
    v_mul_f32 v185, s68, v185
    v_cvt_pk_bf16_f32 v14, v184, v185
    v_lshlrev_b32 v184, 16, v14
    v_and_b32 v185, 0xffff0000, v14
    v_cvt_pk_bf16_f32 v14, v186, v187
    v_lshlrev_b32 v186, 16, v14
    v_and_b32 v187, 0xffff0000, v14
    v_mul_f32 v186, s68, v186
    v_mul_f32 v187, s68, v187
    v_cvt_pk_bf16_f32 v14, v186, v187
    v_lshlrev_b32 v186, 16, v14
    v_and_b32 v187, 0xffff0000, v14
    v_cvt_pk_bf16_f32 v14, v188, v189
    v_lshlrev_b32 v188, 16, v14
    v_and_b32 v189, 0xffff0000, v14
    v_mul_f32 v188, s68, v188
    v_mul_f32 v189, s68, v189
    v_cvt_pk_bf16_f32 v14, v188, v189
    v_lshlrev_b32 v188, 16, v14
    v_and_b32 v189, 0xffff0000, v14
    v_cvt_pk_bf16_f32 v14, v190, v191
    v_lshlrev_b32 v190, 16, v14
    v_and_b32 v191, 0xffff0000, v14
    v_mul_f32 v190, s68, v190
    v_mul_f32 v191, s68, v191
    v_cvt_pk_bf16_f32 v14, v190, v191
    v_lshlrev_b32 v190, 16, v14
    v_and_b32 v191, 0xffff0000, v14
    v_cvt_pk_bf16_f32 v14, v192, v193
    v_lshlrev_b32 v192, 16, v14
    v_and_b32 v193, 0xffff0000, v14
    v_mul_f32 v192, s68, v192
    v_mul_f32 v193, s68, v193
    v_cvt_pk_bf16_f32 v14, v192, v193
    v_lshlrev_b32 v192, 16, v14
    v_and_b32 v193, 0xffff0000, v14
    v_cvt_pk_bf16_f32 v14, v194, v195
    v_lshlrev_b32 v194, 16, v14
    v_and_b32 v195, 0xffff0000, v14
    v_mul_f32 v194, s68, v194
    v_mul_f32 v195, s68, v195
    v_cvt_pk_bf16_f32 v14, v194, v195
    v_lshlrev_b32 v194, 16, v14
    v_and_b32 v195, 0xffff0000, v14
    v_cvt_pk_bf16_f32 v14, v196, v197
    v_lshlrev_b32 v196, 16, v14
    v_and_b32 v197, 0xffff0000, v14
    v_mul_f32 v196, s68, v196
    v_mul_f32 v197, s68, v197
    v_cvt_pk_bf16_f32 v14, v196, v197
    v_lshlrev_b32 v196, 16, v14
    v_and_b32 v197, 0xffff0000, v14
    v_cvt_pk_bf16_f32 v14, v198, v199
    v_lshlrev_b32 v198, 16, v14
    v_and_b32 v199, 0xffff0000, v14
    v_mul_f32 v198, s68, v198
    v_mul_f32 v199, s68, v199
    v_cvt_pk_bf16_f32 v14, v198, v199
    v_lshlrev_b32 v198, 16, v14
    v_and_b32 v199, 0xffff0000, v14
    v_cvt_pk_bf16_f32 v14, v200, v201
    v_lshlrev_b32 v200, 16, v14
    v_and_b32 v201, 0xffff0000, v14
    v_mul_f32 v200, s68, v200
    v_mul_f32 v201, s68, v201
    v_cvt_pk_bf16_f32 v14, v200, v201
    v_lshlrev_b32 v200, 16, v14
    v_and_b32 v201, 0xffff0000, v14
    v_cvt_pk_bf16_f32 v14, v202, v203
    v_lshlrev_b32 v202, 16, v14
    v_and_b32 v203, 0xffff0000, v14
    v_mul_f32 v202, s68, v202
    v_mul_f32 v203, s68, v203
    v_cvt_pk_bf16_f32 v14, v202, v203
    v_lshlrev_b32 v202, 16, v14
    v_and_b32 v203, 0xffff0000, v14
    v_cvt_pk_bf16_f32 v14, v204, v205
    v_lshlrev_b32 v204, 16, v14
    v_and_b32 v205, 0xffff0000, v14
    v_mul_f32 v204, s68, v204
    v_mul_f32 v205, s68, v205
    v_cvt_pk_bf16_f32 v14, v204, v205
    v_lshlrev_b32 v204, 16, v14
    v_and_b32 v205, 0xffff0000, v14
    v_cvt_pk_bf16_f32 v14, v206, v207
    v_lshlrev_b32 v206, 16, v14
    v_and_b32 v207, 0xffff0000, v14
    v_mul_f32 v206, s68, v206
    v_mul_f32 v207, s68, v207
    v_cvt_pk_bf16_f32 v14, v206, v207
    v_lshlrev_b32 v206, 16, v14
    v_and_b32 v207, 0xffff0000, v14
    v_cvt_pk_bf16_f32 v14, v208, v209
    v_lshlrev_b32 v208, 16, v14
    v_and_b32 v209, 0xffff0000, v14
    v_mul_f32 v208, s68, v208
    v_mul_f32 v209, s68, v209
    v_cvt_pk_bf16_f32 v14, v208, v209
    v_lshlrev_b32 v208, 16, v14
    v_and_b32 v209, 0xffff0000, v14
    v_cvt_pk_bf16_f32 v14, v210, v211
    v_lshlrev_b32 v210, 16, v14
    v_and_b32 v211, 0xffff0000, v14
    v_mul_f32 v210, s68, v210
    v_mul_f32 v211, s68, v211
    v_cvt_pk_bf16_f32 v14, v210, v211
    v_lshlrev_b32 v210, 16, v14
    v_and_b32 v211, 0xffff0000, v14
    v_cvt_pk_bf16_f32 v14, v212, v213
    v_lshlrev_b32 v212, 16, v14
    v_and_b32 v213, 0xffff0000, v14
    v_mul_f32 v212, s68, v212
    v_mul_f32 v213, s68, v213
    v_cvt_pk_bf16_f32 v14, v212, v213
    v_lshlrev_b32 v212, 16, v14
    v_and_b32 v213, 0xffff0000, v14
    v_cvt_pk_bf16_f32 v14, v214, v215
    v_lshlrev_b32 v214, 16, v14
    v_and_b32 v215, 0xffff0000, v14
    v_mul_f32 v214, s68, v214
    v_mul_f32 v215, s68, v215
    v_cvt_pk_bf16_f32 v14, v214, v215
    v_lshlrev_b32 v214, 16, v14
    v_and_b32 v215, 0xffff0000, v14
    v_cvt_pk_bf16_f32 v14, v216, v217
    v_lshlrev_b32 v216, 16, v14
    v_and_b32 v217, 0xffff0000, v14
    v_mul_f32 v216, s68, v216
    v_mul_f32 v217, s68, v217
    v_cvt_pk_bf16_f32 v14, v216, v217
    v_lshlrev_b32 v216, 16, v14
    v_and_b32 v217, 0xffff0000, v14
    v_cvt_pk_bf16_f32 v14, v218, v219
    v_lshlrev_b32 v218, 16, v14
    v_and_b32 v219, 0xffff0000, v14
    v_mul_f32 v218, s68, v218
    v_mul_f32 v219, s68, v219
    v_cvt_pk_bf16_f32 v14, v218, v219
    v_lshlrev_b32 v218, 16, v14
    v_and_b32 v219, 0xffff0000, v14
    v_cvt_pk_bf16_f32 v14, v220, v221
    v_lshlrev_b32 v220, 16, v14
    v_and_b32 v221, 0xffff0000, v14
    v_mul_f32 v220, s68, v220
    v_mul_f32 v221, s68, v221
    v_cvt_pk_bf16_f32 v14, v220, v221
    v_lshlrev_b32 v220, 16, v14
    v_and_b32 v221, 0xffff0000, v14
    v_cvt_pk_bf16_f32 v14, v222, v223
    v_lshlrev_b32 v222, 16, v14
    v_and_b32 v223, 0xffff0000, v14
    v_mul_f32 v222, s68, v222
    v_mul_f32 v223, s68, v223
    v_cvt_pk_bf16_f32 v14, v222, v223
    v_lshlrev_b32 v222, 16, v14
    v_and_b32 v223, 0xffff0000, v14
    v_cvt_pk_bf16_f32 v14, v224, v225
    v_lshlrev_b32 v224, 16, v14
    v_and_b32 v225, 0xffff0000, v14
    v_mul_f32 v224, s68, v224
    v_mul_f32 v225, s68, v225
    v_cvt_pk_bf16_f32 v14, v224, v225
    v_lshlrev_b32 v224, 16, v14
    v_and_b32 v225, 0xffff0000, v14
    v_cvt_pk_bf16_f32 v14, v226, v227
    v_lshlrev_b32 v226, 16, v14
    v_and_b32 v227, 0xffff0000, v14
    v_mul_f32 v226, s68, v226
    v_mul_f32 v227, s68, v227
    v_cvt_pk_bf16_f32 v14, v226, v227
    v_lshlrev_b32 v226, 16, v14
    v_and_b32 v227, 0xffff0000, v14
    v_cvt_pk_bf16_f32 v14, v228, v229
    v_lshlrev_b32 v228, 16, v14
    v_and_b32 v229, 0xffff0000, v14
    v_mul_f32 v228, s68, v228
    v_mul_f32 v229, s68, v229
    v_cvt_pk_bf16_f32 v14, v228, v229
    v_lshlrev_b32 v228, 16, v14
    v_and_b32 v229, 0xffff0000, v14
    v_cvt_pk_bf16_f32 v14, v230, v231
    v_lshlrev_b32 v230, 16, v14
    v_and_b32 v231, 0xffff0000, v14
    v_mul_f32 v230, s68, v230
    v_mul_f32 v231, s68, v231
    v_cvt_pk_bf16_f32 v14, v230, v231
    v_lshlrev_b32 v230, 16, v14
    v_and_b32 v231, 0xffff0000, v14
    v_cndmask_b32 v164, v164, v12, s[76:77]
    v_cndmask_b32 v165, v165, v12, s[78:79]
    v_cndmask_b32 v166, v166, v12, s[80:81]
    v_cndmask_b32 v167, v167, v12, s[82:83]
    v_cndmask_b32 v228, v12, v228, s[76:77]
    v_cndmask_b32 v229, v12, v229, s[78:79]
    v_cndmask_b32 v230, v12, v230, s[80:81]
    v_cndmask_b32 v231, v12, v231, s[82:83]
    s_add_u32 s71, s70, 1
    s_cmp_lt_u32 s71, 16
    s_cselect_b32 s71, s74, 0
    v_add_f32 v164, s71, v164
    v_add_f32 v165, s71, v165
    v_add_f32 v166, s71, v166
    v_add_f32 v167, s71, v167
    s_add_u32 s71, s70, 2
    s_cmp_lt_u32 s71, 16
    s_cselect_b32 s71, s74, 0
    v_add_f32 v168, s71, v168
    v_add_f32 v169, s71, v169
    v_add_f32 v170, s71, v170
    v_add_f32 v171, s71, v171
    s_add_u32 s71, s70, 3
    s_cmp_lt_u32 s71, 16
    s_cselect_b32 s71, s74, 0
    v_add_f32 v172, s71, v172
    v_add_f32 v173, s71, v173
    v_add_f32 v174, s71, v174
    v_add_f32 v175, s71, v175
    s_add_u32 s71, s70, 4
    s_cmp_lt_u32 s71, 16
    s_cselect_b32 s71, s74, 0
    v_add_f32 v176, s71, v176
    v_add_f32 v177, s71, v177
    v_add_f32 v178, s71, v178
    v_add_f32 v179, s71, v179
    s_add_u32 s71, s70, 5
    s_cmp_lt_u32 s71, 16
    s_cselect_b32 s71, s74, 0
    v_add_f32 v180, s71, v180
    v_add_f32 v181, s71, v181
    v_add_f32 v182, s71, v182
    v_add_f32 v183, s71, v183
    s_add_u32 s71, s70, 6
    s_cmp_lt_u32 s71, 16
    s_cselect_b32 s71, s74, 0
    v_add_f32 v184, s71, v184
    v_add_f32 v185, s71, v185
    v_add_f32 v186, s71, v186
    v_add_f32 v187, s71, v187
    s_add_u32 s71, s70, 7
    s_cmp_lt_u32 s71, 16
    s_cselect_b32 s71, s74, 0
    v_add_f32 v188, s71, v188
    v_add_f32 v189, s71, v189
    v_add_f32 v190, s71, v190
    v_add_f32 v191, s71, v191
    s_add_u32 s71, s70, 8
    s_cmp_lt_u32 s71, 16
    s_cselect_b32 s71, s74, 0
    v_add_f32 v192, s71, v192
    v_add_f32 v193, s71, v193
    v_add_f32 v194, s71, v194
    v_add_f32 v195, s71, v195
    s_add_u32 s71, s70, 9
    s_cmp_lt_u32 s71, 16
    s_cselect_b32 s71, s74, 0
    v_add_f32 v196, s71, v196
    v_add_f32 v197, s71, v197
    v_add_f32 v198, s71, v198
    v_add_f32 v199, s71, v199
    s_add_u32 s71, s70, 10
    s_cmp_lt_u32 s71, 16
    s_cselect_b32 s71, s74, 0
    v_add_f32 v200, s71, v200
    v_add_f32 v201, s71, v201
    v_add_f32 v202, s71, v202
    v_add_f32 v203, s71, v203
    s_add_u32 s71, s70, 11
    s_cmp_lt_u32 s71, 16
    s_cselect_b32 s71, s74, 0
    v_add_f32 v204, s71, v204
    v_add_f32 v205, s71, v205
    v_add_f32 v206, s71, v206
    v_add_f32 v207, s71, v207
    s_add_u32 s71, s70, 12
    s_cmp_lt_u32 s71, 16
    s_cselect_b32 s71, s74, 0
    v_add_f32 v208, s71, v208
    v_add_f32 v209, s71, v209
    v_add_f32 v210, s71, v210
    v_add_f32 v211, s71, v211
    s_add_u32 s71, s70, 13
    s_cmp_lt_u32 s71, 16
    s_cselect_b32 s71, s74, 0
    v_add_f32 v212, s71, v212
    v_add_f32 v213, s71, v213
    v_add_f32 v214, s71, v214
    v_add_f32 v215, s71, v215
    s_add_u32 s71, s70, 14
    s_cmp_lt_u32 s71, 16
    s_cselect_b32 s71, s74, 0
    v_add_f32 v216, s71, v216
    v_add_f32 v217, s71, v217
    v_add_f32 v218, s71, v218
    v_add_f32 v219, s71, v219
    s_add_u32 s71, s70, 15
    s_cmp_lt_u32 s71, 16
    s_cselect_b32 s71, s74, 0
    v_add_f32 v220, s71, v220
    v_add_f32 v221, s71, v221
    v_add_f32 v222, s71, v222
    v_add_f32 v223, s71, v223
    v_max_f32 v13, v164, v165
    v_max3_f32 v13, v13, v166, v167
    v_max3_f32 v13, v13, v168, v169
    v_max3_f32 v13, v13, v170, v171
    v_max3_f32 v13, v13, v172, v173
    v_max3_f32 v13, v13, v174, v175
    v_max3_f32 v13, v13, v176, v177
    v_max3_f32 v13, v13, v178, v179
    v_max3_f32 v13, v13, v180, v181
    v_max3_f32 v13, v13, v182, v183
    v_max3_f32 v13, v13, v184, v185
    v_max3_f32 v13, v13, v186, v187
    v_max3_f32 v13, v13, v188, v189
    v_max3_f32 v13, v13, v190, v191
    v_max3_f32 v13, v13, v192, v193
    v_max3_f32 v13, v13, v194, v195
    v_max3_f32 v13, v13, v196, v197
    v_max3_f32 v13, v13, v198, v199
    v_max3_f32 v13, v13, v200, v201
    v_max3_f32 v13, v13, v202, v203
    v_max3_f32 v13, v13, v204, v205
    v_max3_f32 v13, v13, v206, v207
    v_max3_f32 v13, v13, v208, v209
    v_max3_f32 v13, v13, v210, v211
    v_max3_f32 v13, v13, v212, v213
    v_max3_f32 v13, v13, v214, v215
    v_max3_f32 v13, v13, v216, v217
    v_max3_f32 v13, v13, v218, v219
    v_max3_f32 v13, v13, v220, v221
    v_max3_f32 v13, v13, v222, v223
    v_max3_f32 v13, v13, v224, v225
    v_max3_f32 v13, v13, v226, v227
    v_max3_f32 v13, v13, v228, v229
    v_max3_f32 v13, v13, v230, v231
    v_mov_b32 v14, v13
    s_nop 1
    v_permlane16_swap_b32 v13, v14
    s_nop 1
    v_max_f32 v13, v13, v14
    v_mov_b32 v14, v13
    s_nop 1
    v_permlane32_swap_b32 v13, v14
    s_nop 1
    v_max_f32 v13, v13, v14
    v_sub_f32 v164, v164, v13
    v_mul_f32 v164, s69, v164
    v_exp_f32 v164, v164
    v_sub_f32 v165, v165, v13
    v_mul_f32 v165, s69, v165
    v_exp_f32 v165, v165
    v_sub_f32 v166, v166, v13
    v_mul_f32 v166, s69, v166
    v_exp_f32 v166, v166
    v_sub_f32 v167, v167, v13
    v_mul_f32 v167, s69, v167
    v_exp_f32 v167, v167
    v_sub_f32 v168, v168, v13
    v_mul_f32 v168, s69, v168
    v_exp_f32 v168, v168
    v_sub_f32 v169, v169, v13
    v_mul_f32 v169, s69, v169
    v_exp_f32 v169, v169
    v_sub_f32 v170, v170, v13
    v_mul_f32 v170, s69, v170
    v_exp_f32 v170, v170
    v_sub_f32 v171, v171, v13
    v_mul_f32 v171, s69, v171
    v_exp_f32 v171, v171
    v_sub_f32 v172, v172, v13
    v_mul_f32 v172, s69, v172
    v_exp_f32 v172, v172
    v_sub_f32 v173, v173, v13
    v_mul_f32 v173, s69, v173
    v_exp_f32 v173, v173
    v_sub_f32 v174, v174, v13
    v_mul_f32 v174, s69, v174
    v_exp_f32 v174, v174
    v_sub_f32 v175, v175, v13
    v_mul_f32 v175, s69, v175
    v_exp_f32 v175, v175
    v_sub_f32 v176, v176, v13
    v_mul_f32 v176, s69, v176
    v_exp_f32 v176, v176
    v_sub_f32 v177, v177, v13
    v_mul_f32 v177, s69, v177
    v_exp_f32 v177, v177
    v_sub_f32 v178, v178, v13
    v_mul_f32 v178, s69, v178
    v_exp_f32 v178, v178
    v_sub_f32 v179, v179, v13
    v_mul_f32 v179, s69, v179
    v_exp_f32 v179, v179
    v_sub_f32 v180, v180, v13
    v_mul_f32 v180, s69, v180
    v_exp_f32 v180, v180
    v_sub_f32 v181, v181, v13
    v_mul_f32 v181, s69, v181
    v_exp_f32 v181, v181
    v_sub_f32 v182, v182, v13
    v_mul_f32 v182, s69, v182
    v_exp_f32 v182, v182
    v_sub_f32 v183, v183, v13
    v_mul_f32 v183, s69, v183
    v_exp_f32 v183, v183
    v_sub_f32 v184, v184, v13
    v_mul_f32 v184, s69, v184
    v_exp_f32 v184, v184
    v_sub_f32 v185, v185, v13
    v_mul_f32 v185, s69, v185
    v_exp_f32 v185, v185
    v_sub_f32 v186, v186, v13
    v_mul_f32 v186, s69, v186
    v_exp_f32 v186, v186
    v_sub_f32 v187, v187, v13
    v_mul_f32 v187, s69, v187
    v_exp_f32 v187, v187
    v_sub_f32 v188, v188, v13
    v_mul_f32 v188, s69, v188
    v_exp_f32 v188, v188
    v_sub_f32 v189, v189, v13
    v_mul_f32 v189, s69, v189
    v_exp_f32 v189, v189
    v_sub_f32 v190, v190, v13
    v_mul_f32 v190, s69, v190
    v_exp_f32 v190, v190
    v_sub_f32 v191, v191, v13
    v_mul_f32 v191, s69, v191
    v_exp_f32 v191, v191
    v_sub_f32 v192, v192, v13
    v_mul_f32 v192, s69, v192
    v_exp_f32 v192, v192
    v_sub_f32 v193, v193, v13
    v_mul_f32 v193, s69, v193
    v_exp_f32 v193, v193
    v_sub_f32 v194, v194, v13
    v_mul_f32 v194, s69, v194
    v_exp_f32 v194, v194
    v_sub_f32 v195, v195, v13
    v_mul_f32 v195, s69, v195
    v_exp_f32 v195, v195
    v_sub_f32 v196, v196, v13
    v_mul_f32 v196, s69, v196
    v_exp_f32 v196, v196
    v_sub_f32 v197, v197, v13
    v_mul_f32 v197, s69, v197
    v_exp_f32 v197, v197
    v_sub_f32 v198, v198, v13
    v_mul_f32 v198, s69, v198
    v_exp_f32 v198, v198
    v_sub_f32 v199, v199, v13
    v_mul_f32 v199, s69, v199
    v_exp_f32 v199, v199
    v_sub_f32 v200, v200, v13
    v_mul_f32 v200, s69, v200
    v_exp_f32 v200, v200
    v_sub_f32 v201, v201, v13
    v_mul_f32 v201, s69, v201
    v_exp_f32 v201, v201
    v_sub_f32 v202, v202, v13
    v_mul_f32 v202, s69, v202
    v_exp_f32 v202, v202
    v_sub_f32 v203, v203, v13
    v_mul_f32 v203, s69, v203
    v_exp_f32 v203, v203
    v_sub_f32 v204, v204, v13
    v_mul_f32 v204, s69, v204
    v_exp_f32 v204, v204
    v_sub_f32 v205, v205, v13
    v_mul_f32 v205, s69, v205
    v_exp_f32 v205, v205
    v_sub_f32 v206, v206, v13
    v_mul_f32 v206, s69, v206
    v_exp_f32 v206, v206
    v_sub_f32 v207, v207, v13
    v_mul_f32 v207, s69, v207
    v_exp_f32 v207, v207
    v_sub_f32 v208, v208, v13
    v_mul_f32 v208, s69, v208
    v_exp_f32 v208, v208
    v_sub_f32 v209, v209, v13
    v_mul_f32 v209, s69, v209
    v_exp_f32 v209, v209
    v_sub_f32 v210, v210, v13
    v_mul_f32 v210, s69, v210
    v_exp_f32 v210, v210
    v_sub_f32 v211, v211, v13
    v_mul_f32 v211, s69, v211
    v_exp_f32 v211, v211
    v_sub_f32 v212, v212, v13
    v_mul_f32 v212, s69, v212
    v_exp_f32 v212, v212
    v_sub_f32 v213, v213, v13
    v_mul_f32 v213, s69, v213
    v_exp_f32 v213, v213
    v_sub_f32 v214, v214, v13
    v_mul_f32 v214, s69, v214
    v_exp_f32 v214, v214
    v_sub_f32 v215, v215, v13
    v_mul_f32 v215, s69, v215
    v_exp_f32 v215, v215
    v_sub_f32 v216, v216, v13
    v_mul_f32 v216, s69, v216
    v_exp_f32 v216, v216
    v_sub_f32 v217, v217, v13
    v_mul_f32 v217, s69, v217
    v_exp_f32 v217, v217
    v_sub_f32 v218, v218, v13
    v_mul_f32 v218, s69, v218
    v_exp_f32 v218, v218
    v_sub_f32 v219, v219, v13
    v_mul_f32 v219, s69, v219
    v_exp_f32 v219, v219
    v_sub_f32 v220, v220, v13
    v_mul_f32 v220, s69, v220
    v_exp_f32 v220, v220
    v_sub_f32 v221, v221, v13
    v_mul_f32 v221, s69, v221
    v_exp_f32 v221, v221
    v_sub_f32 v222, v222, v13
    v_mul_f32 v222, s69, v222
    v_exp_f32 v222, v222
    v_sub_f32 v223, v223, v13
    v_mul_f32 v223, s69, v223
    v_exp_f32 v223, v223
    v_sub_f32 v224, v224, v13
    v_mul_f32 v224, s69, v224
    v_exp_f32 v224, v224
    v_sub_f32 v225, v225, v13
    v_mul_f32 v225, s69, v225
    v_exp_f32 v225, v225
    v_sub_f32 v226, v226, v13
    v_mul_f32 v226, s69, v226
    v_exp_f32 v226, v226
    v_sub_f32 v227, v227, v13
    v_mul_f32 v227, s69, v227
    v_exp_f32 v227, v227
    v_sub_f32 v228, v228, v13
    v_mul_f32 v228, s69, v228
    v_exp_f32 v228, v228
    v_sub_f32 v229, v229, v13
    v_mul_f32 v229, s69, v229
    v_exp_f32 v229, v229
    v_sub_f32 v230, v230, v13
    v_mul_f32 v230, s69, v230
    v_exp_f32 v230, v230
    v_sub_f32 v231, v231, v13
    v_mul_f32 v231, s69, v231
    v_exp_f32 v231, v231
    s_nop 0
    v_add_f32 v13, v164, v165
    v_add_f32 v13, v13, v166
    v_add_f32 v13, v13, v167
    v_add_f32 v13, v13, v168
    v_add_f32 v13, v13, v169
    v_add_f32 v13, v13, v170
    v_add_f32 v13, v13, v171
    v_add_f32 v13, v13, v172
    v_add_f32 v13, v13, v173
    v_add_f32 v13, v13, v174
    v_add_f32 v13, v13, v175
    v_add_f32 v13, v13, v176
    v_add_f32 v13, v13, v177
    v_add_f32 v13, v13, v178
    v_add_f32 v13, v13, v179
    v_add_f32 v13, v13, v180
    v_add_f32 v13, v13, v181
    v_add_f32 v13, v13, v182
    v_add_f32 v13, v13, v183
    v_add_f32 v13, v13, v184
    v_add_f32 v13, v13, v185
    v_add_f32 v13, v13, v186
    v_add_f32 v13, v13, v187
    v_add_f32 v13, v13, v188
    v_add_f32 v13, v13, v189
    v_add_f32 v13, v13, v190
    v_add_f32 v13, v13, v191
    v_add_f32 v13, v13, v192
    v_add_f32 v13, v13, v193
    v_add_f32 v13, v13, v194
    v_add_f32 v13, v13, v195
    v_add_f32 v13, v13, v196
    v_add_f32 v13, v13, v197
    v_add_f32 v13, v13, v198
    v_add_f32 v13, v13, v199
    v_add_f32 v13, v13, v200
    v_add_f32 v13, v13, v201
    v_add_f32 v13, v13, v202
    v_add_f32 v13, v13, v203
    v_add_f32 v13, v13, v204
    v_add_f32 v13, v13, v205
    v_add_f32 v13, v13, v206
    v_add_f32 v13, v13, v207
    v_add_f32 v13, v13, v208
    v_add_f32 v13, v13, v209
    v_add_f32 v13, v13, v210
    v_add_f32 v13, v13, v211
    v_add_f32 v13, v13, v212
    v_add_f32 v13, v13, v213
    v_add_f32 v13, v13, v214
    v_add_f32 v13, v13, v215
    v_add_f32 v13, v13, v216
    v_add_f32 v13, v13, v217
    v_add_f32 v13, v13, v218
    v_add_f32 v13, v13, v219
    v_add_f32 v13, v13, v220
    v_add_f32 v13, v13, v221
    v_add_f32 v13, v13, v222
    v_add_f32 v13, v13, v223
    v_add_f32 v13, v13, v224
    v_add_f32 v13, v13, v225
    v_add_f32 v13, v13, v226
    v_add_f32 v13, v13, v227
    v_add_f32 v13, v13, v228
    v_add_f32 v13, v13, v229
    v_add_f32 v13, v13, v230
    v_add_f32 v13, v13, v231
    v_mov_b32 v14, v13
    s_nop 1
    v_permlane16_swap_b32 v13, v14
    s_nop 1
    v_add_f32 v13, v13, v14
    v_mov_b32 v14, v13
    s_nop 1
    v_permlane32_swap_b32 v13, v14
    s_nop 1
    v_add_f32 v13, v13, v14
    v_rcp_f32 v13, v13
    s_nop 0
    v_mul_f32 v164, v164, v13
    v_mul_f32 v165, v165, v13
    v_mul_f32 v166, v166, v13
    v_mul_f32 v167, v167, v13
    v_mul_f32 v168, v168, v13
    v_mul_f32 v169, v169, v13
    v_mul_f32 v170, v170, v13
    v_mul_f32 v171, v171, v13
    v_mul_f32 v172, v172, v13
    v_mul_f32 v173, v173, v13
    v_mul_f32 v174, v174, v13
    v_mul_f32 v175, v175, v13
    v_mul_f32 v176, v176, v13
    v_mul_f32 v177, v177, v13
    v_mul_f32 v178, v178, v13
    v_mul_f32 v179, v179, v13
    v_mul_f32 v180, v180, v13
    v_mul_f32 v181, v181, v13
    v_mul_f32 v182, v182, v13
    v_mul_f32 v183, v183, v13
    v_mul_f32 v184, v184, v13
    v_mul_f32 v185, v185, v13
    v_mul_f32 v186, v186, v13
    v_mul_f32 v187, v187, v13
    v_mul_f32 v188, v188, v13
    v_mul_f32 v189, v189, v13
    v_mul_f32 v190, v190, v13
    v_mul_f32 v191, v191, v13
    v_mul_f32 v192, v192, v13
    v_mul_f32 v193, v193, v13
    v_mul_f32 v194, v194, v13
    v_mul_f32 v195, v195, v13
    v_mul_f32 v196, v196, v13
    v_mul_f32 v197, v197, v13
    v_mul_f32 v198, v198, v13
    v_mul_f32 v199, v199, v13
    v_mul_f32 v200, v200, v13
    v_mul_f32 v201, v201, v13
    v_mul_f32 v202, v202, v13
    v_mul_f32 v203, v203, v13
    v_mul_f32 v204, v204, v13
    v_mul_f32 v205, v205, v13
    v_mul_f32 v206, v206, v13
    v_mul_f32 v207, v207, v13
    v_mul_f32 v208, v208, v13
    v_mul_f32 v209, v209, v13
    v_mul_f32 v210, v210, v13
    v_mul_f32 v211, v211, v13
    v_mul_f32 v212, v212, v13
    v_mul_f32 v213, v213, v13
    v_mul_f32 v214, v214, v13
    v_mul_f32 v215, v215, v13
    v_mul_f32 v216, v216, v13
    v_mul_f32 v217, v217, v13
    v_mul_f32 v218, v218, v13
    v_mul_f32 v219, v219, v13
    v_mul_f32 v220, v220, v13
    v_mul_f32 v221, v221, v13
    v_mul_f32 v222, v222, v13
    v_mul_f32 v223, v223, v13
    v_mul_f32 v224, v224, v13
    v_mul_f32 v225, v225, v13
    v_mul_f32 v226, v226, v13
    v_mul_f32 v227, v227, v13
    v_mul_f32 v228, v228, v13
    v_mul_f32 v229, v229, v13
    v_mul_f32 v230, v230, v13
    v_mul_f32 v231, v231, v13
    v_cvt_pk_bf16_f32 v164, v164, v165
    v_cvt_pk_bf16_f32 v165, v166, v167
    v_cvt_pk_bf16_f32 v168, v168, v169
    v_cvt_pk_bf16_f32 v169, v170, v171
    v_cvt_pk_bf16_f32 v172, v172, v173
    v_cvt_pk_bf16_f32 v173, v174, v175
    v_cvt_pk_bf16_f32 v176, v176, v177
    v_cvt_pk_bf16_f32 v177, v178, v179
    v_cvt_pk_bf16_f32 v180, v180, v181
    v_cvt_pk_bf16_f32 v181, v182, v183
    v_cvt_pk_bf16_f32 v184, v184, v185
    v_cvt_pk_bf16_f32 v185, v186, v187
    v_cvt_pk_bf16_f32 v188, v188, v189
    v_cvt_pk_bf16_f32 v189, v190, v191
    v_cvt_pk_bf16_f32 v192, v192, v193
    v_cvt_pk_bf16_f32 v193, v194, v195
    v_cvt_pk_bf16_f32 v196, v196, v197
    v_cvt_pk_bf16_f32 v197, v198, v199
    v_cvt_pk_bf16_f32 v200, v200, v201
    v_cvt_pk_bf16_f32 v201, v202, v203
    v_cvt_pk_bf16_f32 v204, v204, v205
    v_cvt_pk_bf16_f32 v205, v206, v207
    v_cvt_pk_bf16_f32 v208, v208, v209
    v_cvt_pk_bf16_f32 v209, v210, v211
    v_cvt_pk_bf16_f32 v212, v212, v213
    v_cvt_pk_bf16_f32 v213, v214, v215
    v_cvt_pk_bf16_f32 v216, v216, v217
    v_cvt_pk_bf16_f32 v217, v218, v219
    v_cvt_pk_bf16_f32 v220, v220, v221
    v_cvt_pk_bf16_f32 v221, v222, v223
    v_cvt_pk_bf16_f32 v224, v224, v225
    v_cvt_pk_bf16_f32 v225, v226, v227
    v_cvt_pk_bf16_f32 v228, v228, v229
    v_cvt_pk_bf16_f32 v229, v230, v231
    s_waitcnt vmcnt(0)
    v_mov_b32 v98, v100
    v_mov_b32 v99, v101
    s_nop 1
    v_mfma_f32_16x16x32_bf16 v[232:235], v[24:27], v[96:99], 0
    v_mfma_f32_16x16x32_bf16 v[236:239], v[60:63], v[96:99], 0
    v_mov_b32 v106, v108
    v_mov_b32 v107, v109
    s_nop 1
    v_mfma_f32_16x16x32_bf16 v[232:235], v[28:31], v[104:107], v[232:235]
    v_mfma_f32_16x16x32_bf16 v[236:239], v[64:67], v[104:107], v[236:239]
    v_mov_b32 v114, v116
    v_mov_b32 v115, v117
    s_nop 1
    v_mfma_f32_16x16x32_bf16 v[232:235], v[32:35], v[112:115], v[232:235]
    v_mfma_f32_16x16x32_bf16 v[236:239], v[68:71], v[112:115], v[236:239]
    v_mov_b32 v122, v124
    v_mov_b32 v123, v125
    s_nop 1
    v_mfma_f32_16x16x32_bf16 v[232:235], v[36:39], v[120:123], v[232:235]
    v_mfma_f32_16x16x32_bf16 v[236:239], v[72:75], v[120:123], v[236:239]
    v_mov_b32 v130, v132
    v_mov_b32 v131, v133
    s_nop 1
    v_mfma_f32_16x16x32_bf16 v[232:235], v[40:43], v[128:131], v[232:235]
    v_mfma_f32_16x16x32_bf16 v[236:239], v[76:79], v[128:131], v[236:239]
    v_mov_b32 v138, v140
    v_mov_b32 v139, v141
    s_nop 1
    v_mfma_f32_16x16x32_bf16 v[232:235], v[44:47], v[136:139], v[232:235]
    v_mfma_f32_16x16x32_bf16 v[236:239], v[80:83], v[136:139], v[236:239]
    v_mov_b32 v146, v148
    v_mov_b32 v147, v149
    s_nop 1
    v_mfma_f32_16x16x32_bf16 v[232:235], v[48:51], v[144:147], v[232:235]
    v_mfma_f32_16x16x32_bf16 v[236:239], v[84:87], v[144:147], v[236:239]
    v_mov_b32 v154, v156
    v_mov_b32 v155, v157
    s_nop 1
    v_mfma_f32_16x16x32_bf16 v[232:235], v[52:55], v[152:155], v[232:235]
    v_mfma_f32_16x16x32_bf16 v[236:239], v[88:91], v[152:155], v[236:239]
    v_mov_b32 v162, 0
    v_mov_b32 v163, 0
    s_nop 1
    v_mfma_f32_16x16x32_bf16 v[232:235], v[56:59], v[160:163], v[232:235]
    v_mfma_f32_16x16x32_bf16 v[236:239], v[92:95], v[160:163], v[236:239]
    v_mov_b32 v166, v164
    v_mov_b32 v167, v165
    v_mov_b32 v164, 0
    v_mov_b32 v165, 0
    s_nop 1
    v_mfma_f32_16x16x32_bf16 v[240:243], v[24:27], v[164:167], 0
    v_mfma_f32_16x16x32_bf16 v[244:247], v[60:63], v[164:167], 0
    v_mov_b32 v170, v172
    v_mov_b32 v171, v173
    s_nop 1
    v_mfma_f32_16x16x32_bf16 v[240:243], v[28:31], v[168:171], v[240:243]
    v_mfma_f32_16x16x32_bf16 v[244:247], v[64:67], v[168:171], v[244:247]
    v_mov_b32 v178, v180
    v_mov_b32 v179, v181
    s_nop 1
    v_mfma_f32_16x16x32_bf16 v[240:243], v[32:35], v[176:179], v[240:243]
    v_mfma_f32_16x16x32_bf16 v[244:247], v[68:71], v[176:179], v[244:247]
    v_mov_b32 v186, v188
    v_mov_b32 v187, v189
    s_nop 1
    v_mfma_f32_16x16x32_bf16 v[240:243], v[36:39], v[184:187], v[240:243]
    v_mfma_f32_16x16x32_bf16 v[244:247], v[72:75], v[184:187], v[244:247]
    v_mov_b32 v194, v196
    v_mov_b32 v195, v197
    s_nop 1
    v_mfma_f32_16x16x32_bf16 v[240:243], v[40:43], v[192:195], v[240:243]
    v_mfma_f32_16x16x32_bf16 v[244:247], v[76:79], v[192:195], v[244:247]
    v_mov_b32 v202, v204
    v_mov_b32 v203, v205
    s_nop 1
    v_mfma_f32_16x16x32_bf16 v[240:243], v[44:47], v[200:203], v[240:243]
    v_mfma_f32_16x16x32_bf16 v[244:247], v[80:83], v[200:203], v[244:247]
    v_mov_b32 v210, v212
    v_mov_b32 v211, v213
    s_nop 1
    v_mfma_f32_16x16x32_bf16 v[240:243], v[48:51], v[208:211], v[240:243]
    v_mfma_f32_16x16x32_bf16 v[244:247], v[84:87], v[208:211], v[244:247]
    v_mov_b32 v218, v220
    v_mov_b32 v219, v221
    s_nop 1
    v_mfma_f32_16x16x32_bf16 v[240:243], v[52:55], v[216:219], v[240:243]
    v_mfma_f32_16x16x32_bf16 v[244:247], v[88:91], v[216:219], v[244:247]
    v_mov_b32 v226, v228
    v_mov_b32 v227, v229
    s_nop 1
    v_mfma_f32_16x16x32_bf16 v[240:243], v[56:59], v[224:227], v[240:243]
    v_mfma_f32_16x16x32_bf16 v[244:247], v[92:95], v[224:227], v[244:247]
    s_nop 7
    s_nop 3
    v_mul_u32_u24 v8, 1152, v3
    v_lshl_add_u32 v8, v2, 3, v8
    s_mul_i32 s64, s38, 36
    v_add_u32 v8, s64, v8
    s_mul_i32 s64, s37, 36864
    s_add_u32 s65, s64, 18432
    v_cvt_pk_bf16_f32 v232, v232, v233
    v_cvt_pk_bf16_f32 v233, v234, v235
    v_cvt_pk_bf16_f32 v236, v236, v237
    buffer_store_dwordx2 v[232:233], v8, s[48:51], s64 offen sc1
    v_cvt_pk_bf16_f32 v240, v240, v241
    v_cvt_pk_bf16_f32 v241, v242, v243
    v_cvt_pk_bf16_f32 v244, v244, v245
    buffer_store_dwordx2 v[240:241], v8, s[48:51], s65 offen sc1
    s_mov_b32 exec_lo, 0xffff
    s_mov_b32 exec_hi, 0
    buffer_store_dword v236, v8, s[48:51], s64 offen offset:32 sc1
    buffer_store_dword v244, v8, s[48:51], s65 offen offset:32 sc1
    s_mov_b64 exec, -1
    s_add_u32 s89, s89, 896
    s_branch KB_loop
KB_done:
    s_waitcnt vmcnt(0)
    s_barrier
    s_cmp_lg_u32 s4, 0
    s_cbranch_scc1 KW_bw2
    s_mov_b32 exec_lo, 1
    s_mov_b32 exec_hi, 0
    v_mov_b32 v2, 44
    v_mov_b32 v3, 1
    global_atomic_add v2, v3, s[32:33]
    s_mov_b32 s6, 0
KW_bs2:
    global_load_dword v6, v2, s[32:33] sc1
    s_add_u32 s6, s6, 1
    s_waitcnt vmcnt(0)
    v_readfirstlane_b32 s7, v6
    s_cmp_ge_u32 s6, 0x200000
    s_cbranch_scc1 KW_bg2
    s_cmp_ge_u32 s7, 224
    s_cbranch_scc1 KW_bg2
    s_sleep 8
    s_branch KW_bs2
KW_bg2:
    s_mov_b64 exec, -1
KW_bw2:
    s_barrier
    s_cmp_ge_u32 s88, 192
    s_cbranch_scc1 KBB_done
    s_and_b32 s37, s88, 31
    s_lshr_b32 s38, s88, 5
    s_mul_i32 s39, s37, 73728
    s_add_u32 s39, s39, 0x5400000
    s_add_u32 s40, s34, s39
    s_addc_u32 s41, s35, 0
    s_mov_b32 s42, 73728
    s_mov_b32 s43, 0x00020000
    s_mul_i32 s39, s38, 192
    s_add_u32 s44, s26, s39
    s_addc_u32 s45, s27, 0
    s_sub_u32 s46, 663552, s39
    s_mov_b32 s47, 0x00020000
    v_lshrrev_b32 v1, 3, v0
    v_add_u32 v1, 0, v1
    v_and_b32 v2, 7, v0
    v_mul_u32_u24 v3, 1152, v1
    v_lshl_add_u32 v8, v2, 4, v3
    v_mul_u32_u24 v3, 144, v1
    v_lshl_add_u32 v13, v2, 4, v3
    v_lshrrev_b32 v1, 3, v0
    v_add_u32 v1, 32, v1
    v_and_b32 v2, 7, v0
    v_mul_u32_u24 v3, 1152, v1
    v_lshl_add_u32 v9, v2, 4, v3
    v_mul_u32_u24 v3, 144, v1
    v_lshl_add_u32 v14, v2, 4, v3
    v_add_u32 v1, 0, v0
    v_mul_u32_u24 v2, 87382, v1
    v_lshrrev_b32 v2, 20, v2
    v_mul_u32_u24 v3, 12, v2
    v_sub_u32 v1, v1, v3
    v_mul_u32_u24 v3, 1152, v2
    v_lshl_add_u32 v10, v1, 4, v3
    v_mul_u32_u24 v3, 224, v2
    v_lshl_add_u32 v15, v1, 4, v3
    v_add_u32 v15, 9216, v15
    v_add_u32 v1, 256, v0
    v_mul_u32_u24 v2, 87382, v1
    v_lshrrev_b32 v2, 20, v2
    v_mul_u32_u24 v3, 12, v2
    v_sub_u32 v1, v1, v3
    v_mul_u32_u24 v3, 1152, v2
    v_lshl_add_u32 v11, v1, 4, v3
    v_mul_u32_u24 v3, 224, v2
    v_lshl_add_u32 v16, v1, 4, v3
    v_add_u32 v16, 9216, v16
    v_add_u32 v1, 512, v0
    v_mul_u32_u24 v2, 87382, v1
    v_lshrrev_b32 v2, 20, v2
    v_mul_u32_u24 v3, 12, v2
    v_sub_u32 v1, v1, v3
    v_mul_u32_u24 v3, 1152, v2
    v_lshl_add_u32 v12, v1, 4, v3
    v_mul_u32_u24 v3, 224, v2
    v_lshl_add_u32 v17, v1, 4, v3
    v_add_u32 v17, 9216, v17
    v_lshrrev_b32 v1, 6, v0
    v_and_b32 v2, 63, v0
    v_lshrrev_b32 v3, 1, v1
    v_mul_u32_u24 v3, 32, v3
    v_and_b32 v18, 15, v2
    v_add_u32 v3, v3, v18
    v_mul_u32_u24 v3, 144, v3
    v_lshrrev_b32 v18, 4, v2
    v_lshl_add_u32 v18, v18, 3, v3
    v_lshrrev_b32 v3, 4, v2
    v_lshlrev_b32 v3, 2, v3
    v_bfe_u32 v19, v2, 2, 2
    v_add_u32 v3, v3, v19
    v_mul_u32_u24 v3, 224, v3
    v_and_b32 v1, 1, v1
    v_mul_u32_u24 v1, 96, v1
    v_add_u32 v3, v3, v1
    v_and_b32 v1, 3, v2
    v_lshl_add_u32 v19, v1, 3, v3
    v_add_u32 v19, 9216, v19
    v_add_u32 v20, 23552, v18
    v_add_u32 v21, 23552, v19
    v_mov_b32 v104, 0
    v_mov_b32 v105, 0
    v_mov_b32 v106, 0
    v_mov_b32 v107, 0
    v_mov_b32 v108, 0
    v_mov_b32 v109, 0
    v_mov_b32 v110, 0
    v_mov_b32 v111, 0
    v_mov_b32 v112, 0
    v_mov_b32 v113, 0
    v_mov_b32 v114, 0
    v_mov_b32 v115, 0
    v_mov_b32 v116, 0
    v_mov_b32 v117, 0
    v_mov_b32 v118, 0
    v_mov_b32 v119, 0
    v_mov_b32 v120, 0
    v_mov_b32 v121, 0
    v_mov_b32 v122, 0
    v_mov_b32 v123, 0
    v_mov_b32 v124, 0
    v_mov_b32 v125, 0
    v_mov_b32 v126, 0
    v_mov_b32 v127, 0
    s_mov_b32 s48, 0
    s_mov_b32 s49, 0
    buffer_load_dwordx4 v[24:27], v8, s[40:43], s48 offen
    buffer_load_dwordx4 v[28:31], v9, s[40:43], s48 offen
    buffer_load_dwordx4 v[32:35], v10, s[44:47], s49 offen
    buffer_load_dwordx4 v[36:39], v11, s[44:47], s49 offen
    buffer_load_dwordx4 v[40:43], v12, s[44:47], s49 offen
    s_add_u32 s48, s48, 128
    s_add_u32 s49, s49, 0x12000
    buffer_load_dwordx4 v[44:47], v8, s[40:43], s48 offen
    buffer_load_dwordx4 v[48:51], v9, s[40:43], s48 offen
    buffer_load_dwordx4 v[52:55], v10, s[44:47], s49 offen
    buffer_load_dwordx4 v[56:59], v11, s[44:47], s49 offen
    buffer_load_dwordx4 v[60:63], v12, s[44:47], s49 offen
    s_add_u32 s48, s48, 128
    s_add_u32 s49, s49, 0x12000
    s_waitcnt vmcnt(5)
    s_barrier
    ds_write_b128 v13, v[24:27] offset:0
    ds_write_b128 v14, v[28:31] offset:0
    ds_write_b128 v15, v[32:35] offset:0
    ds_write_b128 v16, v[36:39] offset:0
    ds_write_b128 v17, v[40:43] offset:0
    s_waitcnt lgkmcnt(0)
    s_barrier
    s_mov_b32 s50, 9
GL_13:
    buffer_load_dwordx4 v[24:27], v8, s[40:43], s48 offen
    buffer_load_dwordx4 v[28:31], v9, s[40:43], s48 offen
    buffer_load_dwordx4 v[32:35], v10, s[44:47], s49 offen
    buffer_load_dwordx4 v[36:39], v11, s[44:47], s49 offen
    buffer_load_dwordx4 v[40:43], v12, s[44:47], s49 offen
    s_add_u32 s48, s48, 128
    s_add_u32 s49, s49, 0x12000
    ds_read_b64 v[64:65], v18 offset:0
    ds_read_b64 v[66:67], v18 offset:32
    ds_read_b64 v[68:69], v18 offset:2304
    ds_read_b64 v[70:71], v18 offset:2336
    ds_read_b64_tr_b16 v[80:81], v19 offset:0
    ds_read_b64_tr_b16 v[82:83], v19 offset:3584
    ds_read_b64_tr_b16 v[84:85], v19 offset:32
    ds_read_b64_tr_b16 v[86:87], v19 offset:3616
    ds_read_b64_tr_b16 v[88:89], v19 offset:64
    ds_read_b64_tr_b16 v[90:91], v19 offset:3648
    ds_read_b64 v[72:73], v18 offset:64
    ds_read_b64 v[74:75], v18 offset:96
    ds_read_b64 v[76:77], v18 offset:2368
    ds_read_b64 v[78:79], v18 offset:2400
    ds_read_b64_tr_b16 v[92:93], v19 offset:7168
    ds_read_b64_tr_b16 v[94:95], v19 offset:10752
    ds_read_b64_tr_b16 v[96:97], v19 offset:7200
    ds_read_b64_tr_b16 v[98:99], v19 offset:10784
    ds_read_b64_tr_b16 v[100:101], v19 offset:7232
    ds_read_b64_tr_b16 v[102:103], v19 offset:10816
    s_waitcnt lgkmcnt(10)
    v_mfma_f32_16x16x32_bf16 v[104:107], v[80:83], v[64:67], v[104:107]
    v_mfma_f32_16x16x32_bf16 v[108:111], v[84:87], v[64:67], v[108:111]
    v_mfma_f32_16x16x32_bf16 v[112:115], v[88:91], v[64:67], v[112:115]
    v_mfma_f32_16x16x32_bf16 v[116:119], v[80:83], v[68:71], v[116:119]
    v_mfma_f32_16x16x32_bf16 v[120:123], v[84:87], v[68:71], v[120:123]
    v_mfma_f32_16x16x32_bf16 v[124:127], v[88:91], v[68:71], v[124:127]
    s_waitcnt lgkmcnt(0)
    v_mfma_f32_16x16x32_bf16 v[104:107], v[92:95], v[72:75], v[104:107]
    v_mfma_f32_16x16x32_bf16 v[108:111], v[96:99], v[72:75], v[108:111]
    v_mfma_f32_16x16x32_bf16 v[112:115], v[100:103], v[72:75], v[112:115]
    v_mfma_f32_16x16x32_bf16 v[116:119], v[92:95], v[76:79], v[116:119]
    v_mfma_f32_16x16x32_bf16 v[120:123], v[96:99], v[76:79], v[120:123]
    v_mfma_f32_16x16x32_bf16 v[124:127], v[100:103], v[76:79], v[124:127]
    s_waitcnt vmcnt(5)
    ds_write_b128 v13, v[44:47] offset:23552
    ds_write_b128 v14, v[48:51] offset:23552
    ds_write_b128 v15, v[52:55] offset:23552
    ds_write_b128 v16, v[56:59] offset:23552
    ds_write_b128 v17, v[60:63] offset:23552
    s_waitcnt lgkmcnt(0)
    s_barrier
    s_sub_u32 s50, s50, 1
    s_cmp_eq_u32 s50, 0
    s_cbranch_scc1 GE_14
    buffer_load_dwordx4 v[44:47], v8, s[40:43], s48 offen
    buffer_load_dwordx4 v[48:51], v9, s[40:43], s48 offen
    buffer_load_dwordx4 v[52:55], v10, s[44:47], s49 offen
    buffer_load_dwordx4 v[56:59], v11, s[44:47], s49 offen
    buffer_load_dwordx4 v[60:63], v12, s[44:47], s49 offen
    s_add_u32 s48, s48, 128
    s_add_u32 s49, s49, 0x12000
    ds_read_b64 v[64:65], v20 offset:0
    ds_read_b64 v[66:67], v20 offset:32
    ds_read_b64 v[68:69], v20 offset:2304
    ds_read_b64 v[70:71], v20 offset:2336
    ds_read_b64_tr_b16 v[80:81], v21 offset:0
    ds_read_b64_tr_b16 v[82:83], v21 offset:3584
    ds_read_b64_tr_b16 v[84:85], v21 offset:32
    ds_read_b64_tr_b16 v[86:87], v21 offset:3616
    ds_read_b64_tr_b16 v[88:89], v21 offset:64
    ds_read_b64_tr_b16 v[90:91], v21 offset:3648
    ds_read_b64 v[72:73], v20 offset:64
    ds_read_b64 v[74:75], v20 offset:96
    ds_read_b64 v[76:77], v20 offset:2368
    ds_read_b64 v[78:79], v20 offset:2400
    ds_read_b64_tr_b16 v[92:93], v21 offset:7168
    ds_read_b64_tr_b16 v[94:95], v21 offset:10752
    ds_read_b64_tr_b16 v[96:97], v21 offset:7200
    ds_read_b64_tr_b16 v[98:99], v21 offset:10784
    ds_read_b64_tr_b16 v[100:101], v21 offset:7232
    ds_read_b64_tr_b16 v[102:103], v21 offset:10816
    s_waitcnt lgkmcnt(10)
    v_mfma_f32_16x16x32_bf16 v[104:107], v[80:83], v[64:67], v[104:107]
    v_mfma_f32_16x16x32_bf16 v[108:111], v[84:87], v[64:67], v[108:111]
    v_mfma_f32_16x16x32_bf16 v[112:115], v[88:91], v[64:67], v[112:115]
    v_mfma_f32_16x16x32_bf16 v[116:119], v[80:83], v[68:71], v[116:119]
    v_mfma_f32_16x16x32_bf16 v[120:123], v[84:87], v[68:71], v[120:123]
    v_mfma_f32_16x16x32_bf16 v[124:127], v[88:91], v[68:71], v[124:127]
    s_waitcnt lgkmcnt(0)
    v_mfma_f32_16x16x32_bf16 v[104:107], v[92:95], v[72:75], v[104:107]
    v_mfma_f32_16x16x32_bf16 v[108:111], v[96:99], v[72:75], v[108:111]
    v_mfma_f32_16x16x32_bf16 v[112:115], v[100:103], v[72:75], v[112:115]
    v_mfma_f32_16x16x32_bf16 v[116:119], v[92:95], v[76:79], v[116:119]
    v_mfma_f32_16x16x32_bf16 v[120:123], v[96:99], v[76:79], v[120:123]
    v_mfma_f32_16x16x32_bf16 v[124:127], v[100:103], v[76:79], v[124:127]
    s_waitcnt vmcnt(5)
    ds_write_b128 v13, v[24:27] offset:0
    ds_write_b128 v14, v[28:31] offset:0
    ds_write_b128 v15, v[32:35] offset:0
    ds_write_b128 v16, v[36:39] offset:0
    ds_write_b128 v17, v[40:43] offset:0
    s_waitcnt lgkmcnt(0)
    s_barrier
    s_sub_u32 s50, s50, 1
    s_cmp_lg_u32 s50, 0
    s_cbranch_scc1 GL_13
GE_14:
    s_waitcnt vmcnt(0)
    s_nop 7
    s_nop 7
    s_mul_i32 s39, s37, 73728
    s_mul_i32 s52, s38, 192
    s_add_u32 s39, s39, s52
    s_add_u32 s39, s39, 0x5a00000
    s_add_u32 s52, s34, s39
    s_addc_u32 s53, s35, 0
    s_mov_b32 s54, 73728
    s_mov_b32 s55, 0x00020000
    v_lshrrev_b32 v1, 6, v0
    v_and_b32 v2, 63, v0
    v_lshrrev_b32 v3, 1, v1
    v_and_b32 v1, 1, v1
    v_mul_u32_u24 v3, 32, v3
    v_mul_u32_u24 v1, 48, v1
    v_and_b32 v4, 15, v2
    v_lshrrev_b32 v2, 4, v2
    v_lshlrev_b32 v2, 2, v2
    v_add_u32 v3, v3, v4
    v_add_u32 v1, v1, v2
    v_mul_u32_u24 v3, 1152, v3
    v_lshl_add_u32 v4, v1, 1, v3
    v_cvt_pk_bf16_f32 v104, v104, v105
    v_cvt_pk_bf16_f32 v105, v106, v107
    s_mov_b32 s51, 0x0
    buffer_store_dwordx2 v[104:105], v4, s[52:55], s51 offen offset:0 sc1
    v_cvt_pk_bf16_f32 v108, v108, v109
    v_cvt_pk_bf16_f32 v109, v110, v111
    s_mov_b32 s51, 0x0
    buffer_store_dwordx2 v[108:109], v4, s[52:55], s51 offen offset:32 sc1
    v_cvt_pk_bf16_f32 v112, v112, v113
    v_cvt_pk_bf16_f32 v113, v114, v115
    s_mov_b32 s51, 0x0
    buffer_store_dwordx2 v[112:113], v4, s[52:55], s51 offen offset:64 sc1
    v_cvt_pk_bf16_f32 v116, v116, v117
    v_cvt_pk_bf16_f32 v117, v118, v119
    s_mov_b32 s51, 0x4800
    buffer_store_dwordx2 v[116:117], v4, s[52:55], s51 offen offset:0 sc1
    v_cvt_pk_bf16_f32 v120, v120, v121
    v_cvt_pk_bf16_f32 v121, v122, v123
    s_mov_b32 s51, 0x4800
    buffer_store_dwordx2 v[120:121], v4, s[52:55], s51 offen offset:32 sc1
    v_cvt_pk_bf16_f32 v124, v124, v125
    v_cvt_pk_bf16_f32 v125, v126, v127
    s_mov_b32 s51, 0x4800
    buffer_store_dwordx2 v[124:125], v4, s[52:55], s51 offen offset:64 sc1
KBB_done:
    s_waitcnt vmcnt(0)
    s_barrier
    s_cmp_lg_u32 s4, 0
    s_cbranch_scc1 KW_bw3
    s_mov_b32 exec_lo, 1
    s_mov_b32 exec_hi, 0
    v_mov_b32 v2, 48
    v_mov_b32 v3, 1
    global_atomic_add v2, v3, s[32:33]
    s_mov_b32 s6, 0
KW_bs3:
    global_load_dword v6, v2, s[32:33] sc1
    s_add_u32 s6, s6, 1
    s_waitcnt vmcnt(0)
    v_readfirstlane_b32 s7, v6
    s_cmp_ge_u32 s6, 0x200000
    s_cbranch_scc1 KW_bg3
    s_cmp_ge_u32 s7, 224
    s_cbranch_scc1 KW_bg3
    s_sleep 8
    s_branch KW_bs3
KW_bg3:
    s_mov_b64 exec, -1
KW_bw3:
    s_barrier
    s_cmp_ge_u32 s88, 96
    s_cbranch_scc1 KF_start
    v_and_b32 v1, 63, v0
    v_lshrrev_b32 v2, 4, v1
    v_and_b32 v3, 15, v1
    v_and_b32 v4, 7, v1
    v_lshlrev_b32 v5, 2, v2
    v_add_u32 v6, 0, v5
    v_cmp_le_u32 s[76:77], v6, v3
    v_add_u32 v6, 1, v5
    v_cmp_le_u32 s[78:79], v6, v3
    v_add_u32 v6, 2, v5
    v_cmp_le_u32 s[80:81], v6, v3
    v_add_u32 v6, 3, v5
    v_cmp_le_u32 s[82:83], v6, v3
    s_mov_b32 s72, 0
    s_mov_b32 s73, -1
    s_mov_b32 s74, 0xff800000
    s_lshl_b32 s89, s88, 2
    s_add_u32 s89, s89, s4
KA_loop:
    s_cmp_ge_u32 s89, 2048
    s_cbranch_scc1 KM_done
    s_mov_b32 s36, s89
    s_mov_b32 s40, s34
    s_mov_b32 s41, s35
    s_mov_b32 s42, 0x1000000
    s_mov_b32 s43, 0x00020000
    s_add_u32 s44, s34, 0x1000000
    s_addc_u32 s45, s35, 0
    s_mov_b32 s46, 0x1000000
    s_mov_b32 s47, 0x00020000
    s_add_u32 s48, s34, 0x2000000
    s_addc_u32 s49, s35, 0
    s_mov_b32 s50, 0x1000000
    s_mov_b32 s51, 0x00020000
    s_add_u32 s52, s34, 0x3c00000
    s_addc_u32 s53, s35, 0
    s_mov_b32 s54, 0x400000
    s_mov_b32 s55, 0x00020000
    s_add_u32 s56, s34, 0x4000000
    s_addc_u32 s57, s35, 0
    s_mov_b32 s58, 0x400000
    s_mov_b32 s59, 0x00020000
    s_add_u32 s60, s34, 0x4400000
    s_addc_u32 s61, s35, 0
    s_mov_b32 s62, 0x1000000
    s_mov_b32 s63, 0x00020000
    s_lshr_b32 s37, s36, 5
    s_and_b32 s38, s36, 31
    v_lshlrev_b32 v8, 13, v3
    v_lshl_add_u32 v8, v2, 4, v8
    s_lshl_b32 s64, s37, 18
    s_lshl_b32 s65, s38, 8
    s_add_u32 s64, s64, s65
    s_add_u32 s65, s64, 0x20000
    buffer_load_dwordx4 v[16:19], v8, s[40:43], s64 offen offset:0
    buffer_load_dwordx4 v[20:23], v8, s[40:43], s64 offen offset:64
    buffer_load_dwordx4 v[24:27], v8, s[40:43], s64 offen offset:128
    buffer_load_dwordx4 v[28:31], v8, s[40:43], s64 offen offset:192
    buffer_load_dwordx4 v[32:35], v8, s[40:43], s65 offen offset:0
    buffer_load_dwordx4 v[36:39], v8, s[40:43], s65 offen offset:64
    buffer_load_dwordx4 v[40:43], v8, s[40:43], s65 offen offset:128
    buffer_load_dwordx4 v[44:47], v8, s[40:43], s65 offen offset:192
    buffer_load_dwordx4 v[64:67], v8, s[44:47], s64 offen offset:0
    buffer_load_dwordx4 v[68:71], v8, s[44:47], s64 offen offset:64
    buffer_load_dwordx4 v[72:75], v8, s[44:47], s64 offen offset:128
    buffer_load_dwordx4 v[76:79], v8, s[44:47], s64 offen offset:192
    buffer_load_dwordx4 v[80:83], v8, s[44:47], s65 offen offset:0
    buffer_load_dwordx4 v[84:87], v8, s[44:47], s65 offen offset:64
    buffer_load_dwordx4 v[88:91], v8, s[44:47], s65 offen offset:128
    buffer_load_dwordx4 v[92:95], v8, s[44:47], s65 offen offset:192
    v_lshlrev_b32 v10, 12, v3
    v_lshl_add_u32 v10, v2, 3, v10
    s_lshl_b32 s67, s38, 19
    s_lshl_b32 s68, s37, 6
    s_add_u32 s67, s67, s68
    buffer_load_dwordx2 v[96:97], v10, s[48:51], s67 offen
    buffer_load_dwordx2 v[98:99], v10, s[48:51], s67 offen offset:32
    s_add_u32 s67, s67, 0x10000
    buffer_load_dwordx2 v[104:105], v10, s[48:51], s67 offen
    buffer_load_dwordx2 v[106:107], v10, s[48:51], s67 offen offset:32
    s_add_u32 s67, s67, 0x10000
    buffer_load_dwordx2 v[112:113], v10, s[48:51], s67 offen
    buffer_load_dwordx2 v[114:115], v10, s[48:51], s67 offen offset:32
    s_add_u32 s67, s67, 0x10000
    buffer_load_dwordx2 v[120:121], v10, s[48:51], s67 offen
    buffer_load_dwordx2 v[122:123], v10, s[48:51], s67 offen offset:32
    s_add_u32 s67, s67, 0x10000
    buffer_load_dwordx2 v[128:129], v10, s[48:51], s67 offen
    buffer_load_dwordx2 v[130:131], v10, s[48:51], s67 offen offset:32
    s_add_u32 s67, s67, 0x10000
    buffer_load_dwordx2 v[136:137], v10, s[48:51], s67 offen
    buffer_load_dwordx2 v[138:139], v10, s[48:51], s67 offen offset:32
    s_add_u32 s67, s67, 0x10000
    buffer_load_dwordx2 v[144:145], v10, s[48:51], s67 offen
    buffer_load_dwordx2 v[146:147], v10, s[48:51], s67 offen offset:32
    s_add_u32 s67, s67, 0x10000
    buffer_load_dwordx2 v[152:153], v10, s[48:51], s67 offen
    buffer_load_dwordx2 v[154:155], v10, s[48:51], s67 offen offset:32
    s_add_u32 s67, s67, 0x10000
    s_lshl_b32 s70, s38, 4
    s_add_u32 s70, s70, 0x5800000
    v_mov_b32 v240, s70
    s_mov_b32 s6, 0
KA_spin:
    global_load_dwordx4 v[244:247], v240, s[34:35] sc1
    s_add_u32 s6, s6, 1
    s_waitcnt vmcnt(0)
    v_min_u32 v244, v244, v245
    v_min_u32 v246, v246, v247
    v_min_u32 v244, v244, v246
    s_nop 0
    v_readfirstlane_b32 s7, v244
    s_cmp_ge_u32 s6, 0x200000
    s_cbranch_scc1 KA_go
    s_cmp_gt_u32 s7, s37
    s_cbranch_scc1 KA_go
    s_add_u32 s7, s7, 1
    s_cmp_ge_u32 s7, s37
    s_cbranch_scc1 KA_near
    s_sleep 60
KA_near:
    s_sleep 3
    s_branch KA_spin
KA_go:
    v_lshlrev_b32 v9, 8, v4
    v_lshl_add_u32 v9, v2, 4, v9
    s_lshl_b32 s66, s36, 11
    buffer_load_dwordx4 v[48:51], v9, s[52:55], s66 offen offset:0 sc1
    buffer_load_dwordx4 v[52:55], v9, s[52:55], s66 offen offset:64 sc1
    buffer_load_dwordx4 v[56:59], v9, s[52:55], s66 offen offset:128 sc1
    buffer_load_dwordx4 v[60:63], v9, s[52:55], s66 offen offset:192 sc1
    v_and_b32 v11, 1, v2
    v_lshlrev_b32 v11, 3, v11
    v_lshl_add_u32 v11, v3, 4, v11
    buffer_load_dwordx2 v[100:101], v11, s[56:59], s66 offen offset:0 sc1
    buffer_load_dwordx2 v[108:109], v11, s[56:59], s66 offen offset:256 sc1
    buffer_load_dwordx2 v[116:117], v11, s[56:59], s66 offen offset:512 sc1
    buffer_load_dwordx2 v[124:125], v11, s[56:59], s66 offen offset:768 sc1
    buffer_load_dwordx2 v[132:133], v11, s[56:59], s66 offen offset:1024 sc1
    buffer_load_dwordx2 v[140:141], v11, s[56:59], s66 offen offset:1280 sc1
    buffer_load_dwordx2 v[148:149], v11, s[56:59], s66 offen offset:1536 sc1
    buffer_load_dwordx2 v[156:157], v11, s[56:59], s66 offen offset:1792 sc1
    s_waitcnt vmcnt(0)
    v_mfma_f32_16x16x32_bf16 v[160:163], v[48:51], v[16:19], 0
    v_mfma_f32_16x16x32_bf16 v[160:163], v[52:55], v[20:23], v[160:163]
    v_mfma_f32_16x16x32_bf16 v[160:163], v[56:59], v[24:27], v[160:163]
    v_mfma_f32_16x16x32_bf16 v[160:163], v[60:63], v[28:31], v[160:163]
    v_mfma_f32_16x16x32_bf16 v[164:167], v[64:67], v[16:19], 0
    v_mfma_f32_16x16x32_bf16 v[164:167], v[68:71], v[20:23], v[164:167]
    v_mfma_f32_16x16x32_bf16 v[164:167], v[72:75], v[24:27], v[164:167]
    v_mfma_f32_16x16x32_bf16 v[164:167], v[76:79], v[28:31], v[164:167]
    v_mfma_f32_16x16x32_bf16 v[168:171], v[80:83], v[16:19], 0
    v_mfma_f32_16x16x32_bf16 v[168:171], v[84:87], v[20:23], v[168:171]
    v_mfma_f32_16x16x32_bf16 v[168:171], v[88:91], v[24:27], v[168:171]
    v_mfma_f32_16x16x32_bf16 v[168:171], v[92:95], v[28:31], v[168:171]
    v_mfma_f32_16x16x32_bf16 v[172:175], v[48:51], v[32:35], 0
    v_mfma_f32_16x16x32_bf16 v[172:175], v[52:55], v[36:39], v[172:175]
    v_mfma_f32_16x16x32_bf16 v[172:175], v[56:59], v[40:43], v[172:175]
    v_mfma_f32_16x16x32_bf16 v[172:175], v[60:63], v[44:47], v[172:175]
    v_mfma_f32_16x16x32_bf16 v[176:179], v[64:67], v[32:35], 0
    v_mfma_f32_16x16x32_bf16 v[176:179], v[68:71], v[36:39], v[176:179]
    v_mfma_f32_16x16x32_bf16 v[176:179], v[72:75], v[40:43], v[176:179]
    v_mfma_f32_16x16x32_bf16 v[176:179], v[76:79], v[44:47], v[176:179]
    v_mfma_f32_16x16x32_bf16 v[180:183], v[80:83], v[32:35], 0
    v_mfma_f32_16x16x32_bf16 v[180:183], v[84:87], v[36:39], v[180:183]
    v_mfma_f32_16x16x32_bf16 v[180:183], v[88:91], v[40:43], v[180:183]
    v_mfma_f32_16x16x32_bf16 v[180:183], v[92:95], v[44:47], v[180:183]
    s_nop 7
    s_nop 1
    s_mov_b32 s68, 0x3db504f3
    s_mov_b32 s69, 0x3fb8aa3b
    v_mov_b32 v12, s74
    v_cvt_pk_bf16_f32 v14, v160, v161
    v_lshlrev_b32 v160, 16, v14
    v_and_b32 v161, 0xffff0000, v14
    v_mul_f32 v160, s68, v160
    v_mul_f32 v161, s68, v161
    v_cvt_pk_bf16_f32 v14, v160, v161
    v_lshlrev_b32 v160, 16, v14
    v_and_b32 v161, 0xffff0000, v14
    v_cvt_pk_bf16_f32 v14, v162, v163
    v_lshlrev_b32 v162, 16, v14
    v_and_b32 v163, 0xffff0000, v14
    v_mul_f32 v162, s68, v162
    v_mul_f32 v163, s68, v163
    v_cvt_pk_bf16_f32 v14, v162, v163
    v_lshlrev_b32 v162, 16, v14
    v_and_b32 v163, 0xffff0000, v14
    v_cvt_pk_bf16_f32 v14, v164, v165
    v_lshlrev_b32 v164, 16, v14
    v_and_b32 v165, 0xffff0000, v14
    v_mul_f32 v164, s68, v164
    v_mul_f32 v165, s68, v165
    v_cvt_pk_bf16_f32 v14, v164, v165
    v_lshlrev_b32 v164, 16, v14
    v_and_b32 v165, 0xffff0000, v14
    v_cvt_pk_bf16_f32 v14, v166, v167
    v_lshlrev_b32 v166, 16, v14
    v_and_b32 v167, 0xffff0000, v14
    v_mul_f32 v166, s68, v166
    v_mul_f32 v167, s68, v167
    v_cvt_pk_bf16_f32 v14, v166, v167
    v_lshlrev_b32 v166, 16, v14
    v_and_b32 v167, 0xffff0000, v14
    v_cvt_pk_bf16_f32 v14, v168, v169
    v_lshlrev_b32 v168, 16, v14
    v_and_b32 v169, 0xffff0000, v14
    v_mul_f32 v168, s68, v168
    v_mul_f32 v169, s68, v169
    v_cvt_pk_bf16_f32 v14, v168, v169
    v_lshlrev_b32 v168, 16, v14
    v_and_b32 v169, 0xffff0000, v14
    v_cvt_pk_bf16_f32 v14, v170, v171
    v_lshlrev_b32 v170, 16, v14
    v_and_b32 v171, 0xffff0000, v14
    v_mul_f32 v170, s68, v170
    v_mul_f32 v171, s68, v171
    v_cvt_pk_bf16_f32 v14, v170, v171
    v_lshlrev_b32 v170, 16, v14
    v_and_b32 v171, 0xffff0000, v14
    v_cndmask_b32 v160, v160, v12, s[72:73]
    v_cndmask_b32 v161, v161, v12, s[72:73]
    v_cndmask_b32 v162, v162, v12, s[72:73]
    v_cndmask_b32 v163, v163, v12, s[72:73]
    v_cndmask_b32 v164, v12, v164, s[76:77]
    v_mov_b32 v168, v12
    v_cndmask_b32 v165, v12, v165, s[78:79]
    v_mov_b32 v169, v12
    v_cndmask_b32 v166, v12, v166, s[80:81]
    v_mov_b32 v170, v12
    v_cndmask_b32 v167, v12, v167, s[82:83]
    v_mov_b32 v171, v12
    v_max_f32 v13, v160, v161
    v_max3_f32 v13, v13, v162, v163
    v_max3_f32 v13, v13, v164, v165
    v_max3_f32 v13, v13, v166, v167
    v_max3_f32 v13, v13, v168, v169
    v_max3_f32 v13, v13, v170, v171
    v_mov_b32 v14, v13
    s_nop 1
    v_permlane16_swap_b32 v13, v14
    s_nop 1
    v_max_f32 v13, v13, v14
    v_mov_b32 v14, v13
    s_nop 1
    v_permlane32_swap_b32 v13, v14
    s_nop 1
    v_max_f32 v13, v13, v14
    v_sub_f32 v160, v160, v13
    v_mul_f32 v160, s69, v160
    v_exp_f32 v160, v160
    v_sub_f32 v161, v161, v13
    v_mul_f32 v161, s69, v161
    v_exp_f32 v161, v161
    v_sub_f32 v162, v162, v13
    v_mul_f32 v162, s69, v162
    v_exp_f32 v162, v162
    v_sub_f32 v163, v163, v13
    v_mul_f32 v163, s69, v163
    v_exp_f32 v163, v163
    v_sub_f32 v164, v164, v13
    v_mul_f32 v164, s69, v164
    v_exp_f32 v164, v164
    v_sub_f32 v165, v165, v13
    v_mul_f32 v165, s69, v165
    v_exp_f32 v165, v165
    v_sub_f32 v166, v166, v13
    v_mul_f32 v166, s69, v166
    v_exp_f32 v166, v166
    v_sub_f32 v167, v167, v13
    v_mul_f32 v167, s69, v167
    v_exp_f32 v167, v167
    v_sub_f32 v168, v168, v13
    v_mul_f32 v168, s69, v168
    v_exp_f32 v168, v168
    v_sub_f32 v169, v169, v13
    v_mul_f32 v169, s69, v169
    v_exp_f32 v169, v169
    v_sub_f32 v170, v170, v13
    v_mul_f32 v170, s69, v170
    v_exp_f32 v170, v170
    v_sub_f32 v171, v171, v13
    v_mul_f32 v171, s69, v171
    v_exp_f32 v171, v171
    s_nop 0
    v_add_f32 v13, v160, v161
    v_add_f32 v13, v13, v162
    v_add_f32 v13, v13, v163
    v_add_f32 v13, v13, v164
    v_add_f32 v13, v13, v165
    v_add_f32 v13, v13, v166
    v_add_f32 v13, v13, v167
    v_add_f32 v13, v13, v168
    v_add_f32 v13, v13, v169
    v_add_f32 v13, v13, v170
    v_add_f32 v13, v13, v171
    v_mov_b32 v14, v13
    s_nop 1
    v_permlane16_swap_b32 v13, v14
    s_nop 1
    v_add_f32 v13, v13, v14
    v_mov_b32 v14, v13
    s_nop 1
    v_permlane32_swap_b32 v13, v14
    s_nop 1
    v_add_f32 v13, v13, v14
    v_rcp_f32 v13, v13
    s_nop 0
    v_mul_f32 v160, v160, v13
    v_mul_f32 v161, v161, v13
    v_mul_f32 v162, v162, v13
    v_mul_f32 v163, v163, v13
    v_mul_f32 v164, v164, v13
    v_mul_f32 v165, v165, v13
    v_mul_f32 v166, v166, v13
    v_mul_f32 v167, v167, v13
    v_mul_f32 v168, v168, v13
    v_mul_f32 v169, v169, v13
    v_mul_f32 v170, v170, v13
    v_mul_f32 v171, v171, v13
    v_cvt_pk_bf16_f32 v190, v164, v165
    v_cvt_pk_bf16_f32 v191, v166, v167
    v_cvt_pk_bf16_f32 v192, v168, v169
    v_cvt_pk_bf16_f32 v193, v170, v171
    v_cvt_pk_bf16_f32 v194, v160, v161
    v_cvt_pk_bf16_f32 v195, v162, v163
    v_cvt_pk_bf16_f32 v14, v172, v173
    v_lshlrev_b32 v172, 16, v14
    v_and_b32 v173, 0xffff0000, v14
    v_mul_f32 v172, s68, v172
    v_mul_f32 v173, s68, v173
    v_cvt_pk_bf16_f32 v14, v172, v173
    v_lshlrev_b32 v172, 16, v14
    v_and_b32 v173, 0xffff0000, v14
    v_cvt_pk_bf16_f32 v14, v174, v175
    v_lshlrev_b32 v174, 16, v14
    v_and_b32 v175, 0xffff0000, v14
    v_mul_f32 v174, s68, v174
    v_mul_f32 v175, s68, v175
    v_cvt_pk_bf16_f32 v14, v174, v175
    v_lshlrev_b32 v174, 16, v14
    v_and_b32 v175, 0xffff0000, v14
    v_cvt_pk_bf16_f32 v14, v176, v177
    v_lshlrev_b32 v176, 16, v14
    v_and_b32 v177, 0xffff0000, v14
    v_mul_f32 v176, s68, v176
    v_mul_f32 v177, s68, v177
    v_cvt_pk_bf16_f32 v14, v176, v177
    v_lshlrev_b32 v176, 16, v14
    v_and_b32 v177, 0xffff0000, v14
    v_cvt_pk_bf16_f32 v14, v178, v179
    v_lshlrev_b32 v178, 16, v14
    v_and_b32 v179, 0xffff0000, v14
    v_mul_f32 v178, s68, v178
    v_mul_f32 v179, s68, v179
    v_cvt_pk_bf16_f32 v14, v178, v179
    v_lshlrev_b32 v178, 16, v14
    v_and_b32 v179, 0xffff0000, v14
    v_cvt_pk_bf16_f32 v14, v180, v181
    v_lshlrev_b32 v180, 16, v14
    v_and_b32 v181, 0xffff0000, v14
    v_mul_f32 v180, s68, v180
    v_mul_f32 v181, s68, v181
    v_cvt_pk_bf16_f32 v14, v180, v181
    v_lshlrev_b32 v180, 16, v14
    v_and_b32 v181, 0xffff0000, v14
    v_cvt_pk_bf16_f32 v14, v182, v183
    v_lshlrev_b32 v182, 16, v14
    v_and_b32 v183, 0xffff0000, v14
    v_mul_f32 v182, s68, v182
    v_mul_f32 v183, s68, v183
    v_cvt_pk_bf16_f32 v14, v182, v183
    v_lshlrev_b32 v182, 16, v14
    v_and_b32 v183, 0xffff0000, v14
    v_cndmask_b32 v172, v172, v12, s[72:73]
    v_cndmask_b32 v173, v173, v12, s[72:73]
    v_cndmask_b32 v174, v174, v12, s[72:73]
    v_cndmask_b32 v175, v175, v12, s[72:73]
    v_cndmask_b32 v180, v12, v180, s[76:77]
    v_cndmask_b32 v181, v12, v181, s[78:79]
    v_cndmask_b32 v182, v12, v182, s[80:81]
    v_cndmask_b32 v183, v12, v183, s[82:83]
    v_max_f32 v13, v172, v173
    v_max3_f32 v13, v13, v174, v175
    v_max3_f32 v13, v13, v176, v177
    v_max3_f32 v13, v13, v178, v179
    v_max3_f32 v13, v13, v180, v181
    v_max3_f32 v13, v13, v182, v183
    v_mov_b32 v14, v13
    s_nop 1
    v_permlane16_swap_b32 v13, v14
    s_nop 1
    v_max_f32 v13, v13, v14
    v_mov_b32 v14, v13
    s_nop 1
    v_permlane32_swap_b32 v13, v14
    s_nop 1
    v_max_f32 v13, v13, v14
    v_sub_f32 v172, v172, v13
    v_mul_f32 v172, s69, v172
    v_exp_f32 v172, v172
    v_sub_f32 v173, v173, v13
    v_mul_f32 v173, s69, v173
    v_exp_f32 v173, v173
    v_sub_f32 v174, v174, v13
    v_mul_f32 v174, s69, v174
    v_exp_f32 v174, v174
    v_sub_f32 v175, v175, v13
    v_mul_f32 v175, s69, v175
    v_exp_f32 v175, v175
    v_sub_f32 v176, v176, v13
    v_mul_f32 v176, s69, v176
    v_exp_f32 v176, v176
    v_sub_f32 v177, v177, v13
    v_mul_f32 v177, s69, v177
    v_exp_f32 v177, v177
    v_sub_f32 v178, v178, v13
    v_mul_f32 v178, s69, v178
    v_exp_f32 v178, v178
    v_sub_f32 v179, v179, v13
    v_mul_f32 v179, s69, v179
    v_exp_f32 v179, v179
    v_sub_f32 v180, v180, v13
    v_mul_f32 v180, s69, v180
    v_exp_f32 v180, v180
    v_sub_f32 v181, v181, v13
    v_mul_f32 v181, s69, v181
    v_exp_f32 v181, v181
    v_sub_f32 v182, v182, v13
    v_mul_f32 v182, s69, v182
    v_exp_f32 v182, v182
    v_sub_f32 v183, v183, v13
    v_mul_f32 v183, s69, v183
    v_exp_f32 v183, v183
    s_nop 0
    v_add_f32 v13, v172, v173
    v_add_f32 v13, v13, v174
    v_add_f32 v13, v13, v175
    v_add_f32 v13, v13, v176
    v_add_f32 v13, v13, v177
    v_add_f32 v13, v13, v178
    v_add_f32 v13, v13, v179
    v_add_f32 v13, v13, v180
    v_add_f32 v13, v13, v181
    v_add_f32 v13, v13, v182
    v_add_f32 v13, v13, v183
    v_mov_b32 v14, v13
    s_nop 1
    v_permlane16_swap_b32 v13, v14
    s_nop 1
    v_add_f32 v13, v13, v14
    v_mov_b32 v14, v13
    s_nop 1
    v_permlane32_swap_b32 v13, v14
    s_nop 1
    v_add_f32 v13, v13, v14
    v_rcp_f32 v13, v13
    s_nop 0
    v_mul_f32 v172, v172, v13
    v_mul_f32 v173, v173, v13
    v_mul_f32 v174, v174, v13
    v_mul_f32 v175, v175, v13
    v_mul_f32 v176, v176, v13
    v_mul_f32 v177, v177, v13
    v_mul_f32 v178, v178, v13
    v_mul_f32 v179, v179, v13
    v_mul_f32 v180, v180, v13
    v_mul_f32 v181, v181, v13
    v_mul_f32 v182, v182, v13
    v_mul_f32 v183, v183, v13
    v_cvt_pk_bf16_f32 v198, v176, v177
    v_cvt_pk_bf16_f32 v199, v178, v179
    v_cvt_pk_bf16_f32 v200, v180, v181
    v_cvt_pk_bf16_f32 v201, v182, v183
    v_cvt_pk_bf16_f32 v202, v172, v173
    v_cvt_pk_bf16_f32 v203, v174, v175
    s_nop 1
    v_mfma_f32_16x16x32_bf16 v[16:19], v[96:99], v[190:193], 0
    v_mfma_f32_16x16x32_bf16 v[20:23], v[104:107], v[190:193], 0
    v_mfma_f32_16x16x32_bf16 v[24:27], v[112:115], v[190:193], 0
    v_mfma_f32_16x16x32_bf16 v[28:31], v[120:123], v[190:193], 0
    v_mfma_f32_16x16x32_bf16 v[32:35], v[128:131], v[190:193], 0
    v_mfma_f32_16x16x32_bf16 v[36:39], v[136:139], v[190:193], 0
    v_mfma_f32_16x16x32_bf16 v[40:43], v[144:147], v[190:193], 0
    v_mfma_f32_16x16x32_bf16 v[44:47], v[152:155], v[190:193], 0
    v_mfma_f32_16x16x32_bf16 v[48:51], v[96:99], v[198:201], 0
    v_mfma_f32_16x16x32_bf16 v[52:55], v[104:107], v[198:201], 0
    v_mfma_f32_16x16x32_bf16 v[56:59], v[112:115], v[198:201], 0
    v_mfma_f32_16x16x32_bf16 v[60:63], v[120:123], v[198:201], 0
    v_mfma_f32_16x16x32_bf16 v[64:67], v[128:131], v[198:201], 0
    v_mfma_f32_16x16x32_bf16 v[68:71], v[136:139], v[198:201], 0
    v_mfma_f32_16x16x32_bf16 v[72:75], v[144:147], v[198:201], 0
    v_mfma_f32_16x16x32_bf16 v[76:79], v[152:155], v[198:201], 0
    s_nop 7
    v_mfma_f32_16x16x16_bf16 v[16:19], v[100:101], v[194:195], v[16:19]
    v_mfma_f32_16x16x16_bf16 v[20:23], v[108:109], v[194:195], v[20:23]
    v_mfma_f32_16x16x16_bf16 v[24:27], v[116:117], v[194:195], v[24:27]
    v_mfma_f32_16x16x16_bf16 v[28:31], v[124:125], v[194:195], v[28:31]
    v_mfma_f32_16x16x16_bf16 v[32:35], v[132:133], v[194:195], v[32:35]
    v_mfma_f32_16x16x16_bf16 v[36:39], v[140:141], v[194:195], v[36:39]
    v_mfma_f32_16x16x16_bf16 v[40:43], v[148:149], v[194:195], v[40:43]
    v_mfma_f32_16x16x16_bf16 v[44:47], v[156:157], v[194:195], v[44:47]
    v_mfma_f32_16x16x16_bf16 v[48:51], v[100:101], v[202:203], v[48:51]
    v_mfma_f32_16x16x16_bf16 v[52:55], v[108:109], v[202:203], v[52:55]
    v_mfma_f32_16x16x16_bf16 v[56:59], v[116:117], v[202:203], v[56:59]
    v_mfma_f32_16x16x16_bf16 v[60:63], v[124:125], v[202:203], v[60:63]
    v_mfma_f32_16x16x16_bf16 v[64:67], v[132:133], v[202:203], v[64:67]
    v_mfma_f32_16x16x16_bf16 v[68:71], v[140:141], v[202:203], v[68:71]
    v_mfma_f32_16x16x16_bf16 v[72:75], v[148:149], v[202:203], v[72:75]
    v_mfma_f32_16x16x16_bf16 v[76:79], v[156:157], v[202:203], v[76:79]
    s_nop 7
    s_nop 3
    v_lshlrev_b32 v8, 13, v3
    v_lshl_add_u32 v8, v2, 3, v8
    v_cvt_pk_bf16_f32 v16, v16, v17
    v_cvt_pk_bf16_f32 v17, v18, v19
    buffer_store_dwordx2 v[16:17], v8, s[60:63], s64 offen offset:0 sc1
    v_cvt_pk_bf16_f32 v20, v20, v21
    v_cvt_pk_bf16_f32 v21, v22, v23
    buffer_store_dwordx2 v[20:21], v8, s[60:63], s64 offen offset:32 sc1
    v_cvt_pk_bf16_f32 v24, v24, v25
    v_cvt_pk_bf16_f32 v25, v26, v27
    buffer_store_dwordx2 v[24:25], v8, s[60:63], s64 offen offset:64 sc1
    v_cvt_pk_bf16_f32 v28, v28, v29
    v_cvt_pk_bf16_f32 v29, v30, v31
    buffer_store_dwordx2 v[28:29], v8, s[60:63], s64 offen offset:96 sc1
    v_cvt_pk_bf16_f32 v32, v32, v33
    v_cvt_pk_bf16_f32 v33, v34, v35
    buffer_store_dwordx2 v[32:33], v8, s[60:63], s64 offen offset:128 sc1
    v_cvt_pk_bf16_f32 v36, v36, v37
    v_cvt_pk_bf16_f32 v37, v38, v39
    buffer_store_dwordx2 v[36:37], v8, s[60:63], s64 offen offset:160 sc1
    v_cvt_pk_bf16_f32 v40, v40, v41
    v_cvt_pk_bf16_f32 v41, v42, v43
    buffer_store_dwordx2 v[40:41], v8, s[60:63], s64 offen offset:192 sc1
    v_cvt_pk_bf16_f32 v44, v44, v45
    v_cvt_pk_bf16_f32 v45, v46, v47
    buffer_store_dwordx2 v[44:45], v8, s[60:63], s64 offen offset:224 sc1
    v_cvt_pk_bf16_f32 v48, v48, v49
    v_cvt_pk_bf16_f32 v49, v50, v51
    buffer_store_dwordx2 v[48:49], v8, s[60:63], s65 offen offset:0 sc1
    v_cvt_pk_bf16_f32 v52, v52, v53
    v_cvt_pk_bf16_f32 v53, v54, v55
    buffer_store_dwordx2 v[52:53], v8, s[60:63], s65 offen offset:32 sc1
    v_cvt_pk_bf16_f32 v56, v56, v57
    v_cvt_pk_bf16_f32 v57, v58, v59
    buffer_store_dwordx2 v[56:57], v8, s[60:63], s65 offen offset:64 sc1
    v_cvt_pk_bf16_f32 v60, v60, v61
    v_cvt_pk_bf16_f32 v61, v62, v63
    buffer_store_dwordx2 v[60:61], v8, s[60:63], s65 offen offset:96 sc1
    v_cvt_pk_bf16_f32 v64, v64, v65
    v_cvt_pk_bf16_f32 v65, v66, v67
    buffer_store_dwordx2 v[64:65], v8, s[60:63], s65 offen offset:128 sc1
    v_cvt_pk_bf16_f32 v68, v68, v69
    v_cvt_pk_bf16_f32 v69, v70, v71
    buffer_store_dwordx2 v[68:69], v8, s[60:63], s65 offen offset:160 sc1
    v_cvt_pk_bf16_f32 v72, v72, v73
    v_cvt_pk_bf16_f32 v73, v74, v75
    buffer_store_dwordx2 v[72:73], v8, s[60:63], s65 offen offset:192 sc1
    v_cvt_pk_bf16_f32 v76, v76, v77
    v_cvt_pk_bf16_f32 v77, v78, v79
    buffer_store_dwordx2 v[76:77], v8, s[60:63], s65 offen offset:224 sc1
    s_waitcnt vmcnt(0)
    s_lshr_b32 s39, s89, 2
    s_lshl_b32 s39, s39, 2
    s_add_u32 s39, s39, 0x5800400
    s_mov_b32 exec_lo, 1
    s_mov_b32 exec_hi, 0
    v_mov_b32 v8, s39
    v_mov_b32 v9, 1
    global_atomic_add v8, v9, s[34:35]
    s_mov_b64 exec, -1
    s_add_u32 s89, s89, 384
    s_branch KA_loop
KF_start:
    s_barrier
    s_cmp_lg_u32 s4, 0
    s_cbranch_scc1 KQ_wS
    s_mov_b32 exec_lo, 1
    s_mov_b32 exec_hi, 0
    v_mov_b32 v2, 52
    v_mov_b32 v3, 1
    global_atomic_add v4, v2, v3, s[32:33] sc0
    s_waitcnt vmcnt(0)
    v_mov_b32 v2, 0
    ds_write_b32 v2, v4 offset:16
    s_mov_b64 exec, -1
    s_waitcnt lgkmcnt(0)
KQ_wS:
    s_barrier
    v_mov_b32 v2, 0
    ds_read_b32 v3, v2 offset:16
    s_waitcnt lgkmcnt(0)
    v_readfirstlane_b32 s89, v3
KF_loop:
    s_cmp_ge_u32 s89, 720
    s_cbranch_scc1 KG_start
    s_mul_hi_u32 s37, s89, 0xaaaaaab
    s_mul_i32 s39, s37, 24
    s_sub_u32 s39, s89, s39
    s_mul_i32 s36, s39, 43
    s_lshr_b32 s36, s36, 8
    s_mul_i32 s38, s36, 6
    s_sub_u32 s38, s39, s38
    s_mul_i32 s56, s37, 6
    s_add_u32 s56, s56, s38
    s_add_u32 s37, s37, 0
    s_mul_i32 s39, s37, 524288
    s_mul_i32 s52, s36, 2048
    s_add_u32 s39, s39, s52
    s_add_u32 s39, s39, 0x4400000
    s_add_u32 s40, s34, s39
    s_addc_u32 s41, s35, 0
    s_mov_b32 s42, 518144
    s_mov_b32 s43, 0x00020000
    s_mul_i32 s39, s36, 1179648
    s_mul_i32 s52, s38, 192
    s_add_u32 s39, s39, s52
    s_add_u32 s44, s18, s39
    s_addc_u32 s45, s19, 0
    s_sub_u32 s46, 4718592, s39
    s_mov_b32 s47, 0x00020000
    v_lshrrev_b32 v1, 4, v0
    v_add_u32 v1, 0, v1
    v_and_b32 v2, 15, v0
    v_mul_u32_u24 v3, 8192, v1
    v_lshl_add_u32 v8, v2, 4, v3
    v_mul_u32_u24 v3, 272, v1
    v_lshl_add_u32 v18, v2, 4, v3
    v_lshrrev_b32 v1, 4, v0
    v_add_u32 v1, 16, v1
    v_and_b32 v2, 15, v0
    v_mul_u32_u24 v3, 8192, v1
    v_lshl_add_u32 v9, v2, 4, v3
    v_mul_u32_u24 v3, 272, v1
    v_lshl_add_u32 v19, v2, 4, v3
    v_lshrrev_b32 v1, 4, v0
    v_add_u32 v1, 32, v1
    v_and_b32 v2, 15, v0
    v_mul_u32_u24 v3, 8192, v1
    v_lshl_add_u32 v10, v2, 4, v3
    v_mul_u32_u24 v3, 272, v1
    v_lshl_add_u32 v20, v2, 4, v3
    v_lshrrev_b32 v1, 4, v0
    v_add_u32 v1, 48, v1
    v_and_b32 v2, 15, v0
    v_mul_u32_u24 v3, 8192, v1
    v_lshl_add_u32 v11, v2, 4, v3
    v_mul_u32_u24 v3, 272, v1
    v_lshl_add_u32 v21, v2, 4, v3
    v_add_u32 v1, 0, v0
    v_mul_u32_u24 v2, 87382, v1
    v_lshrrev_b32 v2, 20, v2
    v_mul_u32_u24 v3, 12, v2
    v_sub_u32 v1, v1, v3
    v_mul_u32_u24 v3, 1152, v2
    v_lshl_add_u32 v12, v1, 4, v3
    v_mul_u32_u24 v3, 224, v2
    v_lshl_add_u32 v22, v1, 4, v3
    v_add_u32 v22, 17408, v22
    v_add_u32 v1, 256, v0
    v_mul_u32_u24 v2, 87382, v1
    v_lshrrev_b32 v2, 20, v2
    v_mul_u32_u24 v3, 12, v2
    v_sub_u32 v1, v1, v3
    v_mul_u32_u24 v3, 1152, v2
    v_lshl_add_u32 v13, v1, 4, v3
    v_mul_u32_u24 v3, 224, v2
    v_lshl_add_u32 v23, v1, 4, v3
    v_add_u32 v23, 17408, v23
    v_add_u32 v1, 512, v0
    v_mul_u32_u24 v2, 87382, v1
    v_lshrrev_b32 v2, 20, v2
    v_mul_u32_u24 v3, 12, v2
    v_sub_u32 v1, v1, v3
    v_mul_u32_u24 v3, 1152, v2
    v_lshl_add_u32 v14, v1, 4, v3
    v_mul_u32_u24 v3, 224, v2
    v_lshl_add_u32 v24, v1, 4, v3
    v_add_u32 v24, 17408, v24
    v_add_u32 v1, 768, v0
    v_mul_u32_u24 v2, 87382, v1
    v_lshrrev_b32 v2, 20, v2
    v_mul_u32_u24 v3, 12, v2
    v_sub_u32 v1, v1, v3
    v_mul_u32_u24 v3, 1152, v2
    v_lshl_add_u32 v15, v1, 4, v3
    v_mul_u32_u24 v3, 224, v2
    v_lshl_add_u32 v25, v1, 4, v3
    v_add_u32 v25, 17408, v25
    v_add_u32 v1, 1024, v0
    v_mul_u32_u24 v2, 87382, v1
    v_lshrrev_b32 v2, 20, v2
    v_mul_u32_u24 v3, 12, v2
    v_sub_u32 v1, v1, v3
    v_mul_u32_u24 v3, 1152, v2
    v_lshl_add_u32 v16, v1, 4, v3
    v_mul_u32_u24 v3, 224, v2
    v_lshl_add_u32 v26, v1, 4, v3
    v_add_u32 v26, 17408, v26
    v_add_u32 v1, 1280, v0
    v_mul_u32_u24 v2, 87382, v1
    v_lshrrev_b32 v2, 20, v2
    v_mul_u32_u24 v3, 12, v2
    v_sub_u32 v1, v1, v3
    v_mul_u32_u24 v3, 1152, v2
    v_lshl_add_u32 v17, v1, 4, v3
    v_mul_u32_u24 v3, 224, v2
    v_lshl_add_u32 v27, v1, 4, v3
    v_add_u32 v27, 17408, v27
    v_lshrrev_b32 v1, 6, v0
    v_and_b32 v2, 63, v0
    v_lshrrev_b32 v3, 1, v1
    v_mul_u32_u24 v3, 32, v3
    v_and_b32 v28, 15, v2
    v_add_u32 v3, v3, v28
    v_mul_u32_u24 v3, 272, v3
    v_lshrrev_b32 v28, 4, v2
    v_lshl_add_u32 v28, v28, 3, v3
    v_lshrrev_b32 v3, 4, v2
    v_lshlrev_b32 v3, 2, v3
    v_bfe_u32 v29, v2, 2, 2
    v_add_u32 v3, v3, v29
    v_mul_u32_u24 v3, 224, v3
    v_and_b32 v1, 1, v1
    v_mul_u32_u24 v1, 96, v1
    v_add_u32 v3, v3, v1
    v_and_b32 v1, 3, v2
    v_lshl_add_u32 v29, v1, 3, v3
    v_add_u32 v29, 17408, v29
    v_add_u32 v30, 46080, v28
    v_add_u32 v31, 46080, v29
    v_mov_b32 v152, 0
    v_mov_b32 v153, 0
    v_mov_b32 v154, 0
    v_mov_b32 v155, 0
    v_mov_b32 v156, 0
    v_mov_b32 v157, 0
    v_mov_b32 v158, 0
    v_mov_b32 v159, 0
    v_mov_b32 v160, 0
    v_mov_b32 v161, 0
    v_mov_b32 v162, 0
    v_mov_b32 v163, 0
    v_mov_b32 v164, 0
    v_mov_b32 v165, 0
    v_mov_b32 v166, 0
    v_mov_b32 v167, 0
    v_mov_b32 v168, 0
    v_mov_b32 v169, 0
    v_mov_b32 v170, 0
    v_mov_b32 v171, 0
    v_mov_b32 v172, 0
    v_mov_b32 v173, 0
    v_mov_b32 v174, 0
    v_mov_b32 v175, 0
    s_mov_b32 s48, 0
    s_mov_b32 s49, 0
    buffer_load_dwordx4 v[48:51], v12, s[44:47], s49 offen
    buffer_load_dwordx4 v[52:55], v13, s[44:47], s49 offen
    buffer_load_dwordx4 v[56:59], v14, s[44:47], s49 offen
    buffer_load_dwordx4 v[60:63], v15, s[44:47], s49 offen
    buffer_load_dwordx4 v[64:67], v16, s[44:47], s49 offen
    buffer_load_dwordx4 v[68:71], v17, s[44:47], s49 offen
    s_add_u32 s49, s49, 0x24000
    buffer_load_dwordx4 v[88:91], v12, s[44:47], s49 offen
    buffer_load_dwordx4 v[92:95], v13, s[44:47], s49 offen
    buffer_load_dwordx4 v[96:99], v14, s[44:47], s49 offen
    buffer_load_dwordx4 v[100:103], v15, s[44:47], s49 offen
    buffer_load_dwordx4 v[104:107], v16, s[44:47], s49 offen
    buffer_load_dwordx4 v[108:111], v17, s[44:47], s49 offen
    s_add_u32 s49, s49, 0x24000
    s_mul_i32 s39, s37, 16
    s_mul_i32 s52, s36, 2
    s_add_u32 s39, s39, s52
    s_lshl_b32 s39, s39, 2
    s_add_u32 s39, s39, 0x5800400
    v_mov_b32 v2, s39
    s_mov_b32 s6, 0
KF_spin:
    global_load_dwordx2 v[4:5], v2, s[34:35] sc1
    global_load_dwordx2 v[6:7], v2, s[34:35] offset:32 sc1
    s_add_u32 s6, s6, 1
    s_waitcnt vmcnt(0)
    v_min_u32 v4, v4, v5
    v_min3_u32 v4, v4, v6, v7
    s_nop 0
    v_readfirstlane_b32 s7, v4
    s_cmp_ge_u32 s6, 0x200000
    s_cbranch_scc1 KF_go
    s_cmp_ge_u32 s7, 4
    s_cbranch_scc1 KF_go
    s_sleep 4
    s_branch KF_spin
KF_go:
    buffer_load_dwordx4 v[32:35], v8, s[40:43], s48 offen sc1
    buffer_load_dwordx4 v[36:39], v9, s[40:43], s48 offen sc1
    buffer_load_dwordx4 v[40:43], v10, s[40:43], s48 offen sc1
    buffer_load_dwordx4 v[44:47], v11, s[40:43], s48 offen sc1
    s_add_u32 s48, s48, 256
    buffer_load_dwordx4 v[72:75], v8, s[40:43], s48 offen sc1
    buffer_load_dwordx4 v[76:79], v9, s[40:43], s48 offen sc1
    buffer_load_dwordx4 v[80:83], v10, s[40:43], s48 offen sc1
    buffer_load_dwordx4 v[84:87], v11, s[40:43], s48 offen sc1
    s_add_u32 s48, s48, 256
    s_waitcnt vmcnt(4)
    s_barrier
    ds_write_b128 v18, v[32:35] offset:0
    ds_write_b128 v19, v[36:39] offset:0
    ds_write_b128 v20, v[40:43] offset:0
    ds_write_b128 v21, v[44:47] offset:0
    ds_write_b128 v22, v[48:51] offset:0
    ds_write_b128 v23, v[52:55] offset:0
    ds_write_b128 v24, v[56:59] offset:0
    ds_write_b128 v25, v[60:63] offset:0
    ds_write_b128 v26, v[64:67] offset:0
    ds_write_b128 v27, v[68:71] offset:0
    s_waitcnt lgkmcnt(0)
    s_barrier
    s_mov_b32 s50, 8
GL_15:
    buffer_load_dwordx4 v[32:35], v8, s[40:43], s48 offen sc1
    buffer_load_dwordx4 v[36:39], v9, s[40:43], s48 offen sc1
    buffer_load_dwordx4 v[40:43], v10, s[40:43], s48 offen sc1
    buffer_load_dwordx4 v[44:47], v11, s[40:43], s48 offen sc1
    buffer_load_dwordx4 v[48:51], v12, s[44:47], s49 offen
    buffer_load_dwordx4 v[52:55], v13, s[44:47], s49 offen
    buffer_load_dwordx4 v[56:59], v14, s[44:47], s49 offen
    buffer_load_dwordx4 v[60:63], v15, s[44:47], s49 offen
    buffer_load_dwordx4 v[64:67], v16, s[44:47], s49 offen
    buffer_load_dwordx4 v[68:71], v17, s[44:47], s49 offen
    s_add_u32 s48, s48, 256
    s_add_u32 s49, s49, 0x24000
    ds_read_b64 v[112:113], v28 offset:0
    ds_read_b64 v[114:115], v28 offset:32
    ds_read_b64 v[116:117], v28 offset:4352
    ds_read_b64 v[118:119], v28 offset:4384
    ds_read_b64_tr_b16 v[128:129], v29 offset:0
    ds_read_b64_tr_b16 v[130:131], v29 offset:3584
    ds_read_b64_tr_b16 v[132:133], v29 offset:32
    ds_read_b64_tr_b16 v[134:135], v29 offset:3616
    ds_read_b64_tr_b16 v[136:137], v29 offset:64
    ds_read_b64_tr_b16 v[138:139], v29 offset:3648
    ds_read_b64 v[120:121], v28 offset:64
    ds_read_b64 v[122:123], v28 offset:96
    ds_read_b64 v[124:125], v28 offset:4416
    ds_read_b64 v[126:127], v28 offset:4448
    ds_read_b64_tr_b16 v[140:141], v29 offset:7168
    ds_read_b64_tr_b16 v[142:143], v29 offset:10752
    ds_read_b64_tr_b16 v[144:145], v29 offset:7200
    ds_read_b64_tr_b16 v[146:147], v29 offset:10784
    ds_read_b64_tr_b16 v[148:149], v29 offset:7232
    ds_read_b64_tr_b16 v[150:151], v29 offset:10816
    s_waitcnt lgkmcnt(10)
    v_mfma_f32_16x16x32_bf16 v[152:155], v[128:131], v[112:115], v[152:155]
    v_mfma_f32_16x16x32_bf16 v[156:159], v[132:135], v[112:115], v[156:159]
    v_mfma_f32_16x16x32_bf16 v[160:163], v[136:139], v[112:115], v[160:163]
    v_mfma_f32_16x16x32_bf16 v[164:167], v[128:131], v[116:119], v[164:167]
    v_mfma_f32_16x16x32_bf16 v[168:171], v[132:135], v[116:119], v[168:171]
    v_mfma_f32_16x16x32_bf16 v[172:175], v[136:139], v[116:119], v[172:175]
    ds_read_b64 v[112:113], v28 offset:128
    ds_read_b64 v[114:115], v28 offset:160
    ds_read_b64 v[116:117], v28 offset:4480
    ds_read_b64 v[118:119], v28 offset:4512
    ds_read_b64_tr_b16 v[128:129], v29 offset:14336
    ds_read_b64_tr_b16 v[130:131], v29 offset:17920
    ds_read_b64_tr_b16 v[132:133], v29 offset:14368
    ds_read_b64_tr_b16 v[134:135], v29 offset:17952
    ds_read_b64_tr_b16 v[136:137], v29 offset:14400
    ds_read_b64_tr_b16 v[138:139], v29 offset:17984
    s_waitcnt lgkmcnt(10)
    v_mfma_f32_16x16x32_bf16 v[152:155], v[140:143], v[120:123], v[152:155]
    v_mfma_f32_16x16x32_bf16 v[156:159], v[144:147], v[120:123], v[156:159]
    v_mfma_f32_16x16x32_bf16 v[160:163], v[148:151], v[120:123], v[160:163]
    v_mfma_f32_16x16x32_bf16 v[164:167], v[140:143], v[124:127], v[164:167]
    v_mfma_f32_16x16x32_bf16 v[168:171], v[144:147], v[124:127], v[168:171]
    v_mfma_f32_16x16x32_bf16 v[172:175], v[148:151], v[124:127], v[172:175]
    ds_read_b64 v[120:121], v28 offset:192
    ds_read_b64 v[122:123], v28 offset:224
    ds_read_b64 v[124:125], v28 offset:4544
    ds_read_b64 v[126:127], v28 offset:4576
    ds_read_b64_tr_b16 v[140:141], v29 offset:21504
    ds_read_b64_tr_b16 v[142:143], v29 offset:25088
    ds_read_b64_tr_b16 v[144:145], v29 offset:21536
    ds_read_b64_tr_b16 v[146:147], v29 offset:25120
    ds_read_b64_tr_b16 v[148:149], v29 offset:21568
    ds_read_b64_tr_b16 v[150:151], v29 offset:25152
    s_waitcnt lgkmcnt(10)
    v_mfma_f32_16x16x32_bf16 v[152:155], v[128:131], v[112:115], v[152:155]
    v_mfma_f32_16x16x32_bf16 v[156:159], v[132:135], v[112:115], v[156:159]
    v_mfma_f32_16x16x32_bf16 v[160:163], v[136:139], v[112:115], v[160:163]
    v_mfma_f32_16x16x32_bf16 v[164:167], v[128:131], v[116:119], v[164:167]
    v_mfma_f32_16x16x32_bf16 v[168:171], v[132:135], v[116:119], v[168:171]
    v_mfma_f32_16x16x32_bf16 v[172:175], v[136:139], v[116:119], v[172:175]
    s_waitcnt lgkmcnt(0)
    v_mfma_f32_16x16x32_bf16 v[152:155], v[140:143], v[120:123], v[152:155]
    v_mfma_f32_16x16x32_bf16 v[156:159], v[144:147], v[120:123], v[156:159]
    v_mfma_f32_16x16x32_bf16 v[160:163], v[148:151], v[120:123], v[160:163]
    v_mfma_f32_16x16x32_bf16 v[164:167], v[140:143], v[124:127], v[164:167]
    v_mfma_f32_16x16x32_bf16 v[168:171], v[144:147], v[124:127], v[168:171]
    v_mfma_f32_16x16x32_bf16 v[172:175], v[148:151], v[124:127], v[172:175]
    s_waitcnt vmcnt(10)
    ds_write_b128 v18, v[72:75] offset:46080
    ds_write_b128 v19, v[76:79] offset:46080
    ds_write_b128 v20, v[80:83] offset:46080
    ds_write_b128 v21, v[84:87] offset:46080
    ds_write_b128 v22, v[88:91] offset:46080
    ds_write_b128 v23, v[92:95] offset:46080
    ds_write_b128 v24, v[96:99] offset:46080
    ds_write_b128 v25, v[100:103] offset:46080
    ds_write_b128 v26, v[104:107] offset:46080
    ds_write_b128 v27, v[108:111] offset:46080
    s_waitcnt lgkmcnt(0)
    s_barrier
    s_sub_u32 s50, s50, 1
    s_cmp_eq_u32 s50, 0
    s_cbranch_scc1 GE_16
    buffer_load_dwordx4 v[72:75], v8, s[40:43], s48 offen sc1
    buffer_load_dwordx4 v[76:79], v9, s[40:43], s48 offen sc1
    buffer_load_dwordx4 v[80:83], v10, s[40:43], s48 offen sc1
    buffer_load_dwordx4 v[84:87], v11, s[40:43], s48 offen sc1
    buffer_load_dwordx4 v[88:91], v12, s[44:47], s49 offen
    buffer_load_dwordx4 v[92:95], v13, s[44:47], s49 offen
    buffer_load_dwordx4 v[96:99], v14, s[44:47], s49 offen
    buffer_load_dwordx4 v[100:103], v15, s[44:47], s49 offen
    buffer_load_dwordx4 v[104:107], v16, s[44:47], s49 offen
    buffer_load_dwordx4 v[108:111], v17, s[44:47], s49 offen
    s_add_u32 s48, s48, 256
    s_add_u32 s49, s49, 0x24000
    ds_read_b64 v[112:113], v30 offset:0
    ds_read_b64 v[114:115], v30 offset:32
    ds_read_b64 v[116:117], v30 offset:4352
    ds_read_b64 v[118:119], v30 offset:4384
    ds_read_b64_tr_b16 v[128:129], v31 offset:0
    ds_read_b64_tr_b16 v[130:131], v31 offset:3584
    ds_read_b64_tr_b16 v[132:133], v31 offset:32
    ds_read_b64_tr_b16 v[134:135], v31 offset:3616
    ds_read_b64_tr_b16 v[136:137], v31 offset:64
    ds_read_b64_tr_b16 v[138:139], v31 offset:3648
    ds_read_b64 v[120:121], v30 offset:64
    ds_read_b64 v[122:123], v30 offset:96
    ds_read_b64 v[124:125], v30 offset:4416
    ds_read_b64 v[126:127], v30 offset:4448
    ds_read_b64_tr_b16 v[140:141], v31 offset:7168
    ds_read_b64_tr_b16 v[142:143], v31 offset:10752
    ds_read_b64_tr_b16 v[144:145], v31 offset:7200
    ds_read_b64_tr_b16 v[146:147], v31 offset:10784
    ds_read_b64_tr_b16 v[148:149], v31 offset:7232
    ds_read_b64_tr_b16 v[150:151], v31 offset:10816
    s_waitcnt lgkmcnt(10)
    v_mfma_f32_16x16x32_bf16 v[152:155], v[128:131], v[112:115], v[152:155]
    v_mfma_f32_16x16x32_bf16 v[156:159], v[132:135], v[112:115], v[156:159]
    v_mfma_f32_16x16x32_bf16 v[160:163], v[136:139], v[112:115], v[160:163]
    v_mfma_f32_16x16x32_bf16 v[164:167], v[128:131], v[116:119], v[164:167]
    v_mfma_f32_16x16x32_bf16 v[168:171], v[132:135], v[116:119], v[168:171]
    v_mfma_f32_16x16x32_bf16 v[172:175], v[136:139], v[116:119], v[172:175]
    ds_read_b64 v[112:113], v30 offset:128
    ds_read_b64 v[114:115], v30 offset:160
    ds_read_b64 v[116:117], v30 offset:4480
    ds_read_b64 v[118:119], v30 offset:4512
    ds_read_b64_tr_b16 v[128:129], v31 offset:14336
    ds_read_b64_tr_b16 v[130:131], v31 offset:17920
    ds_read_b64_tr_b16 v[132:133], v31 offset:14368
    ds_read_b64_tr_b16 v[134:135], v31 offset:17952
    ds_read_b64_tr_b16 v[136:137], v31 offset:14400
    ds_read_b64_tr_b16 v[138:139], v31 offset:17984
    s_waitcnt lgkmcnt(10)
    v_mfma_f32_16x16x32_bf16 v[152:155], v[140:143], v[120:123], v[152:155]
    v_mfma_f32_16x16x32_bf16 v[156:159], v[144:147], v[120:123], v[156:159]
    v_mfma_f32_16x16x32_bf16 v[160:163], v[148:151], v[120:123], v[160:163]
    v_mfma_f32_16x16x32_bf16 v[164:167], v[140:143], v[124:127], v[164:167]
    v_mfma_f32_16x16x32_bf16 v[168:171], v[144:147], v[124:127], v[168:171]
    v_mfma_f32_16x16x32_bf16 v[172:175], v[148:151], v[124:127], v[172:175]
    ds_read_b64 v[120:121], v30 offset:192
    ds_read_b64 v[122:123], v30 offset:224
    ds_read_b64 v[124:125], v30 offset:4544
    ds_read_b64 v[126:127], v30 offset:4576
    ds_read_b64_tr_b16 v[140:141], v31 offset:21504
    ds_read_b64_tr_b16 v[142:143], v31 offset:25088
    ds_read_b64_tr_b16 v[144:145], v31 offset:21536
    ds_read_b64_tr_b16 v[146:147], v31 offset:25120
    ds_read_b64_tr_b16 v[148:149], v31 offset:21568
    ds_read_b64_tr_b16 v[150:151], v31 offset:25152
    s_waitcnt lgkmcnt(10)
    v_mfma_f32_16x16x32_bf16 v[152:155], v[128:131], v[112:115], v[152:155]
    v_mfma_f32_16x16x32_bf16 v[156:159], v[132:135], v[112:115], v[156:159]
    v_mfma_f32_16x16x32_bf16 v[160:163], v[136:139], v[112:115], v[160:163]
    v_mfma_f32_16x16x32_bf16 v[164:167], v[128:131], v[116:119], v[164:167]
    v_mfma_f32_16x16x32_bf16 v[168:171], v[132:135], v[116:119], v[168:171]
    v_mfma_f32_16x16x32_bf16 v[172:175], v[136:139], v[116:119], v[172:175]
    s_waitcnt lgkmcnt(0)
    v_mfma_f32_16x16x32_bf16 v[152:155], v[140:143], v[120:123], v[152:155]
    v_mfma_f32_16x16x32_bf16 v[156:159], v[144:147], v[120:123], v[156:159]
    v_mfma_f32_16x16x32_bf16 v[160:163], v[148:151], v[120:123], v[160:163]
    v_mfma_f32_16x16x32_bf16 v[164:167], v[140:143], v[124:127], v[164:167]
    v_mfma_f32_16x16x32_bf16 v[168:171], v[144:147], v[124:127], v[168:171]
    v_mfma_f32_16x16x32_bf16 v[172:175], v[148:151], v[124:127], v[172:175]
    s_waitcnt vmcnt(10)
    ds_write_b128 v18, v[32:35] offset:0
    ds_write_b128 v19, v[36:39] offset:0
    ds_write_b128 v20, v[40:43] offset:0
    ds_write_b128 v21, v[44:47] offset:0
    ds_write_b128 v22, v[48:51] offset:0
    ds_write_b128 v23, v[52:55] offset:0
    ds_write_b128 v24, v[56:59] offset:0
    ds_write_b128 v25, v[60:63] offset:0
    ds_write_b128 v26, v[64:67] offset:0
    ds_write_b128 v27, v[68:71] offset:0
    s_waitcnt lgkmcnt(0)
    s_barrier
    s_sub_u32 s50, s50, 1
    s_cmp_lg_u32 s50, 0
    s_cbranch_scc1 GL_15
GE_16:
    s_waitcnt vmcnt(0)
    s_nop 7
    s_nop 7
    s_mul_i32 s39, s56, 98304
    s_add_u32 s39, s39, 0x6000000
    s_add_u32 s52, s34, s39
    s_addc_u32 s53, s35, 0
    s_mov_b32 s54, 98304
    s_mov_b32 s55, 0x00020000
    v_lshlrev_b32 v1, 4, v0
    s_mul_i32 s57, s36, 24576
    buffer_store_dwordx4 v[152:155], v1, s[52:55], s57 offen sc1
    s_add_u32 s57, s57, 4096
    buffer_store_dwordx4 v[156:159], v1, s[52:55], s57 offen sc1
    s_add_u32 s57, s57, 4096
    buffer_store_dwordx4 v[160:163], v1, s[52:55], s57 offen sc1
    s_add_u32 s57, s57, 4096
    buffer_store_dwordx4 v[164:167], v1, s[52:55], s57 offen sc1
    s_add_u32 s57, s57, 4096
    buffer_store_dwordx4 v[168:171], v1, s[52:55], s57 offen sc1
    s_add_u32 s57, s57, 4096
    buffer_store_dwordx4 v[172:175], v1, s[52:55], s57 offen sc1
    s_add_u32 s57, s57, 4096
    s_waitcnt vmcnt(0)
    s_barrier
    s_cmp_lg_u32 s4, 0
    s_cbranch_scc1 KF_w
    s_mov_b32 exec_lo, 1
    s_mov_b32 exec_hi, 0
    s_lshl_b32 s39, s56, 2
    s_add_u32 s39, s39, 0x5801000
    v_mov_b32 v2, s39
    v_mov_b32 v3, 1
    global_atomic_add v4, v2, v3, s[34:35] sc0
    s_waitcnt vmcnt(0)
    v_mov_b32 v2, 0
    ds_write_b32 v2, v4
    s_mov_b64 exec, -1
    s_waitcnt lgkmcnt(0)
KF_w:
    s_barrier
    v_mov_b32 v2, 0
    ds_read_b32 v3, v2
    s_waitcnt lgkmcnt(0)
    v_readfirstlane_b32 s7, v3
    s_cmp_lg_u32 s7, 3
    s_cbranch_scc1 KF_next
    s_mov_b32 s39, 0
    buffer_load_dwordx4 v[100:103], v1, s[52:55], s39 offen sc1
    s_mov_b32 s39, 4096
    buffer_load_dwordx4 v[104:107], v1, s[52:55], s39 offen sc1
    s_mov_b32 s39, 8192
    buffer_load_dwordx4 v[108:111], v1, s[52:55], s39 offen sc1
    s_mov_b32 s39, 12288
    buffer_load_dwordx4 v[112:115], v1, s[52:55], s39 offen sc1
    s_mov_b32 s39, 16384
    buffer_load_dwordx4 v[116:119], v1, s[52:55], s39 offen sc1
    s_mov_b32 s39, 20480
    buffer_load_dwordx4 v[120:123], v1, s[52:55], s39 offen sc1
    s_mov_b32 s39, 24576
    buffer_load_dwordx4 v[124:127], v1, s[52:55], s39 offen sc1
    s_mov_b32 s39, 28672
    buffer_load_dwordx4 v[128:131], v1, s[52:55], s39 offen sc1
    s_mov_b32 s39, 32768
    buffer_load_dwordx4 v[132:135], v1, s[52:55], s39 offen sc1
    s_mov_b32 s39, 36864
    buffer_load_dwordx4 v[136:139], v1, s[52:55], s39 offen sc1
    s_mov_b32 s39, 40960
    buffer_load_dwordx4 v[140:143], v1, s[52:55], s39 offen sc1
    s_mov_b32 s39, 45056
    buffer_load_dwordx4 v[144:147], v1, s[52:55], s39 offen sc1
    s_mov_b32 s39, 49152
    buffer_load_dwordx4 v[148:151], v1, s[52:55], s39 offen sc1
    s_mov_b32 s39, 53248
    buffer_load_dwordx4 v[152:155], v1, s[52:55], s39 offen sc1
    s_mov_b32 s39, 57344
    buffer_load_dwordx4 v[156:159], v1, s[52:55], s39 offen sc1
    s_mov_b32 s39, 61440
    buffer_load_dwordx4 v[160:163], v1, s[52:55], s39 offen sc1
    s_mov_b32 s39, 65536
    buffer_load_dwordx4 v[164:167], v1, s[52:55], s39 offen sc1
    s_mov_b32 s39, 69632
    buffer_load_dwordx4 v[168:171], v1, s[52:55], s39 offen sc1
    s_mov_b32 s39, 73728
    buffer_load_dwordx4 v[172:175], v1, s[52:55], s39 offen sc1
    s_mov_b32 s39, 77824
    buffer_load_dwordx4 v[176:179], v1, s[52:55], s39 offen sc1
    s_mov_b32 s39, 81920
    buffer_load_dwordx4 v[180:183], v1, s[52:55], s39 offen sc1
    s_mov_b32 s39, 86016
    buffer_load_dwordx4 v[184:187], v1, s[52:55], s39 offen sc1
    s_mov_b32 s39, 90112
    buffer_load_dwordx4 v[188:191], v1, s[52:55], s39 offen sc1
    s_mov_b32 s39, 94208
    buffer_load_dwordx4 v[192:195], v1, s[52:55], s39 offen sc1
    s_add_u32 s60, s34, 0x5a00000
    s_addc_u32 s61, s35, 0
    s_mov_b32 s62, 0x240000
    s_mov_b32 s63, 0x00020000
    s_add_u32 s64, s34, 0x5700000
    s_addc_u32 s65, s35, 0
    s_mov_b32 s66, 0x2000
    s_mov_b32 s67, 0x00020000
    v_lshrrev_b32 v2, 7, v0
    v_and_b32 v3, 15, v0
    v_mul_u32_u24 v2, 32, v2
    v_add_u32 v2, v2, v3
    v_bfe_u32 v3, v0, 6, 1
    v_bfe_u32 v4, v0, 4, 2
    v_mul_u32_u24 v5, 1152, v2
    v_mul_u32_u24 v6, 96, v3
    v_add_u32 v5, v5, v6
    v_lshl_add_u32 v5, v4, 3, v5
    s_mul_i32 s39, s37, 73728
    s_mul_i32 s57, s38, 192
    s_add_u32 s39, s39, s57
    s_add_u32 s58, s39, 18432
    buffer_load_dwordx2 v[200:201], v5, s[60:63], s39 offen offset:0 sc1
    buffer_load_dwordx2 v[202:203], v5, s[60:63], s39 offen offset:32 sc1
    buffer_load_dwordx2 v[204:205], v5, s[60:63], s39 offen offset:64 sc1
    buffer_load_dwordx2 v[206:207], v5, s[60:63], s58 offen offset:0 sc1
    buffer_load_dwordx2 v[208:209], v5, s[60:63], s58 offen offset:32 sc1
    buffer_load_dwordx2 v[210:211], v5, s[60:63], s58 offen offset:64 sc1
    v_lshlrev_b32 v6, 2, v2
    s_mul_i32 s57, s37, 256
    buffer_load_dword v214, v6, s[64:67], s57 offen sc1
    buffer_load_dword v215, v6, s[64:67], s57 offen offset:64 sc1
    s_waitcnt vmcnt(0)
    v_add_f32 v100, v100, v124
    v_add_f32 v101, v101, v125
    v_add_f32 v102, v102, v126
    v_add_f32 v103, v103, v127
    v_add_f32 v104, v104, v128
    v_add_f32 v105, v105, v129
    v_add_f32 v106, v106, v130
    v_add_f32 v107, v107, v131
    v_add_f32 v108, v108, v132
    v_add_f32 v109, v109, v133
    v_add_f32 v110, v110, v134
    v_add_f32 v111, v111, v135
    v_add_f32 v112, v112, v136
    v_add_f32 v113, v113, v137
    v_add_f32 v114, v114, v138
    v_add_f32 v115, v115, v139
    v_add_f32 v116, v116, v140
    v_add_f32 v117, v117, v141
    v_add_f32 v118, v118, v142
    v_add_f32 v119, v119, v143
    v_add_f32 v120, v120, v144
    v_add_f32 v121, v121, v145
    v_add_f32 v122, v122, v146
    v_add_f32 v123, v123, v147
    v_add_f32 v100, v100, v148
    v_add_f32 v101, v101, v149
    v_add_f32 v102, v102, v150
    v_add_f32 v103, v103, v151
    v_add_f32 v104, v104, v152
    v_add_f32 v105, v105, v153
    v_add_f32 v106, v106, v154
    v_add_f32 v107, v107, v155
    v_add_f32 v108, v108, v156
    v_add_f32 v109, v109, v157
    v_add_f32 v110, v110, v158
    v_add_f32 v111, v111, v159
    v_add_f32 v112, v112, v160
    v_add_f32 v113, v113, v161
    v_add_f32 v114, v114, v162
    v_add_f32 v115, v115, v163
    v_add_f32 v116, v116, v164
    v_add_f32 v117, v117, v165
    v_add_f32 v118, v118, v166
    v_add_f32 v119, v119, v167
    v_add_f32 v120, v120, v168
    v_add_f32 v121, v121, v169
    v_add_f32 v122, v122, v170
    v_add_f32 v123, v123, v171
    v_add_f32 v100, v100, v172
    v_add_f32 v101, v101, v173
    v_add_f32 v102, v102, v174
    v_add_f32 v103, v103, v175
    v_add_f32 v104, v104, v176
    v_add_f32 v105, v105, v177
    v_add_f32 v106, v106, v178
    v_add_f32 v107, v107, v179
    v_add_f32 v108, v108, v180
    v_add_f32 v109, v109, v181
    v_add_f32 v110, v110, v182
    v_add_f32 v111, v111, v183
    v_add_f32 v112, v112, v184
    v_add_f32 v113, v113, v185
    v_add_f32 v114, v114, v186
    v_add_f32 v115, v115, v187
    v_add_f32 v116, v116, v188
    v_add_f32 v117, v117, v189
    v_add_f32 v118, v118, v190
    v_add_f32 v119, v119, v191
    v_add_f32 v120, v120, v192
    v_add_f32 v121, v121, v193
    v_add_f32 v122, v122, v194
    v_add_f32 v123, v123, v195
    v_sub_f32 v216, 1.0, v214
    v_sub_f32 v217, 1.0, v215
    v_cvt_pk_bf16_f32 v218, v216, v217
    v_lshlrev_b32 v216, 16, v218
    v_and_b32 v217, 0xffff0000, v218
    s_mov_b32 s60, s30
    s_mov_b32 s61, s31
    s_mov_b32 s62, 0x240000
    s_mov_b32 s63, 0x00020000
    v_lshlrev_b32 v220, 16, v200
    v_and_b32 v221, 0xffff0000, v200
    v_lshlrev_b32 v222, 16, v201
    v_and_b32 v223, 0xffff0000, v201
    v_cvt_pk_bf16_f32 v218, v100, v101
    v_lshlrev_b32 v100, 16, v218
    v_and_b32 v101, 0xffff0000, v218
    v_mul_f32 v100, v100, v214
    v_mul_f32 v220, v220, v216
    v_mul_f32 v101, v101, v214
    v_mul_f32 v221, v221, v216
    v_cvt_pk_bf16_f32 v218, v100, v101
    v_lshlrev_b32 v100, 16, v218
    v_and_b32 v101, 0xffff0000, v218
    v_cvt_pk_bf16_f32 v218, v220, v221
    v_lshlrev_b32 v220, 16, v218
    v_and_b32 v221, 0xffff0000, v218
    v_add_f32 v100, v100, v220
    v_add_f32 v101, v101, v221
    v_cvt_pk_bf16_f32 v218, v102, v103
    v_lshlrev_b32 v102, 16, v218
    v_and_b32 v103, 0xffff0000, v218
    v_mul_f32 v102, v102, v214
    v_mul_f32 v222, v222, v216
    v_mul_f32 v103, v103, v214
    v_mul_f32 v223, v223, v216
    v_cvt_pk_bf16_f32 v218, v102, v103
    v_lshlrev_b32 v102, 16, v218
    v_and_b32 v103, 0xffff0000, v218
    v_cvt_pk_bf16_f32 v218, v222, v223
    v_lshlrev_b32 v222, 16, v218
    v_and_b32 v223, 0xffff0000, v218
    v_add_f32 v102, v102, v222
    v_add_f32 v103, v103, v223
    v_cvt_pk_bf16_f32 v100, v100, v101
    v_cvt_pk_bf16_f32 v101, v102, v103
    buffer_store_dwordx2 v[100:101], v5, s[60:63], s39 offen offset:0
    v_lshlrev_b32 v220, 16, v202
    v_and_b32 v221, 0xffff0000, v202
    v_lshlrev_b32 v222, 16, v203
    v_and_b32 v223, 0xffff0000, v203
    v_cvt_pk_bf16_f32 v218, v104, v105
    v_lshlrev_b32 v104, 16, v218
    v_and_b32 v105, 0xffff0000, v218
    v_mul_f32 v104, v104, v214
    v_mul_f32 v220, v220, v216
    v_mul_f32 v105, v105, v214
    v_mul_f32 v221, v221, v216
    v_cvt_pk_bf16_f32 v218, v104, v105
    v_lshlrev_b32 v104, 16, v218
    v_and_b32 v105, 0xffff0000, v218
    v_cvt_pk_bf16_f32 v218, v220, v221
    v_lshlrev_b32 v220, 16, v218
    v_and_b32 v221, 0xffff0000, v218
    v_add_f32 v104, v104, v220
    v_add_f32 v105, v105, v221
    v_cvt_pk_bf16_f32 v218, v106, v107
    v_lshlrev_b32 v106, 16, v218
    v_and_b32 v107, 0xffff0000, v218
    v_mul_f32 v106, v106, v214
    v_mul_f32 v222, v222, v216
    v_mul_f32 v107, v107, v214
    v_mul_f32 v223, v223, v216
    v_cvt_pk_bf16_f32 v218, v106, v107
    v_lshlrev_b32 v106, 16, v218
    v_and_b32 v107, 0xffff0000, v218
    v_cvt_pk_bf16_f32 v218, v222, v223
    v_lshlrev_b32 v222, 16, v218
    v_and_b32 v223, 0xffff0000, v218
    v_add_f32 v106, v106, v222
    v_add_f32 v107, v107, v223
    v_cvt_pk_bf16_f32 v104, v104, v105
    v_cvt_pk_bf16_f32 v105, v106, v107
    buffer_store_dwordx2 v[104:105], v5, s[60:63], s39 offen offset:32
    v_lshlrev_b32 v220, 16, v204
    v_and_b32 v221, 0xffff0000, v204
    v_lshlrev_b32 v222, 16, v205
    v_and_b32 v223, 0xffff0000, v205
    v_cvt_pk_bf16_f32 v218, v108, v109
    v_lshlrev_b32 v108, 16, v218
    v_and_b32 v109, 0xffff0000, v218
    v_mul_f32 v108, v108, v214
    v_mul_f32 v220, v220, v216
    v_mul_f32 v109, v109, v214
    v_mul_f32 v221, v221, v216
    v_cvt_pk_bf16_f32 v218, v108, v109
    v_lshlrev_b32 v108, 16, v218
    v_and_b32 v109, 0xffff0000, v218
    v_cvt_pk_bf16_f32 v218, v220, v221
    v_lshlrev_b32 v220, 16, v218
    v_and_b32 v221, 0xffff0000, v218
    v_add_f32 v108, v108, v220
    v_add_f32 v109, v109, v221
    v_cvt_pk_bf16_f32 v218, v110, v111
    v_lshlrev_b32 v110, 16, v218
    v_and_b32 v111, 0xffff0000, v218
    v_mul_f32 v110, v110, v214
    v_mul_f32 v222, v222, v216
    v_mul_f32 v111, v111, v214
    v_mul_f32 v223, v223, v216
    v_cvt_pk_bf16_f32 v218, v110, v111
    v_lshlrev_b32 v110, 16, v218
    v_and_b32 v111, 0xffff0000, v218
    v_cvt_pk_bf16_f32 v218, v222, v223
    v_lshlrev_b32 v222, 16, v218
    v_and_b32 v223, 0xffff0000, v218
    v_add_f32 v110, v110, v222
    v_add_f32 v111, v111, v223
    v_cvt_pk_bf16_f32 v108, v108, v109
    v_cvt_pk_bf16_f32 v109, v110, v111
    buffer_store_dwordx2 v[108:109], v5, s[60:63], s39 offen offset:64
    v_lshlrev_b32 v220, 16, v206
    v_and_b32 v221, 0xffff0000, v206
    v_lshlrev_b32 v222, 16, v207
    v_and_b32 v223, 0xffff0000, v207
    v_cvt_pk_bf16_f32 v218, v112, v113
    v_lshlrev_b32 v112, 16, v218
    v_and_b32 v113, 0xffff0000, v218
    v_mul_f32 v112, v112, v215
    v_mul_f32 v220, v220, v217
    v_mul_f32 v113, v113, v215
    v_mul_f32 v221, v221, v217
    v_cvt_pk_bf16_f32 v218, v112, v113
    v_lshlrev_b32 v112, 16, v218
    v_and_b32 v113, 0xffff0000, v218
    v_cvt_pk_bf16_f32 v218, v220, v221
    v_lshlrev_b32 v220, 16, v218
    v_and_b32 v221, 0xffff0000, v218
    v_add_f32 v112, v112, v220
    v_add_f32 v113, v113, v221
    v_cvt_pk_bf16_f32 v218, v114, v115
    v_lshlrev_b32 v114, 16, v218
    v_and_b32 v115, 0xffff0000, v218
    v_mul_f32 v114, v114, v215
    v_mul_f32 v222, v222, v217
    v_mul_f32 v115, v115, v215
    v_mul_f32 v223, v223, v217
    v_cvt_pk_bf16_f32 v218, v114, v115
    v_lshlrev_b32 v114, 16, v218
    v_and_b32 v115, 0xffff0000, v218
    v_cvt_pk_bf16_f32 v218, v222, v223
    v_lshlrev_b32 v222, 16, v218
    v_and_b32 v223, 0xffff0000, v218
    v_add_f32 v114, v114, v222
    v_add_f32 v115, v115, v223
    v_cvt_pk_bf16_f32 v112, v112, v113
    v_cvt_pk_bf16_f32 v113, v114, v115
    buffer_store_dwordx2 v[112:113], v5, s[60:63], s58 offen offset:0
    v_lshlrev_b32 v220, 16, v208
    v_and_b32 v221, 0xffff0000, v208
    v_lshlrev_b32 v222, 16, v209
    v_and_b32 v223, 0xffff0000, v209
    v_cvt_pk_bf16_f32 v218, v116, v117
    v_lshlrev_b32 v116, 16, v218
    v_and_b32 v117, 0xffff0000, v218
    v_mul_f32 v116, v116, v215
    v_mul_f32 v220, v220, v217
    v_mul_f32 v117, v117, v215
    v_mul_f32 v221, v221, v217
    v_cvt_pk_bf16_f32 v218, v116, v117
    v_lshlrev_b32 v116, 16, v218
    v_and_b32 v117, 0xffff0000, v218
    v_cvt_pk_bf16_f32 v218, v220, v221
    v_lshlrev_b32 v220, 16, v218
    v_and_b32 v221, 0xffff0000, v218
    v_add_f32 v116, v116, v220
    v_add_f32 v117, v117, v221
    v_cvt_pk_bf16_f32 v218, v118, v119
    v_lshlrev_b32 v118, 16, v218
    v_and_b32 v119, 0xffff0000, v218
    v_mul_f32 v118, v118, v215
    v_mul_f32 v222, v222, v217
    v_mul_f32 v119, v119, v215
    v_mul_f32 v223, v223, v217
    v_cvt_pk_bf16_f32 v218, v118, v119
    v_lshlrev_b32 v118, 16, v218
    v_and_b32 v119, 0xffff0000, v218
    v_cvt_pk_bf16_f32 v218, v222, v223
    v_lshlrev_b32 v222, 16, v218
    v_and_b32 v223, 0xffff0000, v218
    v_add_f32 v118, v118, v222
    v_add_f32 v119, v119, v223
    v_cvt_pk_bf16_f32 v116, v116, v117
    v_cvt_pk_bf16_f32 v117, v118, v119
    buffer_store_dwordx2 v[116:117], v5, s[60:63], s58 offen offset:32
    v_lshlrev_b32 v220, 16, v210
    v_and_b32 v221, 0xffff0000, v210
    v_lshlrev_b32 v222, 16, v211
    v_and_b32 v223, 0xffff0000, v211
    v_cvt_pk_bf16_f32 v218, v120, v121
    v_lshlrev_b32 v120, 16, v218
    v_and_b32 v121, 0xffff0000, v218
    v_mul_f32 v120, v120, v215
    v_mul_f32 v220, v220, v217
    v_mul_f32 v121, v121, v215
    v_mul_f32 v221, v221, v217
    v_cvt_pk_bf16_f32 v218, v120, v121
    v_lshlrev_b32 v120, 16, v218
    v_and_b32 v121, 0xffff0000, v218
    v_cvt_pk_bf16_f32 v218, v220, v221
    v_lshlrev_b32 v220, 16, v218
    v_and_b32 v221, 0xffff0000, v218
    v_add_f32 v120, v120, v220
    v_add_f32 v121, v121, v221
    v_cvt_pk_bf16_f32 v218, v122, v123
    v_lshlrev_b32 v122, 16, v218
    v_and_b32 v123, 0xffff0000, v218
    v_mul_f32 v122, v122, v215
    v_mul_f32 v222, v222, v217
    v_mul_f32 v123, v123, v215
    v_mul_f32 v223, v223, v217
    v_cvt_pk_bf16_f32 v218, v122, v123
    v_lshlrev_b32 v122, 16, v218
    v_and_b32 v123, 0xffff0000, v218
    v_cvt_pk_bf16_f32 v218, v222, v223
    v_lshlrev_b32 v222, 16, v218
    v_and_b32 v223, 0xffff0000, v218
    v_add_f32 v122, v122, v222
    v_add_f32 v123, v123, v223
    v_cvt_pk_bf16_f32 v120, v120, v121
    v_cvt_pk_bf16_f32 v121, v122, v123
    buffer_store_dwordx2 v[120:121], v5, s[60:63], s58 offen offset:64
KF_next:
    s_barrier
    s_cmp_lg_u32 s4, 0
    s_cbranch_scc1 KQ_wF
    s_mov_b32 exec_lo, 1
    s_mov_b32 exec_hi, 0
    v_mov_b32 v2, 52
    v_mov_b32 v3, 1
    global_atomic_add v4, v2, v3, s[32:33] sc0
    s_waitcnt vmcnt(0)
    v_mov_b32 v2, 0
    ds_write_b32 v2, v4 offset:16
    s_mov_b64 exec, -1
    s_waitcnt lgkmcnt(0)
KQ_wF:
    s_barrier
    v_mov_b32 v2, 0
    ds_read_b32 v3, v2 offset:16
    s_waitcnt lgkmcnt(0)
    v_readfirstlane_b32 s89, v3
    s_branch KF_loop
KG_start:
    s_sub_u32 s89, s89, 720
KG_loop:
    s_cmp_ge_u32 s89, 192
    s_cbranch_scc1 KM_done
    s_mul_hi_u32 s37, s89, 0x5555556
    s_mul_i32 s39, s37, 48
    s_sub_u32 s39, s89, s39
    s_mul_i32 s36, s39, 43
    s_lshr_b32 s36, s36, 8
    s_mul_i32 s38, s36, 6
    s_sub_u32 s38, s39, s38
    s_mul_i32 s56, s37, 6
    s_add_u32 s56, s56, s38
    s_add_u32 s37, s37, 60
    s_mul_i32 s39, s37, 262144
    s_mul_i32 s52, s36, 1024
    s_add_u32 s39, s39, s52
    s_add_u32 s39, s39, 0x4400000
    s_add_u32 s40, s34, s39
    s_addc_u32 s41, s35, 0
    s_mov_b32 s42, 254976
    s_mov_b32 s43, 0x00020000
    s_mul_i32 s39, s36, 589824
    s_mul_i32 s52, s38, 192
    s_add_u32 s39, s39, s52
    s_add_u32 s44, s18, s39
    s_addc_u32 s45, s19, 0
    s_sub_u32 s46, 4718592, s39
    s_mov_b32 s47, 0x00020000
    v_add_u32 v1, 0, v0
    v_mul_u32_u24 v2, 87382, v1
    v_lshrrev_b32 v2, 20, v2
    v_mul_u32_u24 v3, 12, v2
    v_sub_u32 v1, v1, v3
    v_mul_u32_u24 v8, 1152, v2
    v_lshl_add_u32 v8, v1, 4, v8
    v_mul_u32_u24 v11, 224, v2
    v_lshl_add_u32 v11, v1, 4, v11
    v_add_u32 v14, 57344, v11
    v_add_u32 v1, 256, v0
    v_mul_u32_u24 v2, 87382, v1
    v_lshrrev_b32 v2, 20, v2
    v_mul_u32_u24 v3, 12, v2
    v_sub_u32 v1, v1, v3
    v_mul_u32_u24 v9, 1152, v2
    v_lshl_add_u32 v9, v1, 4, v9
    v_mul_u32_u24 v12, 224, v2
    v_lshl_add_u32 v12, v1, 4, v12
    v_add_u32 v15, 57344, v12
    v_add_u32 v1, 512, v0
    v_mul_u32_u24 v2, 87382, v1
    v_lshrrev_b32 v2, 20, v2
    v_mul_u32_u24 v3, 12, v2
    v_sub_u32 v1, v1, v3
    v_mul_u32_u24 v10, 1152, v2
    v_lshl_add_u32 v10, v1, 4, v10
    v_mul_u32_u24 v13, 224, v2
    v_lshl_add_u32 v13, v1, 4, v13
    v_add_u32 v16, 57344, v13
    s_mov_b32 s39, 0
    buffer_load_dwordx4 v[32:35], v8, s[44:47], s39 offen
    s_mov_b32 s39, 0
    buffer_load_dwordx4 v[36:39], v9, s[44:47], s39 offen
    s_mov_b32 s39, 0
    buffer_load_dwordx4 v[40:43], v10, s[44:47], s39 offen
    s_mov_b32 s39, 73728
    buffer_load_dwordx4 v[44:47], v8, s[44:47], s39 offen
    s_mov_b32 s39, 73728
    buffer_load_dwordx4 v[48:51], v9, s[44:47], s39 offen
    s_mov_b32 s39, 73728
    buffer_load_dwordx4 v[52:55], v10, s[44:47], s39 offen
    s_mov_b32 s39, 147456
    buffer_load_dwordx4 v[56:59], v8, s[44:47], s39 offen
    s_mov_b32 s39, 147456
    buffer_load_dwordx4 v[60:63], v9, s[44:47], s39 offen
    s_mov_b32 s39, 147456
    buffer_load_dwordx4 v[64:67], v10, s[44:47], s39 offen
    s_mov_b32 s39, 221184
    buffer_load_dwordx4 v[68:71], v8, s[44:47], s39 offen
    s_mov_b32 s39, 221184
    buffer_load_dwordx4 v[72:75], v9, s[44:47], s39 offen
    s_mov_b32 s39, 221184
    buffer_load_dwordx4 v[76:79], v10, s[44:47], s39 offen
    s_mov_b32 s39, 294912
    buffer_load_dwordx4 v[80:83], v8, s[44:47], s39 offen
    s_mov_b32 s39, 294912
    buffer_load_dwordx4 v[84:87], v9, s[44:47], s39 offen
    s_mov_b32 s39, 294912
    buffer_load_dwordx4 v[88:91], v10, s[44:47], s39 offen
    s_mov_b32 s39, 368640
    buffer_load_dwordx4 v[92:95], v8, s[44:47], s39 offen
    s_mov_b32 s39, 368640
    buffer_load_dwordx4 v[96:99], v9, s[44:47], s39 offen
    s_mov_b32 s39, 368640
    buffer_load_dwordx4 v[100:103], v10, s[44:47], s39 offen
    s_mov_b32 s39, 442368
    buffer_load_dwordx4 v[104:107], v8, s[44:47], s39 offen
    s_mov_b32 s39, 442368
    buffer_load_dwordx4 v[108:111], v9, s[44:47], s39 offen
    s_mov_b32 s39, 442368
    buffer_load_dwordx4 v[112:115], v10, s[44:47], s39 offen
    s_mov_b32 s39, 516096
    buffer_load_dwordx4 v[116:119], v8, s[44:47], s39 offen
    s_mov_b32 s39, 516096
    buffer_load_dwordx4 v[120:123], v9, s[44:47], s39 offen
    s_mov_b32 s39, 516096
    buffer_load_dwordx4 v[124:127], v10, s[44:47], s39 offen
    s_barrier
    s_waitcnt vmcnt(0)
    ds_write_b128 v11, v[32:35] offset:0
    ds_write_b128 v12, v[36:39] offset:0
    ds_write_b128 v13, v[40:43] offset:0
    ds_write_b128 v11, v[44:47] offset:14336
    ds_write_b128 v12, v[48:51] offset:14336
    ds_write_b128 v13, v[52:55] offset:14336
    ds_write_b128 v11, v[56:59] offset:28672
    ds_write_b128 v12, v[60:63] offset:28672
    ds_write_b128 v13, v[64:67] offset:28672
    ds_write_b128 v11, v[68:71] offset:43008
    ds_write_b128 v12, v[72:75] offset:43008
    ds_write_b128 v13, v[76:79] offset:43008
    ds_write_b128 v14, v[80:83] offset:0
    ds_write_b128 v15, v[84:87] offset:0
    ds_write_b128 v16, v[88:91] offset:0
    ds_write_b128 v14, v[92:95] offset:14336
    ds_write_b128 v15, v[96:99] offset:14336
    ds_write_b128 v16, v[100:103] offset:14336
    ds_write_b128 v14, v[104:107] offset:28672
    ds_write_b128 v15, v[108:111] offset:28672
    ds_write_b128 v16, v[112:115] offset:28672
    ds_write_b128 v14, v[116:119] offset:43008
    ds_write_b128 v15, v[120:123] offset:43008
    ds_write_b128 v16, v[124:127] offset:43008
    v_and_b32 v1, 63, v0
    v_lshrrev_b32 v2, 4, v1
    v_and_b32 v3, 15, v1
    v_lshrrev_b32 v17, 7, v0
    v_lshl_add_u32 v17, v17, 4, v3
    v_lshlrev_b32 v17, 13, v17
    v_lshl_add_u32 v17, v2, 3, v17
    v_lshlrev_b32 v18, 2, v2
    v_bfe_u32 v19, v1, 2, 2
    v_add_u32 v18, v18, v19
    v_mul_u32_u24 v18, 224, v18
    v_bfe_u32 v19, v0, 6, 1
    v_mul_u32_u24 v19, 96, v19
    v_add_u32 v18, v18, v19
    v_and_b32 v19, 3, v1
    v_lshl_add_u32 v18, v19, 3, v18
    v_add_u32 v19, 57344, v18
    s_waitcnt lgkmcnt(0)
    s_barrier
    s_mul_i32 s39, s37, 8
    s_mul_i32 s52, s36, 1
    s_add_u32 s39, s39, s52
    s_lshl_b32 s39, s39, 2
    s_add_u32 s39, s39, 0x5800400
    v_mov_b32 v2, s39
    s_mov_b32 s6, 0
KG_spin:
    global_load_dword v4, v2, s[34:35] sc1
    s_add_u32 s6, s6, 1
    s_waitcnt vmcnt(0)
    s_nop 0
    v_readfirstlane_b32 s7, v4
    s_cmp_ge_u32 s6, 0x200000
    s_cbranch_scc1 KG_go
    s_cmp_ge_u32 s7, 4
    s_cbranch_scc1 KG_go
    s_sleep 4
    s_branch KG_spin
KG_go:
    buffer_load_dwordx2 v[32:33], v17, s[40:43], 0 offen offset:0 sc1
    buffer_load_dwordx2 v[34:35], v17, s[40:43], 0 offen offset:32 sc1
    buffer_load_dwordx2 v[36:37], v17, s[40:43], 0 offen offset:64 sc1
    buffer_load_dwordx2 v[38:39], v17, s[40:43], 0 offen offset:96 sc1
    buffer_load_dwordx2 v[40:41], v17, s[40:43], 0 offen offset:128 sc1
    buffer_load_dwordx2 v[42:43], v17, s[40:43], 0 offen offset:160 sc1
    buffer_load_dwordx2 v[44:45], v17, s[40:43], 0 offen offset:192 sc1
    buffer_load_dwordx2 v[46:47], v17, s[40:43], 0 offen offset:224 sc1
    buffer_load_dwordx2 v[48:49], v17, s[40:43], 0 offen offset:256 sc1
    buffer_load_dwordx2 v[50:51], v17, s[40:43], 0 offen offset:288 sc1
    buffer_load_dwordx2 v[52:53], v17, s[40:43], 0 offen offset:320 sc1
    buffer_load_dwordx2 v[54:55], v17, s[40:43], 0 offen offset:352 sc1
    buffer_load_dwordx2 v[56:57], v17, s[40:43], 0 offen offset:384 sc1
    buffer_load_dwordx2 v[58:59], v17, s[40:43], 0 offen offset:416 sc1
    buffer_load_dwordx2 v[60:61], v17, s[40:43], 0 offen offset:448 sc1
    buffer_load_dwordx2 v[62:63], v17, s[40:43], 0 offen offset:480 sc1
    buffer_load_dwordx2 v[64:65], v17, s[40:43], 0 offen offset:512 sc1
    buffer_load_dwordx2 v[66:67], v17, s[40:43], 0 offen offset:544 sc1
    buffer_load_dwordx2 v[68:69], v17, s[40:43], 0 offen offset:576 sc1
    buffer_load_dwordx2 v[70:71], v17, s[40:43], 0 offen offset:608 sc1
    buffer_load_dwordx2 v[72:73], v17, s[40:43], 0 offen offset:640 sc1
    buffer_load_dwordx2 v[74:75], v17, s[40:43], 0 offen offset:672 sc1
    buffer_load_dwordx2 v[76:77], v17, s[40:43], 0 offen offset:704 sc1
    buffer_load_dwordx2 v[78:79], v17, s[40:43], 0 offen offset:736 sc1
    buffer_load_dwordx2 v[80:81], v17, s[40:43], 0 offen offset:768 sc1
    buffer_load_dwordx2 v[82:83], v17, s[40:43], 0 offen offset:800 sc1
    buffer_load_dwordx2 v[84:85], v17, s[40:43], 0 offen offset:832 sc1
    buffer_load_dwordx2 v[86:87], v17, s[40:43], 0 offen offset:864 sc1
    buffer_load_dwordx2 v[88:89], v17, s[40:43], 0 offen offset:896 sc1
    buffer_load_dwordx2 v[90:91], v17, s[40:43], 0 offen offset:928 sc1
    buffer_load_dwordx2 v[92:93], v17, s[40:43], 0 offen offset:960 sc1
    buffer_load_dwordx2 v[94:95], v17, s[40:43], 0 offen offset:992 sc1
    ds_read_b64_tr_b16 v[140:141], v18 offset:0
    ds_read_b64_tr_b16 v[142:143], v18 offset:3584
    ds_read_b64_tr_b16 v[144:145], v18 offset:32
    ds_read_b64_tr_b16 v[146:147], v18 offset:3616
    ds_read_b64_tr_b16 v[148:149], v18 offset:64
    ds_read_b64_tr_b16 v[150:151], v18 offset:3648
    ds_read_b64_tr_b16 v[152:153], v18 offset:7168
    ds_read_b64_tr_b16 v[154:155], v18 offset:10752
    ds_read_b64_tr_b16 v[156:157], v18 offset:7200
    ds_read_b64_tr_b16 v[158:159], v18 offset:10784
    ds_read_b64_tr_b16 v[160:161], v18 offset:7232
    ds_read_b64_tr_b16 v[162:163], v18 offset:10816
    s_waitcnt vmcnt(30) lgkmcnt(6)
    v_mfma_f32_16x16x32_bf16 v[124:127], v[140:143], v[32:35], 0
    v_mfma_f32_16x16x32_bf16 v[128:131], v[144:147], v[32:35], 0
    v_mfma_f32_16x16x32_bf16 v[132:135], v[148:151], v[32:35], 0
    ds_read_b64_tr_b16 v[140:141], v18 offset:14336
    ds_read_b64_tr_b16 v[142:143], v18 offset:17920
    ds_read_b64_tr_b16 v[144:145], v18 offset:14368
    ds_read_b64_tr_b16 v[146:147], v18 offset:17952
    ds_read_b64_tr_b16 v[148:149], v18 offset:14400
    ds_read_b64_tr_b16 v[150:151], v18 offset:17984
    s_waitcnt vmcnt(28) lgkmcnt(6)
    v_mfma_f32_16x16x32_bf16 v[124:127], v[152:155], v[36:39], v[124:127]
    v_mfma_f32_16x16x32_bf16 v[128:131], v[156:159], v[36:39], v[128:131]
    v_mfma_f32_16x16x32_bf16 v[132:135], v[160:163], v[36:39], v[132:135]
    ds_read_b64_tr_b16 v[152:153], v18 offset:21504
    ds_read_b64_tr_b16 v[154:155], v18 offset:25088
    ds_read_b64_tr_b16 v[156:157], v18 offset:21536
    ds_read_b64_tr_b16 v[158:159], v18 offset:25120
    ds_read_b64_tr_b16 v[160:161], v18 offset:21568
    ds_read_b64_tr_b16 v[162:163], v18 offset:25152
    s_waitcnt vmcnt(26) lgkmcnt(6)
    v_mfma_f32_16x16x32_bf16 v[124:127], v[140:143], v[40:43], v[124:127]
    v_mfma_f32_16x16x32_bf16 v[128:131], v[144:147], v[40:43], v[128:131]
    v_mfma_f32_16x16x32_bf16 v[132:135], v[148:151], v[40:43], v[132:135]
    ds_read_b64_tr_b16 v[140:141], v18 offset:28672
    ds_read_b64_tr_b16 v[142:143], v18 offset:32256
    ds_read_b64_tr_b16 v[144:145], v18 offset:28704
    ds_read_b64_tr_b16 v[146:147], v18 offset:32288
    ds_read_b64_tr_b16 v[148:149], v18 offset:28736
    ds_read_b64_tr_b16 v[150:151], v18 offset:32320
    s_waitcnt vmcnt(24) lgkmcnt(6)
    v_mfma_f32_16x16x32_bf16 v[124:127], v[152:155], v[44:47], v[124:127]
    v_mfma_f32_16x16x32_bf16 v[128:131], v[156:159], v[44:47], v[128:131]
    v_mfma_f32_16x16x32_bf16 v[132:135], v[160:163], v[44:47], v[132:135]
    ds_read_b64_tr_b16 v[152:153], v18 offset:35840
    ds_read_b64_tr_b16 v[154:155], v18 offset:39424
    ds_read_b64_tr_b16 v[156:157], v18 offset:35872
    ds_read_b64_tr_b16 v[158:159], v18 offset:39456
    ds_read_b64_tr_b16 v[160:161], v18 offset:35904
    ds_read_b64_tr_b16 v[162:163], v18 offset:39488
    s_waitcnt vmcnt(22) lgkmcnt(6)
    v_mfma_f32_16x16x32_bf16 v[124:127], v[140:143], v[48:51], v[124:127]
    v_mfma_f32_16x16x32_bf16 v[128:131], v[144:147], v[48:51], v[128:131]
    v_mfma_f32_16x16x32_bf16 v[132:135], v[148:151], v[48:51], v[132:135]
    ds_read_b64_tr_b16 v[140:141], v18 offset:43008
    ds_read_b64_tr_b16 v[142:143], v18 offset:46592
    ds_read_b64_tr_b16 v[144:145], v18 offset:43040
    ds_read_b64_tr_b16 v[146:147], v18 offset:46624
    ds_read_b64_tr_b16 v[148:149], v18 offset:43072
    ds_read_b64_tr_b16 v[150:151], v18 offset:46656
    s_waitcnt vmcnt(20) lgkmcnt(6)
    v_mfma_f32_16x16x32_bf16 v[124:127], v[152:155], v[52:55], v[124:127]
    v_mfma_f32_16x16x32_bf16 v[128:131], v[156:159], v[52:55], v[128:131]
    v_mfma_f32_16x16x32_bf16 v[132:135], v[160:163], v[52:55], v[132:135]
    ds_read_b64_tr_b16 v[152:153], v18 offset:50176
    ds_read_b64_tr_b16 v[154:155], v18 offset:53760
    ds_read_b64_tr_b16 v[156:157], v18 offset:50208
    ds_read_b64_tr_b16 v[158:159], v18 offset:53792
    ds_read_b64_tr_b16 v[160:161], v18 offset:50240
    ds_read_b64_tr_b16 v[162:163], v18 offset:53824
    s_waitcnt vmcnt(18) lgkmcnt(6)
    v_mfma_f32_16x16x32_bf16 v[124:127], v[140:143], v[56:59], v[124:127]
    v_mfma_f32_16x16x32_bf16 v[128:131], v[144:147], v[56:59], v[128:131]
    v_mfma_f32_16x16x32_bf16 v[132:135], v[148:151], v[56:59], v[132:135]
    ds_read_b64_tr_b16 v[140:141], v19 offset:0
    ds_read_b64_tr_b16 v[142:143], v19 offset:3584
    ds_read_b64_tr_b16 v[144:145], v19 offset:32
    ds_read_b64_tr_b16 v[146:147], v19 offset:3616
    ds_read_b64_tr_b16 v[148:149], v19 offset:64
    ds_read_b64_tr_b16 v[150:151], v19 offset:3648
    s_waitcnt vmcnt(16) lgkmcnt(6)
    v_mfma_f32_16x16x32_bf16 v[124:127], v[152:155], v[60:63], v[124:127]
    v_mfma_f32_16x16x32_bf16 v[128:131], v[156:159], v[60:63], v[128:131]
    v_mfma_f32_16x16x32_bf16 v[132:135], v[160:163], v[60:63], v[132:135]
    ds_read_b64_tr_b16 v[152:153], v19 offset:7168
    ds_read_b64_tr_b16 v[154:155], v19 offset:10752
    ds_read_b64_tr_b16 v[156:157], v19 offset:7200
    ds_read_b64_tr_b16 v[158:159], v19 offset:10784
    ds_read_b64_tr_b16 v[160:161], v19 offset:7232
    ds_read_b64_tr_b16 v[162:163], v19 offset:10816
    s_waitcnt vmcnt(14) lgkmcnt(6)
    v_mfma_f32_16x16x32_bf16 v[124:127], v[140:143], v[64:67], v[124:127]
    v_mfma_f32_16x16x32_bf16 v[128:131], v[144:147], v[64:67], v[128:131]
    v_mfma_f32_16x16x32_bf16 v[132:135], v[148:151], v[64:67], v[132:135]
    ds_read_b64_tr_b16 v[140:141], v19 offset:14336
    ds_read_b64_tr_b16 v[142:143], v19 offset:17920
    ds_read_b64_tr_b16 v[144:145], v19 offset:14368
    ds_read_b64_tr_b16 v[146:147], v19 offset:17952
    ds_read_b64_tr_b16 v[148:149], v19 offset:14400
    ds_read_b64_tr_b16 v[150:151], v19 offset:17984
    s_waitcnt vmcnt(12) lgkmcnt(6)
    v_mfma_f32_16x16x32_bf16 v[124:127], v[152:155], v[68:71], v[124:127]
    v_mfma_f32_16x16x32_bf16 v[128:131], v[156:159], v[68:71], v[128:131]
    v_mfma_f32_16x16x32_bf16 v[132:135], v[160:163], v[68:71], v[132:135]
    ds_read_b64_tr_b16 v[152:153], v19 offset:21504
    ds_read_b64_tr_b16 v[154:155], v19 offset:25088
    ds_read_b64_tr_b16 v[156:157], v19 offset:21536
    ds_read_b64_tr_b16 v[158:159], v19 offset:25120
    ds_read_b64_tr_b16 v[160:161], v19 offset:21568
    ds_read_b64_tr_b16 v[162:163], v19 offset:25152
    s_waitcnt vmcnt(10) lgkmcnt(6)
    v_mfma_f32_16x16x32_bf16 v[124:127], v[140:143], v[72:75], v[124:127]
    v_mfma_f32_16x16x32_bf16 v[128:131], v[144:147], v[72:75], v[128:131]
    v_mfma_f32_16x16x32_bf16 v[132:135], v[148:151], v[72:75], v[132:135]
    ds_read_b64_tr_b16 v[140:141], v19 offset:28672
    ds_read_b64_tr_b16 v[142:143], v19 offset:32256
    ds_read_b64_tr_b16 v[144:145], v19 offset:28704
    ds_read_b64_tr_b16 v[146:147], v19 offset:32288
    ds_read_b64_tr_b16 v[148:149], v19 offset:28736
    ds_read_b64_tr_b16 v[150:151], v19 offset:32320
    s_waitcnt vmcnt(8) lgkmcnt(6)
    v_mfma_f32_16x16x32_bf16 v[124:127], v[152:155], v[76:79], v[124:127]
    v_mfma_f32_16x16x32_bf16 v[128:131], v[156:159], v[76:79], v[128:131]
    v_mfma_f32_16x16x32_bf16 v[132:135], v[160:163], v[76:79], v[132:135]
    ds_read_b64_tr_b16 v[152:153], v19 offset:35840
    ds_read_b64_tr_b16 v[154:155], v19 offset:39424
    ds_read_b64_tr_b16 v[156:157], v19 offset:35872
    ds_read_b64_tr_b16 v[158:159], v19 offset:39456
    ds_read_b64_tr_b16 v[160:161], v19 offset:35904
    ds_read_b64_tr_b16 v[162:163], v19 offset:39488
    s_waitcnt vmcnt(6) lgkmcnt(6)
    v_mfma_f32_16x16x32_bf16 v[124:127], v[140:143], v[80:83], v[124:127]
    v_mfma_f32_16x16x32_bf16 v[128:131], v[144:147], v[80:83], v[128:131]
    v_mfma_f32_16x16x32_bf16 v[132:135], v[148:151], v[80:83], v[132:135]
    ds_read_b64_tr_b16 v[140:141], v19 offset:43008
    ds_read_b64_tr_b16 v[142:143], v19 offset:46592
    ds_read_b64_tr_b16 v[144:145], v19 offset:43040
    ds_read_b64_tr_b16 v[146:147], v19 offset:46624
    ds_read_b64_tr_b16 v[148:149], v19 offset:43072
    ds_read_b64_tr_b16 v[150:151], v19 offset:46656
    s_waitcnt vmcnt(4) lgkmcnt(6)
    v_mfma_f32_16x16x32_bf16 v[124:127], v[152:155], v[84:87], v[124:127]
    v_mfma_f32_16x16x32_bf16 v[128:131], v[156:159], v[84:87], v[128:131]
    v_mfma_f32_16x16x32_bf16 v[132:135], v[160:163], v[84:87], v[132:135]
    ds_read_b64_tr_b16 v[152:153], v19 offset:50176
    ds_read_b64_tr_b16 v[154:155], v19 offset:53760
    ds_read_b64_tr_b16 v[156:157], v19 offset:50208
    ds_read_b64_tr_b16 v[158:159], v19 offset:53792
    ds_read_b64_tr_b16 v[160:161], v19 offset:50240
    ds_read_b64_tr_b16 v[162:163], v19 offset:53824
    s_waitcnt vmcnt(2) lgkmcnt(6)
    v_mfma_f32_16x16x32_bf16 v[124:127], v[140:143], v[88:91], v[124:127]
    v_mfma_f32_16x16x32_bf16 v[128:131], v[144:147], v[88:91], v[128:131]
    v_mfma_f32_16x16x32_bf16 v[132:135], v[148:151], v[88:91], v[132:135]
    s_waitcnt vmcnt(0) lgkmcnt(0)
    v_mfma_f32_16x16x32_bf16 v[124:127], v[152:155], v[92:95], v[124:127]
    v_mfma_f32_16x16x32_bf16 v[128:131], v[156:159], v[92:95], v[128:131]
    v_mfma_f32_16x16x32_bf16 v[132:135], v[160:163], v[92:95], v[132:135]
    s_nop 7
    s_nop 7
    s_mul_i32 s39, s56, 98304
    s_add_u32 s39, s39, 0x7400000
    s_add_u32 s52, s34, s39
    s_addc_u32 s53, s35, 0
    s_mov_b32 s54, 98304
    s_mov_b32 s55, 0x00020000
    v_lshlrev_b32 v1, 4, v0
    s_mul_i32 s57, s36, 12288
    buffer_store_dwordx4 v[124:127], v1, s[52:55], s57 offen sc1
    s_add_u32 s57, s57, 4096
    buffer_store_dwordx4 v[128:131], v1, s[52:55], s57 offen sc1
    s_add_u32 s57, s57, 4096
    buffer_store_dwordx4 v[132:135], v1, s[52:55], s57 offen sc1
    s_add_u32 s57, s57, 4096
    s_waitcnt vmcnt(0)
    s_barrier
    s_cmp_lg_u32 s4, 0
    s_cbranch_scc1 KG_w
    s_mov_b32 exec_lo, 1
    s_mov_b32 exec_hi, 0
    s_lshl_b32 s39, s56, 2
    s_add_u32 s39, s39, 0x5801400
    v_mov_b32 v2, s39
    v_mov_b32 v3, 1
    global_atomic_add v4, v2, v3, s[34:35] sc0
    s_waitcnt vmcnt(0)
    v_mov_b32 v2, 0
    ds_write_b32 v2, v4
    s_mov_b64 exec, -1
    s_waitcnt lgkmcnt(0)
KG_w:
    s_barrier
    v_mov_b32 v2, 0
    ds_read_b32 v3, v2
    s_waitcnt lgkmcnt(0)
    v_readfirstlane_b32 s7, v3
    s_cmp_lg_u32 s7, 7
    s_cbranch_scc1 KG_next
    s_mov_b32 s39, 0
    buffer_load_dwordx4 v[100:103], v1, s[52:55], s39 offen sc1
    s_mov_b32 s39, 4096
    buffer_load_dwordx4 v[104:107], v1, s[52:55], s39 offen sc1
    s_mov_b32 s39, 8192
    buffer_load_dwordx4 v[108:111], v1, s[52:55], s39 offen sc1
    s_mov_b32 s39, 12288
    buffer_load_dwordx4 v[112:115], v1, s[52:55], s39 offen sc1
    s_mov_b32 s39, 16384
    buffer_load_dwordx4 v[116:119], v1, s[52:55], s39 offen sc1
    s_mov_b32 s39, 20480
    buffer_load_dwordx4 v[120:123], v1, s[52:55], s39 offen sc1
    s_mov_b32 s39, 24576
    buffer_load_dwordx4 v[124:127], v1, s[52:55], s39 offen sc1
    s_mov_b32 s39, 28672
    buffer_load_dwordx4 v[128:131], v1, s[52:55], s39 offen sc1
    s_mov_b32 s39, 32768
    buffer_load_dwordx4 v[132:135], v1, s[52:55], s39 offen sc1
    s_mov_b32 s39, 36864
    buffer_load_dwordx4 v[136:139], v1, s[52:55], s39 offen sc1
    s_mov_b32 s39, 40960
    buffer_load_dwordx4 v[140:143], v1, s[52:55], s39 offen sc1
    s_mov_b32 s39, 45056
    buffer_load_dwordx4 v[144:147], v1, s[52:55], s39 offen sc1
    s_mov_b32 s39, 49152
    buffer_load_dwordx4 v[148:151], v1, s[52:55], s39 offen sc1
    s_mov_b32 s39, 53248
    buffer_load_dwordx4 v[152:155], v1, s[52:55], s39 offen sc1
    s_mov_b32 s39, 57344
    buffer_load_dwordx4 v[156:159], v1, s[52:55], s39 offen sc1
    s_mov_b32 s39, 61440
    buffer_load_dwordx4 v[160:163], v1, s[52:55], s39 offen sc1
    s_mov_b32 s39, 65536
    buffer_load_dwordx4 v[164:167], v1, s[52:55], s39 offen sc1
    s_mov_b32 s39, 69632
    buffer_load_dwordx4 v[168:171], v1, s[52:55], s39 offen sc1
    s_mov_b32 s39, 73728
    buffer_load_dwordx4 v[172:175], v1, s[52:55], s39 offen sc1
    s_mov_b32 s39, 77824
    buffer_load_dwordx4 v[176:179], v1, s[52:55], s39 offen sc1
    s_mov_b32 s39, 81920
    buffer_load_dwordx4 v[180:183], v1, s[52:55], s39 offen sc1
    s_mov_b32 s39, 86016
    buffer_load_dwordx4 v[184:187], v1, s[52:55], s39 offen sc1
    s_mov_b32 s39, 90112
    buffer_load_dwordx4 v[188:191], v1, s[52:55], s39 offen sc1
    s_mov_b32 s39, 94208
    buffer_load_dwordx4 v[192:195], v1, s[52:55], s39 offen sc1
    s_add_u32 s60, s34, 0x5a00000
    s_addc_u32 s61, s35, 0
    s_mov_b32 s62, 0x240000
    s_mov_b32 s63, 0x00020000
    s_add_u32 s64, s34, 0x5700000
    s_addc_u32 s65, s35, 0
    s_mov_b32 s66, 0x2000
    s_mov_b32 s67, 0x00020000
    v_lshrrev_b32 v2, 7, v0
    v_and_b32 v3, 15, v0
    v_mul_u32_u24 v2, 16, v2
    v_add_u32 v2, v2, v3
    v_bfe_u32 v3, v0, 6, 1
    v_bfe_u32 v4, v0, 4, 2
    v_mul_u32_u24 v5, 1152, v2
    v_mul_u32_u24 v6, 96, v3
    v_add_u32 v5, v5, v6
    v_lshl_add_u32 v5, v4, 3, v5
    s_mul_i32 s39, s37, 36864
    s_mul_i32 s57, s38, 192
    s_add_u32 s39, s39, s57
    s_add_u32 s58, s39, 18432
    buffer_load_dwordx2 v[200:201], v5, s[60:63], s39 offen offset:0 sc1
    buffer_load_dwordx2 v[202:203], v5, s[60:63], s39 offen offset:32 sc1
    buffer_load_dwordx2 v[204:205], v5, s[60:63], s39 offen offset:64 sc1
    v_lshlrev_b32 v6, 2, v2
    s_mul_i32 s57, s37, 128
    buffer_load_dword v214, v6, s[64:67], s57 offen sc1
    buffer_load_dword v215, v6, s[64:67], s57 offen offset:64 sc1
    s_waitcnt vmcnt(0)
    v_add_f32 v100, v100, v112
    v_add_f32 v101, v101, v113
    v_add_f32 v102, v102, v114
    v_add_f32 v103, v103, v115
    v_add_f32 v104, v104, v116
    v_add_f32 v105, v105, v117
    v_add_f32 v106, v106, v118
    v_add_f32 v107, v107, v119
    v_add_f32 v108, v108, v120
    v_add_f32 v109, v109, v121
    v_add_f32 v110, v110, v122
    v_add_f32 v111, v111, v123
    v_add_f32 v100, v100, v124
    v_add_f32 v101, v101, v125
    v_add_f32 v102, v102, v126
    v_add_f32 v103, v103, v127
    v_add_f32 v104, v104, v128
    v_add_f32 v105, v105, v129
    v_add_f32 v106, v106, v130
    v_add_f32 v107, v107, v131
    v_add_f32 v108, v108, v132
    v_add_f32 v109, v109, v133
    v_add_f32 v110, v110, v134
    v_add_f32 v111, v111, v135
    v_add_f32 v100, v100, v136
    v_add_f32 v101, v101, v137
    v_add_f32 v102, v102, v138
    v_add_f32 v103, v103, v139
    v_add_f32 v104, v104, v140
    v_add_f32 v105, v105, v141
    v_add_f32 v106, v106, v142
    v_add_f32 v107, v107, v143
    v_add_f32 v108, v108, v144
    v_add_f32 v109, v109, v145
    v_add_f32 v110, v110, v146
    v_add_f32 v111, v111, v147
    v_add_f32 v100, v100, v148
    v_add_f32 v101, v101, v149
    v_add_f32 v102, v102, v150
    v_add_f32 v103, v103, v151
    v_add_f32 v104, v104, v152
    v_add_f32 v105, v105, v153
    v_add_f32 v106, v106, v154
    v_add_f32 v107, v107, v155
    v_add_f32 v108, v108, v156
    v_add_f32 v109, v109, v157
    v_add_f32 v110, v110, v158
    v_add_f32 v111, v111, v159
    v_add_f32 v100, v100, v160
    v_add_f32 v101, v101, v161
    v_add_f32 v102, v102, v162
    v_add_f32 v103, v103, v163
    v_add_f32 v104, v104, v164
    v_add_f32 v105, v105, v165
    v_add_f32 v106, v106, v166
    v_add_f32 v107, v107, v167
    v_add_f32 v108, v108, v168
    v_add_f32 v109, v109, v169
    v_add_f32 v110, v110, v170
    v_add_f32 v111, v111, v171
    v_add_f32 v100, v100, v172
    v_add_f32 v101, v101, v173
    v_add_f32 v102, v102, v174
    v_add_f32 v103, v103, v175
    v_add_f32 v104, v104, v176
    v_add_f32 v105, v105, v177
    v_add_f32 v106, v106, v178
    v_add_f32 v107, v107, v179
    v_add_f32 v108, v108, v180
    v_add_f32 v109, v109, v181
    v_add_f32 v110, v110, v182
    v_add_f32 v111, v111, v183
    v_add_f32 v100, v100, v184
    v_add_f32 v101, v101, v185
    v_add_f32 v102, v102, v186
    v_add_f32 v103, v103, v187
    v_add_f32 v104, v104, v188
    v_add_f32 v105, v105, v189
    v_add_f32 v106, v106, v190
    v_add_f32 v107, v107, v191
    v_add_f32 v108, v108, v192
    v_add_f32 v109, v109, v193
    v_add_f32 v110, v110, v194
    v_add_f32 v111, v111, v195
    v_sub_f32 v216, 1.0, v214
    v_sub_f32 v217, 1.0, v215
    v_cvt_pk_bf16_f32 v218, v216, v217
    v_lshlrev_b32 v216, 16, v218
    v_and_b32 v217, 0xffff0000, v218
    s_mov_b32 s60, s30
    s_mov_b32 s61, s31
    s_mov_b32 s62, 0x240000
    s_mov_b32 s63, 0x00020000
    v_lshlrev_b32 v220, 16, v200
    v_and_b32 v221, 0xffff0000, v200
    v_lshlrev_b32 v222, 16, v201
    v_and_b32 v223, 0xffff0000, v201
    v_cvt_pk_bf16_f32 v218, v100, v101
    v_lshlrev_b32 v100, 16, v218
    v_and_b32 v101, 0xffff0000, v218
    v_mul_f32 v100, v100, v214
    v_mul_f32 v220, v220, v216
    v_mul_f32 v101, v101, v214
    v_mul_f32 v221, v221, v216
    v_cvt_pk_bf16_f32 v218, v100, v101
    v_lshlrev_b32 v100, 16, v218
    v_and_b32 v101, 0xffff0000, v218
    v_cvt_pk_bf16_f32 v218, v220, v221
    v_lshlrev_b32 v220, 16, v218
    v_and_b32 v221, 0xffff0000, v218
    v_add_f32 v100, v100, v220
    v_add_f32 v101, v101, v221
    v_cvt_pk_bf16_f32 v218, v102, v103
    v_lshlrev_b32 v102, 16, v218
    v_and_b32 v103, 0xffff0000, v218
    v_mul_f32 v102, v102, v214
    v_mul_f32 v222, v222, v216
    v_mul_f32 v103, v103, v214
    v_mul_f32 v223, v223, v216
    v_cvt_pk_bf16_f32 v218, v102, v103
    v_lshlrev_b32 v102, 16, v218
    v_and_b32 v103, 0xffff0000, v218
    v_cvt_pk_bf16_f32 v218, v222, v223
    v_lshlrev_b32 v222, 16, v218
    v_and_b32 v223, 0xffff0000, v218
    v_add_f32 v102, v102, v222
    v_add_f32 v103, v103, v223
    v_cvt_pk_bf16_f32 v100, v100, v101
    v_cvt_pk_bf16_f32 v101, v102, v103
    buffer_store_dwordx2 v[100:101], v5, s[60:63], s39 offen offset:0
    v_lshlrev_b32 v220, 16, v202
    v_and_b32 v221, 0xffff0000, v202
    v_lshlrev_b32 v222, 16, v203
    v_and_b32 v223, 0xffff0000, v203
    v_cvt_pk_bf16_f32 v218, v104, v105
    v_lshlrev_b32 v104, 16, v218
    v_and_b32 v105, 0xffff0000, v218
    v_mul_f32 v104, v104, v214
    v_mul_f32 v220, v220, v216
    v_mul_f32 v105, v105, v214
    v_mul_f32 v221, v221, v216
    v_cvt_pk_bf16_f32 v218, v104, v105
    v_lshlrev_b32 v104, 16, v218
    v_and_b32 v105, 0xffff0000, v218
    v_cvt_pk_bf16_f32 v218, v220, v221
    v_lshlrev_b32 v220, 16, v218
    v_and_b32 v221, 0xffff0000, v218
    v_add_f32 v104, v104, v220
    v_add_f32 v105, v105, v221
    v_cvt_pk_bf16_f32 v218, v106, v107
    v_lshlrev_b32 v106, 16, v218
    v_and_b32 v107, 0xffff0000, v218
    v_mul_f32 v106, v106, v214
    v_mul_f32 v222, v222, v216
    v_mul_f32 v107, v107, v214
    v_mul_f32 v223, v223, v216
    v_cvt_pk_bf16_f32 v218, v106, v107
    v_lshlrev_b32 v106, 16, v218
    v_and_b32 v107, 0xffff0000, v218
    v_cvt_pk_bf16_f32 v218, v222, v223
    v_lshlrev_b32 v222, 16, v218
    v_and_b32 v223, 0xffff0000, v218
    v_add_f32 v106, v106, v222
    v_add_f32 v107, v107, v223
    v_cvt_pk_bf16_f32 v104, v104, v105
    v_cvt_pk_bf16_f32 v105, v106, v107
    buffer_store_dwordx2 v[104:105], v5, s[60:63], s39 offen offset:32
    v_lshlrev_b32 v220, 16, v204
    v_and_b32 v221, 0xffff0000, v204
    v_lshlrev_b32 v222, 16, v205
    v_and_b32 v223, 0xffff0000, v205
    v_cvt_pk_bf16_f32 v218, v108, v109
    v_lshlrev_b32 v108, 16, v218
    v_and_b32 v109, 0xffff0000, v218
    v_mul_f32 v108, v108, v214
    v_mul_f32 v220, v220, v216
    v_mul_f32 v109, v109, v214
    v_mul_f32 v221, v221, v216
    v_cvt_pk_bf16_f32 v218, v108, v109
    v_lshlrev_b32 v108, 16, v218
    v_and_b32 v109, 0xffff0000, v218
    v_cvt_pk_bf16_f32 v218, v220, v221
    v_lshlrev_b32 v220, 16, v218
    v_and_b32 v221, 0xffff0000, v218
    v_add_f32 v108, v108, v220
    v_add_f32 v109, v109, v221
    v_cvt_pk_bf16_f32 v218, v110, v111
    v_lshlrev_b32 v110, 16, v218
    v_and_b32 v111, 0xffff0000, v218
    v_mul_f32 v110, v110, v214
    v_mul_f32 v222, v222, v216
    v_mul_f32 v111, v111, v214
    v_mul_f32 v223, v223, v216
    v_cvt_pk_bf16_f32 v218, v110, v111
    v_lshlrev_b32 v110, 16, v218
    v_and_b32 v111, 0xffff0000, v218
    v_cvt_pk_bf16_f32 v218, v222, v223
    v_lshlrev_b32 v222, 16, v218
    v_and_b32 v223, 0xffff0000, v218
    v_add_f32 v110, v110, v222
    v_add_f32 v111, v111, v223
    v_cvt_pk_bf16_f32 v108, v108, v109
    v_cvt_pk_bf16_f32 v109, v110, v111
    buffer_store_dwordx2 v[108:109], v5, s[60:63], s39 offen offset:64
KG_next:
    s_barrier
    s_cmp_lg_u32 s4, 0
    s_cbranch_scc1 KQ_wG
    s_mov_b32 exec_lo, 1
    s_mov_b32 exec_hi, 0
    v_mov_b32 v2, 52
    v_mov_b32 v3, 1
    global_atomic_add v4, v2, v3, s[32:33] sc0
    s_waitcnt vmcnt(0)
    v_mov_b32 v2, 0
    ds_write_b32 v2, v4 offset:16
    s_mov_b64 exec, -1
    s_waitcnt lgkmcnt(0)
KQ_wG:
    s_barrier
    v_mov_b32 v2, 0
    ds_read_b32 v3, v2 offset:16
    s_waitcnt lgkmcnt(0)
    v_readfirstlane_b32 s89, v3
    s_sub_u32 s89, s89, 720
    s_branch KG_loop
KM_done:
    s_endpgm
.section .rodata,"a"
.p2align 6
.amdhsa_kernel km_kernel
  .amdhsa_next_free_vgpr 512
  .amdhsa_next_free_sgpr 102
  .amdhsa_accum_offset 256
  .amdhsa_group_segment_fixed_size 0
  .amdhsa_kernarg_size 112
  .amdhsa_user_sgpr_count 2
  .amdhsa_user_sgpr_kernarg_segment_ptr 1
  .amdhsa_system_sgpr_workgroup_id_x 1
.end_amdhsa_kernel
.text
```
